```python
import torch

def _softmax(x, axis=-1):
    return torch.softmax(x, dim=axis)
def _gelu(x):
    return torch.nn.functional.gelu(x, approximate="tanh")
def _silu(x):
    return torch.nn.functional.silu(x)
def _sigmoid(x):
    return torch.sigmoid(x)
def _layernorm(x, axis=-1, eps=1e-5):
    m = x.mean(dim=axis, keepdim=True)
    v = x.var(dim=axis, keepdim=True, unbiased=False)
    return (x - m) / torch.sqrt(v + eps)
def _scatter_add(tgt, idx, src, axis=0):
    return tgt.clone().index_add_(axis, idx, src)
def _segment_sum(src, seg, n):
    out = torch.zeros((n,) + src.shape[1:], dtype=src.dtype)
    return out.index_add_(0, seg, src)
def _pad(x, pw):
    flat = tuple(v for pair in reversed(pw) for v in pair)
    return torch.nn.functional.pad(x, flat)

kernel_name = 'concat_heads__mha_block_cached__mha_block_cached__near_ridge'

def setup_inputs():

    _w = (lambda a: (lambda t: t.to(torch.bfloat16) if t.is_floating_point() else t)(torch.as_tensor(a)))
    def _A_setup():
        B, Sq, D = 8, 128, 448
        H, Sk, Dh = 16, 512, 256
        return {
            "x": _w((lambda *s: torch.randn(*s, dtype=torch.bfloat16) * 0.8)(B, Sq, D)),
            "k_cache": _w((lambda *s: torch.randn(*s, dtype=torch.bfloat16) * 0.8)(B, H, Sk, Dh)),
            "v_cache": _w((lambda *s: torch.randn(*s, dtype=torch.bfloat16) * 0.05)(B, H, Sk, Dh)),
            "wq": _w((lambda *s: torch.randn(*s, dtype=torch.bfloat16) * 0.8)(D, H * Dh) * (D ** -0.5)),
            "wo": _w((lambda *s: torch.randn(*s, dtype=torch.bfloat16) * 0.05)(H * Dh, D) * ((H * Dh) ** -0.5)),
        }
    _A_in = _A_setup()

    def _B_setup():
        B, Sq, D = 8, 128, 448
        H, Sk, Dh = 16, 512, 256
        return {
            "x": _w((lambda *s: torch.randn(*s, dtype=torch.bfloat16) * 0.8)(B, Sq, D)),
            "k_cache": _w((lambda *s: torch.randn(*s, dtype=torch.bfloat16) * 0.8)(B, H, Sk, Dh)),
            "v_cache": _w((lambda *s: torch.randn(*s, dtype=torch.bfloat16) * 0.05)(B, H, Sk, Dh)),
            "wq": _w((lambda *s: torch.randn(*s, dtype=torch.bfloat16) * 0.8)(D, H * Dh) * (D ** -0.5)),
            "wo": _w((lambda *s: torch.randn(*s, dtype=torch.bfloat16) * 0.05)(H * Dh, D) * ((H * Dh) ** -0.5)),
        }
    _B_in = _B_setup()

    return {
        "A_x": _A_in["x"],
        "A_k_cache": _A_in["k_cache"],
        "A_v_cache": _A_in["v_cache"],
        "A_wq": _A_in["wq"],
        "A_wo": _A_in["wo"],
        "B_x": _B_in["x"],
        "B_k_cache": _B_in["k_cache"],
        "B_v_cache": _B_in["v_cache"],
        "B_wq": _B_in["wq"],
        "B_wo": _B_in["wo"],
    }

def reference(A_x, A_k_cache, A_v_cache, A_wq, A_wo, B_x, B_k_cache, B_v_cache, B_wq, B_wo):
    def _A_ref(x, k_cache, v_cache, wq, wo):
        B, Sq, D = x.shape
        H, Dh = 16, 256
        q = (lambda x, *d: x.permute(*d))((x @ wq).reshape(B, Sq, H, Dh), 0, 2, 1, 3)
        scores = torch.einsum("bhqd,bhkd->bhqk", q, k_cache) * (Dh ** -0.5)
        p = _softmax(scores, axis=-1)
        o = torch.einsum("bhqk,bhkd->bhqd", p, v_cache)
        return (lambda x, *d: x.permute(*d))(o, 0, 2, 1, 3).reshape(B, Sq, H * Dh) @ wo

    def _B_ref(x, k_cache, v_cache, wq, wo):
        B, Sq, D = x.shape
        H, Dh = 16, 256
        q = (lambda x, *d: x.permute(*d))((x @ wq).reshape(B, Sq, H, Dh), 0, 2, 1, 3)
        scores = torch.einsum("bhqd,bhkd->bhqk", q, k_cache) * (Dh ** -0.5)
        p = _softmax(scores, axis=-1)
        o = torch.einsum("bhqk,bhkd->bhqd", p, v_cache)
        return (lambda x, *d: x.permute(*d))(o, 0, 2, 1, 3).reshape(B, Sq, H * Dh) @ wo

    a = _A_ref(A_x, A_k_cache, A_v_cache, A_wq, A_wo)
    b = _B_ref(B_x, B_k_cache, B_v_cache, B_wq, B_wo)
    return torch.concatenate([a, b], axis=-1)
```

```asm
; @launch grid=(256,1,1) block=(256,1,1) lds=163840
.amdgcn_target "amdgcn-amd-amdhsa--gfx950"
.text
.set CODE_END_OFF, L_end - concat_heads__mha_block_cached__mha_block_cached__near_ridge_kernel
.globl concat_heads__mha_block_cached__mha_block_cached__near_ridge_kernel
.p2align 12
.p2align 8
.type concat_heads__mha_block_cached__mha_block_cached__near_ridge_kernel,@function
concat_heads__mha_block_cached__mha_block_cached__near_ridge_kernel:
    s_cmp_ge_u32 s2, 256
    s_cbranch_scc1 L_end
    s_and_b32 s3, s2, 7
    s_lshr_b32 s32, s3, 2
    s_mul_i32 s5, s32, 40
    s_add_u32 s6, s0, s5
    s_addc_u32 s7, s1, 0
    s_load_dwordx4 s[80:83], s[6:7], 0
    s_load_dwordx4 s[84:87], s[6:7], 16
    s_load_dwordx2 s[88:89], s[6:7], 32
    s_load_dwordx2 s[90:91], s[0:1], 96
    s_load_dwordx4 s[96:99], s[0:1], 80
    s_lshr_b32 s4, s2, 3
    s_and_b32 s5, s4, 3
    s_and_b32 s6, s3, 3
    s_lshl_b32 s6, s6, 2
    s_add_u32 s34, s5, s6
    s_lshr_b32 s33, s4, 2
    s_getpc_b64 s[92:93]
    s_and_b32 s92, s92, 0xffffff00
    s_and_b32 s7, s4, 15
    s_lshl_b32 s7, s7, 12
    v_lshrrev_b32 v250, 6, v0
    v_lshlrev_b32 v250, 10, v250
    v_and_b32 v251, 15, v0
    v_lshl_add_u32 v250, v251, 6, v250
    v_add_u32 v250, s7, v250
    v_min_u32 v250, CODE_END_OFF - 64, v250
    s_mov_b64 exec, 0xffff
    global_load_dword v251, v250, s[92:93]
    s_mov_b64 exec, -1
    v_lshrrev_b32 v227, 6, v0
    v_and_b32 v243, 63, v0
    v_readfirstlane_b32 s35, v227
    v_lshrrev_b32 v224, 3, v243
    v_and_b32 v225, 7, v243
    v_lshrrev_b32 v229, 1, v224
    v_xor_b32 v231, v225, v229
    v_lshlrev_b32 v231, 4, v231
    s_lshl_b32 s36, s35, 12
    v_lshl_add_u32 v228, v227, 5, v224
    v_mul_u32_u24 v228, 896, v228
    v_add_u32 v229, v228, v231
    v_xor_b32 v230, 64, v229
    v_add_u32 v196, 0, v229
    v_add_u32 v197, 6144, v230
    v_add_u32 v198, 12288, v229
    v_add_u32 v199, 18432, v230
    v_and_b32 v229, 2, v224
    v_xor_b32 v229, v225, v229
    v_lshlrev_b32 v229, 4, v229
    v_lshl_add_u32 v229, v227, 7, v229
    v_lshl_add_u32 v229, v224, 13, v229
    v_xor_b32 v230, 64, v229
    v_add_u32 v192, 0, v229
    v_add_u32 v193, 64512, v230
    v_add_u32 v194, 129024, v229
    v_add_u32 v195, 193536, v230
    s_mul_i32 s5, s33, 114688
    s_lshl_b32 s6, s34, 9
    s_mov_b32 s26, 114688
    s_mov_b32 s27, 0x20000
    s_sub_u32 s18, 3670016, s6
    s_mov_b32 s19, 0x20000
    s_add_u32 s7, s34, s33
    s_and_b32 s7, s7, 3
    s_lshl_b32 s7, s7, 2
    s_lshr_b32 s7, 0x5025, s7
    s_and_b32 s7, s7, 7
    s_lshl_b32 s94, s7, 7
    s_lshl_b32 s95, s7, 19
    s_waitcnt lgkmcnt(0)
    s_add_u32 s24, s80, s5
    s_addc_u32 s25, s81, 0
    s_add_u32 s16, s86, s6
    s_addc_u32 s17, s87, 0
    s_add_u32 m0, s36, 0
    s_nop 0
    buffer_load_dwordx4 v196, s[24:27], s94 offen offset:0 lds
    buffer_load_dwordx4 v197, s[24:27], s94 offen offset:1024 lds
    buffer_load_dwordx4 v198, s[24:27], s94 offen offset:2048 lds
    buffer_load_dwordx4 v199, s[24:27], s94 offen offset:3072 lds
    s_add_u32 m0, s36, 16384
    s_nop 0
    buffer_load_dwordx4 v192, s[16:19], s95 offen offset:0 lds
    buffer_load_dwordx4 v193, s[16:19], s95 offen offset:1024 lds
    buffer_load_dwordx4 v194, s[16:19], s95 offen offset:2048 lds
    buffer_load_dwordx4 v195, s[16:19], s95 offen offset:3072 lds
    v_lshrrev_b32 v230, 4, v243
    v_and_b32 v232, 15, v243
    v_lshrrev_b32 v244, 1, v232
    v_xor_b32 v229, v244, v230
    v_lshlrev_b32 v229, 4, v229
    v_lshl_add_u32 v229, v232, 7, v229
    v_lshl_add_u32 v240, v227, 12, v229
    v_xor_b32 v241, 64, v240
    v_lshrrev_b32 v229, 1, v230
    v_xor_b32 v229, v229, v244
    v_lshlrev_b32 v229, 4, v229
    v_lshl_add_u32 v229, v232, 7, v229
    v_and_b32 v232, 1, v230
    v_lshl_add_u32 v212, v232, 3, v229
    v_xor_b32 v213, 32, v212
    v_xor_b32 v214, 64, v212
    v_xor_b32 v215, 96, v212
    v_bfe_u32 v244, v243, 2, 2
    v_lshl_add_u32 v229, v230, 3, v244
    v_lshlrev_b32 v229, 7, v229
    v_lshrrev_b32 v244, 1, v244
    v_lshl_add_u32 v244, v232, 1, v244
    v_lshl_add_u32 v229, v244, 5, v229
    v_and_b32 v244, 3, v243
    v_lshl_add_u32 v216, v244, 3, v229
    v_xor_b32 v217, 32, v216
    v_xor_b32 v218, 64, v216
    v_xor_b32 v219, 96, v216
    v_lshlrev_b32 v242, 9, v230
    v_lshl_add_u32 v229, v227, 7, v231
    v_lshl_add_u32 v229, v224, 9, v229
    v_xor_b32 v230, 64, v229
    v_add_u32 v200, 0, v229
    v_add_u32 v201, 3072, v230
    v_add_u32 v202, 6144, v229
    v_add_u32 v203, 9216, v230
    v_and_b32 v229, 6, v224
    v_xor_b32 v226, v225, v229
    v_lshlrev_b32 v226, 4, v226
    v_lshl_add_u32 v229, v227, 7, v226
    v_lshl_add_u32 v229, v224, 9, v229
    v_add_u32 v204, 0, v229
    v_add_u32 v205, 3072, v229
    v_add_u32 v206, 6144, v229
    v_add_u32 v207, 9216, v229
    v_add_u32 v229, v228, v226
    v_add_u32 v208, 0, v229
    v_add_u32 v209, 6144, v229
    v_add_u32 v210, 12288, v229
    v_add_u32 v211, 18432, v229
    v_mov_b32 v220, 0xff800000
    v_mov_b32 v221, 0xff800000
    v_lshlrev_b32 v222, 4, v243
    v_add_u32 v222, s36, v222
    s_mov_b32 s39, 0x3db8aa3b
    s_or_b32 s37, s34, s35
    s_lshl_b32 s5, s33, 4
    s_add_u32 s5, s5, s34
    s_lshl_b32 s6, s5, 18
    s_add_u32 s8, s82, s6
    s_addc_u32 s9, s83, 0
    s_mov_b32 s10, 262144
    s_mov_b32 s11, 0x20000
    s_add_u32 s12, s84, s6
    s_addc_u32 s13, s85, 0
    s_mov_b32 s14, 262144
    s_mov_b32 s15, 0x20000
    s_mul_i32 s6, s34, 229376
    s_add_u32 s20, s88, s6
    s_addc_u32 s21, s89, 0
    s_mov_b32 s22, 229376
    s_mov_b32 s23, 0x20000
    s_lshl_b32 s6, s32, 7
    s_add_u32 s5, s5, s6
    s_mul_i32 s5, s5, 262144
    s_add_u32 s28, s90, s5
    s_addc_u32 s29, s91, 0
    s_mov_b32 s30, 262144
    s_mov_b32 s31, 0x20000
    s_lshl_b32 s4, s32, 3
    s_add_u32 s4, s4, s33
    s_lshl_b32 s5, s4, 22
    s_add_u32 s5, s5, 0x3c000
    s_add_u32 s44, s90, s5
    s_addc_u32 s45, s91, 0
    s_mov_b32 s46, 8704
    s_mov_b32 s47, 0x20000
    s_lshl_b32 s5, s4, 2
    s_add_u32 s76, s98, s5
    s_addc_u32 s77, s99, 0
    s_mov_b32 s78, 4
    s_mov_b32 s79, 0x20000
    s_cmp_eq_u32 s33, 7
    s_cselect_b32 s5, 3, s33
    s_lshl_b32 s64, s5, 7
    s_add_u32 s65, s64, 128
    s_cmp_eq_u32 s65, 896
    s_cselect_b32 s65, 0, s65
    s_add_u32 s66, s65, 128
    s_cmp_eq_u32 s66, 896
    s_cselect_b32 s66, 0, s66
    s_add_u32 s67, s66, 128
    s_cmp_eq_u32 s67, 896
    s_cselect_b32 s67, 0, s67
    s_add_u32 s68, s67, 128
    s_cmp_eq_u32 s68, 896
    s_cselect_b32 s68, 0, s68
    s_add_u32 s69, s68, 128
    s_cmp_eq_u32 s69, 896
    s_cselect_b32 s69, 0, s69
    s_add_u32 s70, s69, 128
    s_cmp_eq_u32 s70, 896
    s_cselect_b32 s70, 0, s70
    v_and_b32 v246, 1, v243
    v_lshrrev_b32 v247, 1, v243
    v_and_b32 v244, 1, v247
    v_lshlrev_b32 v244, 12, v244
    v_lshl_add_u32 v244, v247, 7, v244
    v_lshl_add_u32 v244, v246, 13, v244
    s_lshl_b32 s5, s35, 10
    s_add_u32 s5, s5, 0x38000
    v_add_u32 v246, 1, v246
    s_add_u32 s72, s28, s5
    s_addc_u32 s73, s29, 0
    v_add_u32 v244, s5, v244
    s_mov_b32 s75, 0
    v_lshlrev_b32 v229, 3, v243
    v_mov_b32 v248, 0
    v_mov_b32 v249, 0
    s_cmp_lg_u32 s37, 0
    s_cbranch_scc1 L_nz
    buffer_store_dwordx2 v[248:249], v229, s[44:47], 0 offen sc0 sc1
    s_movk_i32 s5, 0x2000
    buffer_store_dwordx2 v[248:249], v229, s[44:47], s5 offen sc0 sc1
L_nz:
    s_add_u32 m0, s36, 32768
    s_add_u32 s38, s95, 262144
    s_sub_u32 s100, s38, 3670016
    s_min_u32 s38, s38, s100
    buffer_load_dwordx4 v192, s[16:19], s38 offen offset:0 lds
    buffer_load_dwordx4 v193, s[16:19], s38 offen offset:1024 lds
    buffer_load_dwordx4 v194, s[16:19], s38 offen offset:2048 lds
    buffer_load_dwordx4 v195, s[16:19], s38 offen offset:3072 lds
    s_add_u32 m0, s36, 49152
    s_add_u32 s38, s94, 128
    s_sub_u32 s100, s38, 896
    s_min_u32 s38, s38, s100
    buffer_load_dwordx4 v196, s[24:27], s38 offen offset:0 lds
    buffer_load_dwordx4 v197, s[24:27], s38 offen offset:1024 lds
    buffer_load_dwordx4 v198, s[24:27], s38 offen offset:2048 lds
    buffer_load_dwordx4 v199, s[24:27], s38 offen offset:3072 lds
    s_add_u32 m0, s36, 65536
    s_add_u32 s38, s95, 524288
    s_sub_u32 s100, s38, 3670016
    s_min_u32 s38, s38, s100
    buffer_load_dwordx4 v192, s[16:19], s38 offen offset:0 lds
    buffer_load_dwordx4 v193, s[16:19], s38 offen offset:1024 lds
    buffer_load_dwordx4 v194, s[16:19], s38 offen offset:2048 lds
    buffer_load_dwordx4 v195, s[16:19], s38 offen offset:3072 lds
    s_waitcnt vmcnt(12)
    s_barrier
    ds_read_b128 v[128:131], v240 offset:0
    ds_read_b128 v[132:135], v240 offset:2048
    ds_read_b128 v[136:139], v241 offset:0
    ds_read_b128 v[140:143], v241 offset:2048
    ds_read_b64_tr_b16 v[160:161], v216 offset:16384
    ds_read_b64_tr_b16 v[162:163], v216 offset:16896
    ds_read_b64_tr_b16 v[164:165], v217 offset:16384
    ds_read_b64_tr_b16 v[166:167], v217 offset:16896
    ds_read_b64_tr_b16 v[168:169], v218 offset:16384
    ds_read_b64_tr_b16 v[170:171], v218 offset:16896
    ds_read_b64_tr_b16 v[172:173], v219 offset:16384
    ds_read_b64_tr_b16 v[174:175], v219 offset:16896
    ds_read_b64_tr_b16 v[176:177], v216 offset:20480
    ds_read_b64_tr_b16 v[178:179], v216 offset:20992
    ds_read_b64_tr_b16 v[180:181], v217 offset:20480
    ds_read_b64_tr_b16 v[182:183], v217 offset:20992
    s_waitcnt lgkmcnt(10)
    v_mfma_f32_16x16x32_bf16 v[0:3], v[160:163], v[128:131], 0
    s_waitcnt lgkmcnt(8)
    ds_read_b64_tr_b16 v[184:185], v218 offset:20480
    ds_read_b64_tr_b16 v[186:187], v218 offset:20992
    v_mfma_f32_16x16x32_bf16 v[8:11], v[160:163], v[132:135], 0
    s_add_u32 m0, s36, 81920
    v_mfma_f32_16x16x32_bf16 v[4:7], v[164:167], v[128:131], 0
    s_waitcnt lgkmcnt(8)
    ds_read_b64_tr_b16 v[188:189], v219 offset:20480
    ds_read_b64_tr_b16 v[190:191], v219 offset:20992
    v_mfma_f32_16x16x32_bf16 v[12:15], v[164:167], v[132:135], 0
    s_add_u32 s38, s95, 786432
    v_mfma_f32_16x16x32_bf16 v[16:19], v[168:171], v[128:131], 0
    s_waitcnt lgkmcnt(8)
    ds_read_b64_tr_b16 v[160:161], v216 offset:24576
    ds_read_b64_tr_b16 v[162:163], v216 offset:25088
    v_mfma_f32_16x16x32_bf16 v[24:27], v[168:171], v[132:135], 0
    s_sub_u32 s100, s38, 3670016
    v_mfma_f32_16x16x32_bf16 v[20:23], v[172:175], v[128:131], 0
    s_waitcnt lgkmcnt(8)
    ds_read_b64_tr_b16 v[164:165], v217 offset:24576
    ds_read_b64_tr_b16 v[166:167], v217 offset:25088
    v_mfma_f32_16x16x32_bf16 v[28:31], v[172:175], v[132:135], 0
    s_min_u32 s38, s38, s100
    v_mfma_f32_16x16x32_bf16 v[32:35], v[176:179], v[128:131], 0
    s_waitcnt lgkmcnt(8)
    ds_read_b64_tr_b16 v[168:169], v218 offset:24576
    ds_read_b64_tr_b16 v[170:171], v218 offset:25088
    v_mfma_f32_16x16x32_bf16 v[40:43], v[176:179], v[132:135], 0
    buffer_load_dwordx4 v192, s[16:19], s38 offen offset:0 lds
    v_mfma_f32_16x16x32_bf16 v[36:39], v[180:183], v[128:131], 0
    s_waitcnt lgkmcnt(8)
    ds_read_b64_tr_b16 v[172:173], v219 offset:24576
    ds_read_b64_tr_b16 v[174:175], v219 offset:25088
    v_mfma_f32_16x16x32_bf16 v[44:47], v[180:183], v[132:135], 0
    buffer_load_dwordx4 v193, s[16:19], s38 offen offset:1024 lds
    v_mfma_f32_16x16x32_bf16 v[48:51], v[184:187], v[128:131], 0
    s_waitcnt lgkmcnt(8)
    ds_read_b64_tr_b16 v[176:177], v216 offset:28672
    ds_read_b64_tr_b16 v[178:179], v216 offset:29184
    v_mfma_f32_16x16x32_bf16 v[56:59], v[184:187], v[132:135], 0
    buffer_load_dwordx4 v194, s[16:19], s38 offen offset:2048 lds
    v_mfma_f32_16x16x32_bf16 v[52:55], v[188:191], v[128:131], 0
    s_waitcnt lgkmcnt(8)
    ds_read_b64_tr_b16 v[180:181], v217 offset:28672
    ds_read_b64_tr_b16 v[182:183], v217 offset:29184
    v_mfma_f32_16x16x32_bf16 v[60:63], v[188:191], v[132:135], 0
    v_mfma_f32_16x16x32_bf16 v[64:67], v[160:163], v[128:131], 0
    s_waitcnt lgkmcnt(8)
    ds_read_b64_tr_b16 v[184:185], v218 offset:28672
    ds_read_b64_tr_b16 v[186:187], v218 offset:29184
    v_mfma_f32_16x16x32_bf16 v[72:75], v[160:163], v[132:135], 0
    buffer_load_dwordx4 v195, s[16:19], s38 offen offset:3072 lds
    v_mfma_f32_16x16x32_bf16 v[68:71], v[164:167], v[128:131], 0
    s_waitcnt lgkmcnt(8)
    ds_read_b64_tr_b16 v[188:189], v219 offset:28672
    ds_read_b64_tr_b16 v[190:191], v219 offset:29184
    v_mfma_f32_16x16x32_bf16 v[76:79], v[164:167], v[132:135], 0
    s_waitcnt vmcnt(12)
    s_barrier
    v_mfma_f32_16x16x32_bf16 v[80:83], v[168:171], v[128:131], 0
    s_waitcnt lgkmcnt(8)
    ds_read_b64_tr_b16 v[160:161], v216 offset:32768
    ds_read_b64_tr_b16 v[162:163], v216 offset:33280
    v_mfma_f32_16x16x32_bf16 v[88:91], v[168:171], v[132:135], 0
    s_add_u32 m0, s36, 98304
    s_add_u32 s38, s94, 256
    v_mfma_f32_16x16x32_bf16 v[84:87], v[172:175], v[128:131], 0
    s_waitcnt lgkmcnt(8)
    ds_read_b64_tr_b16 v[164:165], v217 offset:32768
    ds_read_b64_tr_b16 v[166:167], v217 offset:33280
    v_mfma_f32_16x16x32_bf16 v[92:95], v[172:175], v[132:135], 0
    s_sub_u32 s100, s38, 896
    s_min_u32 s38, s38, s100
    v_mfma_f32_16x16x32_bf16 v[96:99], v[176:179], v[128:131], 0
    s_waitcnt lgkmcnt(8)
    ds_read_b64_tr_b16 v[168:169], v218 offset:32768
    ds_read_b64_tr_b16 v[170:171], v218 offset:33280
    v_mfma_f32_16x16x32_bf16 v[104:107], v[176:179], v[132:135], 0
    buffer_load_dwordx4 v196, s[24:27], s38 offen offset:0 lds
    v_mfma_f32_16x16x32_bf16 v[100:103], v[180:183], v[128:131], 0
    s_waitcnt lgkmcnt(8)
    ds_read_b64_tr_b16 v[172:173], v219 offset:32768
    ds_read_b64_tr_b16 v[174:175], v219 offset:33280
    v_mfma_f32_16x16x32_bf16 v[108:111], v[180:183], v[132:135], 0
    buffer_load_dwordx4 v197, s[24:27], s38 offen offset:1024 lds
    v_mfma_f32_16x16x32_bf16 v[112:115], v[184:187], v[128:131], 0
    s_waitcnt lgkmcnt(8)
    ds_read_b64_tr_b16 v[176:177], v216 offset:36864
    ds_read_b64_tr_b16 v[178:179], v216 offset:37376
    v_mfma_f32_16x16x32_bf16 v[120:123], v[184:187], v[132:135], 0
    buffer_load_dwordx4 v198, s[24:27], s38 offen offset:2048 lds
    v_mfma_f32_16x16x32_bf16 v[116:119], v[188:191], v[128:131], 0
    s_waitcnt lgkmcnt(8)
    ds_read_b64_tr_b16 v[180:181], v217 offset:36864
    ds_read_b64_tr_b16 v[182:183], v217 offset:37376
    v_mfma_f32_16x16x32_bf16 v[124:127], v[188:191], v[132:135], 0
    buffer_load_dwordx4 v199, s[24:27], s38 offen offset:3072 lds
    v_mfma_f32_16x16x32_bf16 v[0:3], v[160:163], v[136:139], v[0:3]
    s_waitcnt lgkmcnt(8)
    ds_read_b64_tr_b16 v[184:185], v218 offset:36864
    ds_read_b64_tr_b16 v[186:187], v218 offset:37376
    v_mfma_f32_16x16x32_bf16 v[8:11], v[160:163], v[140:143], v[8:11]
    s_add_u32 m0, s36, 114688
    v_mfma_f32_16x16x32_bf16 v[4:7], v[164:167], v[136:139], v[4:7]
    s_waitcnt lgkmcnt(8)
    ds_read_b64_tr_b16 v[188:189], v219 offset:36864
    ds_read_b64_tr_b16 v[190:191], v219 offset:37376
    v_mfma_f32_16x16x32_bf16 v[12:15], v[164:167], v[140:143], v[12:15]
    s_add_u32 s38, s95, 1048576
    v_mfma_f32_16x16x32_bf16 v[16:19], v[168:171], v[136:139], v[16:19]
    s_waitcnt lgkmcnt(8)
    ds_read_b64_tr_b16 v[160:161], v216 offset:40960
    ds_read_b64_tr_b16 v[162:163], v216 offset:41472
    v_mfma_f32_16x16x32_bf16 v[24:27], v[168:171], v[140:143], v[24:27]
    s_sub_u32 s100, s38, 3670016
    s_mul_i32 s42, s33, 28672
    s_mul_i32 s43, s35, 7168
    s_add_u32 s42, s42, s43
    v_lshlrev_b32 v253, 4, v243
    buffer_load_dwordx4 a[0:3], v253, s[20:23], s42 offen
    v_mfma_f32_16x16x32_bf16 v[20:23], v[172:175], v[136:139], v[20:23]
    s_waitcnt lgkmcnt(8)
    ds_read_b64_tr_b16 v[164:165], v217 offset:40960
    ds_read_b64_tr_b16 v[166:167], v217 offset:41472
    v_mfma_f32_16x16x32_bf16 v[28:31], v[172:175], v[140:143], v[28:31]
    s_min_u32 s38, s38, s100
    v_mfma_f32_16x16x32_bf16 v[32:35], v[176:179], v[136:139], v[32:35]
    s_waitcnt lgkmcnt(8)
    ds_read_b64_tr_b16 v[168:169], v218 offset:40960
    ds_read_b64_tr_b16 v[170:171], v218 offset:41472
    v_mfma_f32_16x16x32_bf16 v[40:43], v[176:179], v[140:143], v[40:43]
    s_mov_b64 exec, 15
    buffer_store_dword v246, v244, s[28:31], 0 offen sc0 sc1
    s_mov_b64 exec, -1
    v_mfma_f32_16x16x32_bf16 v[36:39], v[180:183], v[136:139], v[36:39]
    s_waitcnt lgkmcnt(8)
    ds_read_b64_tr_b16 v[172:173], v219 offset:40960
    ds_read_b64_tr_b16 v[174:175], v219 offset:41472
    v_mfma_f32_16x16x32_bf16 v[44:47], v[180:183], v[140:143], v[44:47]
    s_add_u32 s42, s42, 1024
    buffer_load_dwordx4 a[0:3], v253, s[20:23], s42 offen
    v_mfma_f32_16x16x32_bf16 v[48:51], v[184:187], v[136:139], v[48:51]
    s_waitcnt lgkmcnt(8)
    ds_read_b64_tr_b16 v[176:177], v216 offset:45056
    ds_read_b64_tr_b16 v[178:179], v216 offset:45568
    v_mfma_f32_16x16x32_bf16 v[56:59], v[184:187], v[140:143], v[56:59]
    s_add_u32 s42, s42, 1024
    buffer_load_dwordx4 a[0:3], v253, s[20:23], s42 offen
    v_add_u32 v216, 65536, v216
    v_mfma_f32_16x16x32_bf16 v[52:55], v[188:191], v[136:139], v[52:55]
    s_waitcnt lgkmcnt(8)
    ds_read_b64_tr_b16 v[180:181], v217 offset:45056
    ds_read_b64_tr_b16 v[182:183], v217 offset:45568
    v_mfma_f32_16x16x32_bf16 v[60:63], v[188:191], v[140:143], v[60:63]
    buffer_load_dwordx4 v192, s[16:19], s38 offen offset:0 lds
    v_add_u32 v217, 65536, v217
    v_mfma_f32_16x16x32_bf16 v[64:67], v[160:163], v[136:139], v[64:67]
    s_waitcnt lgkmcnt(8)
    ds_read_b64_tr_b16 v[184:185], v218 offset:45056
    ds_read_b64_tr_b16 v[186:187], v218 offset:45568
    v_mfma_f32_16x16x32_bf16 v[72:75], v[160:163], v[140:143], v[72:75]
    s_add_u32 s42, s42, 1024
    buffer_load_dwordx4 a[0:3], v253, s[20:23], s42 offen
    v_add_u32 v218, 65536, v218
    v_mfma_f32_16x16x32_bf16 v[68:71], v[164:167], v[136:139], v[68:71]
    s_waitcnt lgkmcnt(8)
    ds_read_b64_tr_b16 v[188:189], v219 offset:45056
    ds_read_b64_tr_b16 v[190:191], v219 offset:45568
    v_mfma_f32_16x16x32_bf16 v[76:79], v[164:167], v[140:143], v[76:79]
    buffer_load_dwordx4 v193, s[16:19], s38 offen offset:1024 lds
    buffer_load_dwordx4 v194, s[16:19], s38 offen offset:2048 lds
    buffer_load_dwordx4 v195, s[16:19], s38 offen offset:3072 lds
    s_waitcnt vmcnt(17)
    s_barrier
    ds_read_b128 v[144:147], v240 offset:49152
    v_add_u32 v219, 65536, v219
    v_mfma_f32_16x16x32_bf16 v[80:83], v[168:171], v[136:139], v[80:83]
    s_waitcnt lgkmcnt(9)
    ds_read_b64_tr_b16 v[160:161], v216 offset:0
    ds_read_b64_tr_b16 v[162:163], v216 offset:512
    v_mfma_f32_16x16x32_bf16 v[88:91], v[168:171], v[140:143], v[88:91]
    s_add_u32 m0, s36, 131072
    ds_read_b128 v[148:151], v240 offset:51200
    s_add_u32 s42, s42, 1024
    buffer_load_dwordx4 a[0:3], v253, s[20:23], s42 offen
    v_add_u32 v240, 65536, v240
    v_mfma_f32_16x16x32_bf16 v[84:87], v[172:175], v[136:139], v[84:87]
    s_waitcnt lgkmcnt(10)
    ds_read_b64_tr_b16 v[164:165], v217 offset:0
    ds_read_b64_tr_b16 v[166:167], v217 offset:512
    v_mfma_f32_16x16x32_bf16 v[92:95], v[172:175], v[140:143], v[92:95]
    s_add_u32 s38, s95, 1310720
    ds_read_b128 v[152:155], v241 offset:49152
    v_mfma_f32_16x16x32_bf16 v[96:99], v[176:179], v[136:139], v[96:99]
    s_waitcnt lgkmcnt(11)
    ds_read_b64_tr_b16 v[168:169], v218 offset:0
    ds_read_b64_tr_b16 v[170:171], v218 offset:512
    v_mfma_f32_16x16x32_bf16 v[104:107], v[176:179], v[140:143], v[104:107]
    s_sub_u32 s100, s38, 3670016
    ds_read_b128 v[156:159], v241 offset:51200
    s_add_u32 s42, s42, 1024
    buffer_load_dwordx4 a[0:3], v253, s[20:23], s42 offen
    v_add_u32 v241, 65536, v241
    v_mfma_f32_16x16x32_bf16 v[100:103], v[180:183], v[136:139], v[100:103]
    s_waitcnt lgkmcnt(12)
    ds_read_b64_tr_b16 v[172:173], v219 offset:0
    ds_read_b64_tr_b16 v[174:175], v219 offset:512
    v_mfma_f32_16x16x32_bf16 v[108:111], v[180:183], v[140:143], v[108:111]
    s_min_u32 s38, s38, s100
    v_mfma_f32_16x16x32_bf16 v[112:115], v[184:187], v[136:139], v[112:115]
    s_waitcnt lgkmcnt(12)
    ds_read_b64_tr_b16 v[176:177], v216 offset:4096
    ds_read_b64_tr_b16 v[178:179], v216 offset:4608
    v_mfma_f32_16x16x32_bf16 v[120:123], v[184:187], v[140:143], v[120:123]
    s_add_u32 s42, s42, 1024
    buffer_load_dwordx4 a[0:3], v253, s[20:23], s42 offen
    v_mfma_f32_16x16x32_bf16 v[116:119], v[188:191], v[136:139], v[116:119]
    s_waitcnt lgkmcnt(10)
    ds_read_b64_tr_b16 v[180:181], v217 offset:4096
    ds_read_b64_tr_b16 v[182:183], v217 offset:4608
    v_mfma_f32_16x16x32_bf16 v[124:127], v[188:191], v[140:143], v[124:127]
    buffer_load_dwordx4 v192, s[16:19], s38 offen offset:0 lds
    v_mfma_f32_16x16x32_bf16 v[0:3], v[160:163], v[144:147], v[0:3]
    s_waitcnt lgkmcnt(10)
    ds_read_b64_tr_b16 v[184:185], v218 offset:4096
    ds_read_b64_tr_b16 v[186:187], v218 offset:4608
    v_mfma_f32_16x16x32_bf16 v[8:11], v[160:163], v[148:151], v[8:11]
    v_mfma_f32_16x16x32_bf16 v[4:7], v[164:167], v[144:147], v[4:7]
    s_waitcnt lgkmcnt(9)
    ds_read_b64_tr_b16 v[188:189], v219 offset:4096
    ds_read_b64_tr_b16 v[190:191], v219 offset:4608
    v_mfma_f32_16x16x32_bf16 v[12:15], v[164:167], v[148:151], v[12:15]
    buffer_load_dwordx4 v193, s[16:19], s38 offen offset:1024 lds
    v_mfma_f32_16x16x32_bf16 v[16:19], v[168:171], v[144:147], v[16:19]
    s_waitcnt lgkmcnt(8)
    ds_read_b64_tr_b16 v[160:161], v216 offset:8192
    ds_read_b64_tr_b16 v[162:163], v216 offset:8704
    v_mfma_f32_16x16x32_bf16 v[24:27], v[168:171], v[148:151], v[24:27]
    v_mfma_f32_16x16x32_bf16 v[20:23], v[172:175], v[144:147], v[20:23]
    s_waitcnt lgkmcnt(8)
    ds_read_b64_tr_b16 v[164:165], v217 offset:8192
    ds_read_b64_tr_b16 v[166:167], v217 offset:8704
    v_mfma_f32_16x16x32_bf16 v[28:31], v[172:175], v[148:151], v[28:31]
    v_mfma_f32_16x16x32_bf16 v[32:35], v[176:179], v[144:147], v[32:35]
    s_waitcnt lgkmcnt(8)
    ds_read_b64_tr_b16 v[168:169], v218 offset:8192
    ds_read_b64_tr_b16 v[170:171], v218 offset:8704
    v_mfma_f32_16x16x32_bf16 v[40:43], v[176:179], v[148:151], v[40:43]
    buffer_load_dwordx4 v194, s[16:19], s38 offen offset:2048 lds
    v_mfma_f32_16x16x32_bf16 v[36:39], v[180:183], v[144:147], v[36:39]
    s_waitcnt lgkmcnt(8)
    ds_read_b64_tr_b16 v[172:173], v219 offset:8192
    ds_read_b64_tr_b16 v[174:175], v219 offset:8704
    v_mfma_f32_16x16x32_bf16 v[44:47], v[180:183], v[148:151], v[44:47]
    v_mfma_f32_16x16x32_bf16 v[48:51], v[184:187], v[144:147], v[48:51]
    s_waitcnt lgkmcnt(8)
    ds_read_b64_tr_b16 v[176:177], v216 offset:12288
    ds_read_b64_tr_b16 v[178:179], v216 offset:12800
    v_mfma_f32_16x16x32_bf16 v[56:59], v[184:187], v[148:151], v[56:59]
    v_mfma_f32_16x16x32_bf16 v[52:55], v[188:191], v[144:147], v[52:55]
    s_waitcnt lgkmcnt(8)
    ds_read_b64_tr_b16 v[180:181], v217 offset:12288
    ds_read_b64_tr_b16 v[182:183], v217 offset:12800
    v_mfma_f32_16x16x32_bf16 v[60:63], v[188:191], v[148:151], v[60:63]
    buffer_load_dwordx4 v195, s[16:19], s38 offen offset:3072 lds
    v_mfma_f32_16x16x32_bf16 v[64:67], v[160:163], v[144:147], v[64:67]
    s_waitcnt lgkmcnt(8)
    ds_read_b64_tr_b16 v[184:185], v218 offset:12288
    ds_read_b64_tr_b16 v[186:187], v218 offset:12800
    v_mfma_f32_16x16x32_bf16 v[72:75], v[160:163], v[148:151], v[72:75]
    v_mfma_f32_16x16x32_bf16 v[68:71], v[164:167], v[144:147], v[68:71]
    s_waitcnt lgkmcnt(8)
    ds_read_b64_tr_b16 v[188:189], v219 offset:12288
    ds_read_b64_tr_b16 v[190:191], v219 offset:12800
    v_mfma_f32_16x16x32_bf16 v[76:79], v[164:167], v[148:151], v[76:79]
    s_waitcnt vmcnt(20)
    s_barrier
    v_mfma_f32_16x16x32_bf16 v[80:83], v[168:171], v[144:147], v[80:83]
    s_waitcnt lgkmcnt(8)
    ds_read_b64_tr_b16 v[160:161], v216 offset:16384
    ds_read_b64_tr_b16 v[162:163], v216 offset:16896
    v_mfma_f32_16x16x32_bf16 v[88:91], v[168:171], v[148:151], v[88:91]
    s_add_u32 m0, s36, 147456
    s_add_u32 s38, s94, 384
    v_mfma_f32_16x16x32_bf16 v[84:87], v[172:175], v[144:147], v[84:87]
    s_waitcnt lgkmcnt(8)
    ds_read_b64_tr_b16 v[164:165], v217 offset:16384
    ds_read_b64_tr_b16 v[166:167], v217 offset:16896
    v_mfma_f32_16x16x32_bf16 v[92:95], v[172:175], v[148:151], v[92:95]
    s_sub_u32 s100, s38, 896
    s_min_u32 s38, s38, s100
    v_mfma_f32_16x16x32_bf16 v[96:99], v[176:179], v[144:147], v[96:99]
    s_waitcnt lgkmcnt(8)
    ds_read_b64_tr_b16 v[168:169], v218 offset:16384
    ds_read_b64_tr_b16 v[170:171], v218 offset:16896
    v_mfma_f32_16x16x32_bf16 v[104:107], v[176:179], v[148:151], v[104:107]
    buffer_load_dwordx4 v196, s[24:27], s38 offen offset:0 lds
    v_mfma_f32_16x16x32_bf16 v[100:103], v[180:183], v[144:147], v[100:103]
    s_waitcnt lgkmcnt(8)
    ds_read_b64_tr_b16 v[172:173], v219 offset:16384
    ds_read_b64_tr_b16 v[174:175], v219 offset:16896
    v_mfma_f32_16x16x32_bf16 v[108:111], v[180:183], v[148:151], v[108:111]
    buffer_load_dwordx4 v197, s[24:27], s38 offen offset:1024 lds
    v_mfma_f32_16x16x32_bf16 v[112:115], v[184:187], v[144:147], v[112:115]
    s_waitcnt lgkmcnt(8)
    ds_read_b64_tr_b16 v[176:177], v216 offset:20480
    ds_read_b64_tr_b16 v[178:179], v216 offset:20992
    v_mfma_f32_16x16x32_bf16 v[120:123], v[184:187], v[148:151], v[120:123]
    buffer_load_dwordx4 v198, s[24:27], s38 offen offset:2048 lds
    v_mfma_f32_16x16x32_bf16 v[116:119], v[188:191], v[144:147], v[116:119]
    s_waitcnt lgkmcnt(8)
    ds_read_b64_tr_b16 v[180:181], v217 offset:20480
    ds_read_b64_tr_b16 v[182:183], v217 offset:20992
    v_mfma_f32_16x16x32_bf16 v[124:127], v[188:191], v[148:151], v[124:127]
    buffer_load_dwordx4 v199, s[24:27], s38 offen offset:3072 lds
    v_mfma_f32_16x16x32_bf16 v[0:3], v[160:163], v[152:155], v[0:3]
    s_waitcnt lgkmcnt(8)
    ds_read_b64_tr_b16 v[184:185], v218 offset:20480
    ds_read_b64_tr_b16 v[186:187], v218 offset:20992
    v_mfma_f32_16x16x32_bf16 v[8:11], v[160:163], v[156:159], v[8:11]
    s_add_u32 m0, s36, 0
    v_mfma_f32_16x16x32_bf16 v[4:7], v[164:167], v[152:155], v[4:7]
    s_waitcnt lgkmcnt(8)
    ds_read_b64_tr_b16 v[188:189], v219 offset:20480
    ds_read_b64_tr_b16 v[190:191], v219 offset:20992
    v_mfma_f32_16x16x32_bf16 v[12:15], v[164:167], v[156:159], v[12:15]
    s_add_u32 s38, s95, 1572864
    v_mfma_f32_16x16x32_bf16 v[16:19], v[168:171], v[152:155], v[16:19]
    s_waitcnt lgkmcnt(8)
    ds_read_b64_tr_b16 v[160:161], v216 offset:24576
    ds_read_b64_tr_b16 v[162:163], v216 offset:25088
    v_mfma_f32_16x16x32_bf16 v[24:27], v[168:171], v[156:159], v[24:27]
    s_sub_u32 s100, s38, 3670016
    v_mfma_f32_16x16x32_bf16 v[20:23], v[172:175], v[152:155], v[20:23]
    s_waitcnt lgkmcnt(8)
    ds_read_b64_tr_b16 v[164:165], v217 offset:24576
    ds_read_b64_tr_b16 v[166:167], v217 offset:25088
    v_mfma_f32_16x16x32_bf16 v[28:31], v[172:175], v[156:159], v[28:31]
    s_min_u32 s38, s38, s100
    v_mfma_f32_16x16x32_bf16 v[32:35], v[176:179], v[152:155], v[32:35]
    s_waitcnt lgkmcnt(8)
    ds_read_b64_tr_b16 v[168:169], v218 offset:24576
    ds_read_b64_tr_b16 v[170:171], v218 offset:25088
    v_mfma_f32_16x16x32_bf16 v[40:43], v[176:179], v[156:159], v[40:43]
    buffer_load_dwordx4 v192, s[16:19], s38 offen offset:0 lds
    v_mfma_f32_16x16x32_bf16 v[36:39], v[180:183], v[152:155], v[36:39]
    s_waitcnt lgkmcnt(8)
    ds_read_b64_tr_b16 v[172:173], v219 offset:24576
    ds_read_b64_tr_b16 v[174:175], v219 offset:25088
    v_mfma_f32_16x16x32_bf16 v[44:47], v[180:183], v[156:159], v[44:47]
    buffer_load_dwordx4 v193, s[16:19], s38 offen offset:1024 lds
    v_mfma_f32_16x16x32_bf16 v[48:51], v[184:187], v[152:155], v[48:51]
    s_waitcnt lgkmcnt(8)
    ds_read_b64_tr_b16 v[176:177], v216 offset:28672
    ds_read_b64_tr_b16 v[178:179], v216 offset:29184
    v_mfma_f32_16x16x32_bf16 v[56:59], v[184:187], v[156:159], v[56:59]
    buffer_load_dwordx4 v194, s[16:19], s38 offen offset:2048 lds
    v_mfma_f32_16x16x32_bf16 v[52:55], v[188:191], v[152:155], v[52:55]
    s_waitcnt lgkmcnt(8)
    ds_read_b64_tr_b16 v[180:181], v217 offset:28672
    ds_read_b64_tr_b16 v[182:183], v217 offset:29184
    v_mfma_f32_16x16x32_bf16 v[60:63], v[188:191], v[156:159], v[60:63]
    v_mfma_f32_16x16x32_bf16 v[64:67], v[160:163], v[152:155], v[64:67]
    s_waitcnt lgkmcnt(8)
    ds_read_b64_tr_b16 v[184:185], v218 offset:28672
    ds_read_b64_tr_b16 v[186:187], v218 offset:29184
    v_mfma_f32_16x16x32_bf16 v[72:75], v[160:163], v[156:159], v[72:75]
    buffer_load_dwordx4 v195, s[16:19], s38 offen offset:3072 lds
    v_mfma_f32_16x16x32_bf16 v[68:71], v[164:167], v[152:155], v[68:71]
    s_waitcnt lgkmcnt(8)
    ds_read_b64_tr_b16 v[188:189], v219 offset:28672
    ds_read_b64_tr_b16 v[190:191], v219 offset:29184
    v_mfma_f32_16x16x32_bf16 v[76:79], v[164:167], v[156:159], v[76:79]
    s_waitcnt vmcnt(15)
    s_barrier
    ds_read_b128 v[128:131], v240 offset:32768
    v_mfma_f32_16x16x32_bf16 v[80:83], v[168:171], v[152:155], v[80:83]
    s_waitcnt lgkmcnt(9)
    ds_read_b64_tr_b16 v[160:161], v216 offset:49152
    ds_read_b64_tr_b16 v[162:163], v216 offset:49664
    v_mfma_f32_16x16x32_bf16 v[88:91], v[168:171], v[156:159], v[88:91]
    s_add_u32 m0, s36, 16384
    ds_read_b128 v[132:135], v240 offset:34816
    s_mov_b32 s41, 65536
    buffer_load_dwordx4 a[64:67], v200, s[8:11], s41 offen offset:0 nt
    v_add_u32 v240, 65536, v240
    v_mfma_f32_16x16x32_bf16 v[84:87], v[172:175], v[152:155], v[84:87]
    s_waitcnt lgkmcnt(10)
    ds_read_b64_tr_b16 v[164:165], v217 offset:49152
    ds_read_b64_tr_b16 v[166:167], v217 offset:49664
    v_mfma_f32_16x16x32_bf16 v[92:95], v[172:175], v[156:159], v[92:95]
    s_add_u32 s38, s95, 1835008
    ds_read_b128 v[136:139], v241 offset:32768
    v_mfma_f32_16x16x32_bf16 v[96:99], v[176:179], v[152:155], v[96:99]
    s_waitcnt lgkmcnt(11)
    ds_read_b64_tr_b16 v[168:169], v218 offset:49152
    ds_read_b64_tr_b16 v[170:171], v218 offset:49664
    v_mfma_f32_16x16x32_bf16 v[104:107], v[176:179], v[156:159], v[104:107]
    s_sub_u32 s100, s38, 3670016
    ds_read_b128 v[140:143], v241 offset:34816
    s_mov_b32 s41, 65536
    buffer_load_dwordx4 a[68:71], v201, s[8:11], s41 offen offset:1024 nt
    v_add_u32 v241, 65536, v241
    v_mfma_f32_16x16x32_bf16 v[100:103], v[180:183], v[152:155], v[100:103]
    s_waitcnt lgkmcnt(12)
    ds_read_b64_tr_b16 v[172:173], v219 offset:49152
    ds_read_b64_tr_b16 v[174:175], v219 offset:49664
    v_mfma_f32_16x16x32_bf16 v[108:111], v[180:183], v[156:159], v[108:111]
    s_min_u32 s38, s38, s100
    v_mfma_f32_16x16x32_bf16 v[112:115], v[184:187], v[152:155], v[112:115]
    s_waitcnt lgkmcnt(12)
    ds_read_b64_tr_b16 v[176:177], v216 offset:53248
    ds_read_b64_tr_b16 v[178:179], v216 offset:53760
    v_mfma_f32_16x16x32_bf16 v[120:123], v[184:187], v[156:159], v[120:123]
    s_mov_b32 s41, 65536
    buffer_load_dwordx4 a[72:75], v202, s[8:11], s41 offen offset:2048 nt
    v_mfma_f32_16x16x32_bf16 v[116:119], v[188:191], v[152:155], v[116:119]
    s_waitcnt lgkmcnt(10)
    ds_read_b64_tr_b16 v[180:181], v217 offset:53248
    ds_read_b64_tr_b16 v[182:183], v217 offset:53760
    v_mfma_f32_16x16x32_bf16 v[124:127], v[188:191], v[156:159], v[124:127]
    buffer_load_dwordx4 v192, s[16:19], s38 offen offset:0 lds
    v_mfma_f32_16x16x32_bf16 v[0:3], v[160:163], v[128:131], v[0:3]
    s_waitcnt lgkmcnt(10)
    ds_read_b64_tr_b16 v[184:185], v218 offset:53248
    ds_read_b64_tr_b16 v[186:187], v218 offset:53760
    v_mfma_f32_16x16x32_bf16 v[8:11], v[160:163], v[132:135], v[8:11]
    s_mov_b32 s41, 65536
    buffer_load_dwordx4 a[76:79], v203, s[8:11], s41 offen offset:3072 nt
    v_mfma_f32_16x16x32_bf16 v[4:7], v[164:167], v[128:131], v[4:7]
    s_waitcnt lgkmcnt(9)
    ds_read_b64_tr_b16 v[188:189], v219 offset:53248
    ds_read_b64_tr_b16 v[190:191], v219 offset:53760
    v_mfma_f32_16x16x32_bf16 v[12:15], v[164:167], v[132:135], v[12:15]
    buffer_load_dwordx4 v193, s[16:19], s38 offen offset:1024 lds
    v_mfma_f32_16x16x32_bf16 v[16:19], v[168:171], v[128:131], v[16:19]
    s_waitcnt lgkmcnt(8)
    ds_read_b64_tr_b16 v[160:161], v216 offset:57344
    ds_read_b64_tr_b16 v[162:163], v216 offset:57856
    v_mfma_f32_16x16x32_bf16 v[24:27], v[168:171], v[132:135], v[24:27]
    v_mfma_f32_16x16x32_bf16 v[20:23], v[172:175], v[128:131], v[20:23]
    s_waitcnt lgkmcnt(8)
    ds_read_b64_tr_b16 v[164:165], v217 offset:57344
    ds_read_b64_tr_b16 v[166:167], v217 offset:57856
    v_mfma_f32_16x16x32_bf16 v[28:31], v[172:175], v[132:135], v[28:31]
    v_mfma_f32_16x16x32_bf16 v[32:35], v[176:179], v[128:131], v[32:35]
    s_waitcnt lgkmcnt(8)
    ds_read_b64_tr_b16 v[168:169], v218 offset:57344
    ds_read_b64_tr_b16 v[170:171], v218 offset:57856
    v_mfma_f32_16x16x32_bf16 v[40:43], v[176:179], v[132:135], v[40:43]
    buffer_load_dwordx4 v194, s[16:19], s38 offen offset:2048 lds
    v_mfma_f32_16x16x32_bf16 v[36:39], v[180:183], v[128:131], v[36:39]
    s_waitcnt lgkmcnt(8)
    ds_read_b64_tr_b16 v[172:173], v219 offset:57344
    ds_read_b64_tr_b16 v[174:175], v219 offset:57856
    v_mfma_f32_16x16x32_bf16 v[44:47], v[180:183], v[132:135], v[44:47]
    v_mfma_f32_16x16x32_bf16 v[48:51], v[184:187], v[128:131], v[48:51]
    s_waitcnt lgkmcnt(8)
    ds_read_b64_tr_b16 v[176:177], v216 offset:61440
    ds_read_b64_tr_b16 v[178:179], v216 offset:61952
    v_mfma_f32_16x16x32_bf16 v[56:59], v[184:187], v[132:135], v[56:59]
    v_add_u32 v216, 65536, v216
    v_mfma_f32_16x16x32_bf16 v[52:55], v[188:191], v[128:131], v[52:55]
    s_waitcnt lgkmcnt(8)
    ds_read_b64_tr_b16 v[180:181], v217 offset:61440
    ds_read_b64_tr_b16 v[182:183], v217 offset:61952
    v_mfma_f32_16x16x32_bf16 v[60:63], v[188:191], v[132:135], v[60:63]
    v_add_u32 v217, 65536, v217
    v_mfma_f32_16x16x32_bf16 v[64:67], v[160:163], v[128:131], v[64:67]
    s_waitcnt lgkmcnt(8)
    ds_read_b64_tr_b16 v[184:185], v218 offset:61440
    ds_read_b64_tr_b16 v[186:187], v218 offset:61952
    v_mfma_f32_16x16x32_bf16 v[72:75], v[160:163], v[132:135], v[72:75]
    buffer_load_dwordx4 v195, s[16:19], s38 offen offset:3072 lds
    v_add_u32 v218, 65536, v218
    v_mfma_f32_16x16x32_bf16 v[68:71], v[164:167], v[128:131], v[68:71]
    s_waitcnt lgkmcnt(8)
    ds_read_b64_tr_b16 v[188:189], v219 offset:61440
    ds_read_b64_tr_b16 v[190:191], v219 offset:61952
    v_mfma_f32_16x16x32_bf16 v[76:79], v[164:167], v[132:135], v[76:79]
    s_waitcnt vmcnt(16)
    s_barrier
    v_add_u32 v219, 65536, v219
    v_mfma_f32_16x16x32_bf16 v[80:83], v[168:171], v[128:131], v[80:83]
    s_waitcnt lgkmcnt(8)
    ds_read_b64_tr_b16 v[160:161], v216 offset:0
    ds_read_b64_tr_b16 v[162:163], v216 offset:512
    v_mfma_f32_16x16x32_bf16 v[88:91], v[168:171], v[132:135], v[88:91]
    s_add_u32 m0, s36, 32768
    s_add_u32 s38, s94, 512
    v_mfma_f32_16x16x32_bf16 v[84:87], v[172:175], v[128:131], v[84:87]
    s_waitcnt lgkmcnt(8)
    ds_read_b64_tr_b16 v[164:165], v217 offset:0
    ds_read_b64_tr_b16 v[166:167], v217 offset:512
    v_mfma_f32_16x16x32_bf16 v[92:95], v[172:175], v[132:135], v[92:95]
    s_sub_u32 s100, s38, 896
    s_min_u32 s38, s38, s100
    v_mfma_f32_16x16x32_bf16 v[96:99], v[176:179], v[128:131], v[96:99]
    s_waitcnt lgkmcnt(8)
    ds_read_b64_tr_b16 v[168:169], v218 offset:0
    ds_read_b64_tr_b16 v[170:171], v218 offset:512
    v_mfma_f32_16x16x32_bf16 v[104:107], v[176:179], v[132:135], v[104:107]
    buffer_load_dwordx4 v196, s[24:27], s38 offen offset:0 lds
    v_mfma_f32_16x16x32_bf16 v[100:103], v[180:183], v[128:131], v[100:103]
    s_waitcnt lgkmcnt(8)
    ds_read_b64_tr_b16 v[172:173], v219 offset:0
    ds_read_b64_tr_b16 v[174:175], v219 offset:512
    v_mfma_f32_16x16x32_bf16 v[108:111], v[180:183], v[132:135], v[108:111]
    buffer_load_dwordx4 v197, s[24:27], s38 offen offset:1024 lds
    v_mfma_f32_16x16x32_bf16 v[112:115], v[184:187], v[128:131], v[112:115]
    s_waitcnt lgkmcnt(8)
    ds_read_b64_tr_b16 v[176:177], v216 offset:4096
    ds_read_b64_tr_b16 v[178:179], v216 offset:4608
    v_mfma_f32_16x16x32_bf16 v[120:123], v[184:187], v[132:135], v[120:123]
    buffer_load_dwordx4 v198, s[24:27], s38 offen offset:2048 lds
    v_mfma_f32_16x16x32_bf16 v[116:119], v[188:191], v[128:131], v[116:119]
    s_waitcnt lgkmcnt(8)
    ds_read_b64_tr_b16 v[180:181], v217 offset:4096
    ds_read_b64_tr_b16 v[182:183], v217 offset:4608
    v_mfma_f32_16x16x32_bf16 v[124:127], v[188:191], v[132:135], v[124:127]
    buffer_load_dwordx4 v199, s[24:27], s38 offen offset:3072 lds
    v_mfma_f32_16x16x32_bf16 v[0:3], v[160:163], v[136:139], v[0:3]
    s_waitcnt lgkmcnt(8)
    ds_read_b64_tr_b16 v[184:185], v218 offset:4096
    ds_read_b64_tr_b16 v[186:187], v218 offset:4608
    v_mfma_f32_16x16x32_bf16 v[8:11], v[160:163], v[140:143], v[8:11]
    s_add_u32 m0, s36, 49152
    v_mfma_f32_16x16x32_bf16 v[4:7], v[164:167], v[136:139], v[4:7]
    s_waitcnt lgkmcnt(8)
    ds_read_b64_tr_b16 v[188:189], v219 offset:4096
    ds_read_b64_tr_b16 v[190:191], v219 offset:4608
    v_mfma_f32_16x16x32_bf16 v[12:15], v[164:167], v[140:143], v[12:15]
    s_add_u32 s38, s95, 2097152
    v_mfma_f32_16x16x32_bf16 v[16:19], v[168:171], v[136:139], v[16:19]
    s_waitcnt lgkmcnt(8)
    ds_read_b64_tr_b16 v[160:161], v216 offset:8192
    ds_read_b64_tr_b16 v[162:163], v216 offset:8704
    v_mfma_f32_16x16x32_bf16 v[24:27], v[168:171], v[140:143], v[24:27]
    s_sub_u32 s100, s38, 3670016
    v_mfma_f32_16x16x32_bf16 v[20:23], v[172:175], v[136:139], v[20:23]
    s_waitcnt lgkmcnt(8)
    ds_read_b64_tr_b16 v[164:165], v217 offset:8192
    ds_read_b64_tr_b16 v[166:167], v217 offset:8704
    v_mfma_f32_16x16x32_bf16 v[28:31], v[172:175], v[140:143], v[28:31]
    s_min_u32 s38, s38, s100
    v_mfma_f32_16x16x32_bf16 v[32:35], v[176:179], v[136:139], v[32:35]
    s_waitcnt lgkmcnt(8)
    ds_read_b64_tr_b16 v[168:169], v218 offset:8192
    ds_read_b64_tr_b16 v[170:171], v218 offset:8704
    v_mfma_f32_16x16x32_bf16 v[40:43], v[176:179], v[140:143], v[40:43]
    buffer_load_dwordx4 v192, s[16:19], s38 offen offset:0 lds
    v_mfma_f32_16x16x32_bf16 v[36:39], v[180:183], v[136:139], v[36:39]
    s_waitcnt lgkmcnt(8)
    ds_read_b64_tr_b16 v[172:173], v219 offset:8192
    ds_read_b64_tr_b16 v[174:175], v219 offset:8704
    v_mfma_f32_16x16x32_bf16 v[44:47], v[180:183], v[140:143], v[44:47]
    buffer_load_dwordx4 v193, s[16:19], s38 offen offset:1024 lds
    v_mfma_f32_16x16x32_bf16 v[48:51], v[184:187], v[136:139], v[48:51]
    s_waitcnt lgkmcnt(8)
    ds_read_b64_tr_b16 v[176:177], v216 offset:12288
    ds_read_b64_tr_b16 v[178:179], v216 offset:12800
    v_mfma_f32_16x16x32_bf16 v[56:59], v[184:187], v[140:143], v[56:59]
    s_mov_b32 s56, 0
    s_mov_b32 s57, 0
    s_mov_b32 s74, 0
    s_mov_b32 s41, 147456
    buffer_load_dwordx4 a[144:147], v200, s[8:11], s41 offen offset:0 nt
    v_add_u32 v216, 4294836224, v216
    v_mfma_f32_16x16x32_bf16 v[52:55], v[188:191], v[136:139], v[52:55]
    s_waitcnt lgkmcnt(8)
    ds_read_b64_tr_b16 v[180:181], v217 offset:12288
    ds_read_b64_tr_b16 v[182:183], v217 offset:12800
    v_mfma_f32_16x16x32_bf16 v[60:63], v[188:191], v[140:143], v[60:63]
    s_load_dword s56, s[72:73], 0
    s_load_dword s57, s[72:73], 8192
    buffer_load_dwordx4 v194, s[16:19], s38 offen offset:2048 lds
    v_add_u32 v217, 4294836224, v217
    v_mfma_f32_16x16x32_bf16 v[64:67], v[160:163], v[136:139], v[64:67]
    s_waitcnt lgkmcnt(8)
    ds_read_b64_tr_b16 v[184:185], v218 offset:12288
    ds_read_b64_tr_b16 v[186:187], v218 offset:12800
    v_mfma_f32_16x16x32_bf16 v[72:75], v[160:163], v[140:143], v[72:75]
    s_mov_b32 s41, 147456
    buffer_load_dwordx4 a[148:151], v201, s[8:11], s41 offen offset:1024 nt
    v_add_u32 v218, 4294836224, v218
    v_mfma_f32_16x16x32_bf16 v[68:71], v[164:167], v[136:139], v[68:71]
    s_waitcnt lgkmcnt(8)
    ds_read_b64_tr_b16 v[188:189], v219 offset:12288
    ds_read_b64_tr_b16 v[190:191], v219 offset:12800
    v_mfma_f32_16x16x32_bf16 v[76:79], v[164:167], v[140:143], v[76:79]
    buffer_load_dwordx4 v195, s[16:19], s38 offen offset:3072 lds
    s_waitcnt vmcnt(18)
    s_barrier
    ds_read_b128 v[144:147], v240 offset:16384
    v_add_u32 v219, 4294836224, v219
    v_mfma_f32_16x16x32_bf16 v[80:83], v[168:171], v[136:139], v[80:83]
    s_waitcnt lgkmcnt(9)
    ds_read_b64_tr_b16 v[160:161], v216 offset:0
    ds_read_b64_tr_b16 v[162:163], v216 offset:512
    v_mfma_f32_16x16x32_bf16 v[88:91], v[168:171], v[140:143], v[88:91]
    s_or_b32 s6, s56, s57
    s_cmp_eq_u32 s74, 0
    s_cselect_b32 s74, s6, s74
    s_add_u32 m0, s36, 65536
    ds_read_b128 v[148:151], v240 offset:18432
    s_mov_b32 s41, 147456
    buffer_load_dwordx4 a[152:155], v202, s[8:11], s41 offen offset:2048 nt
    v_add_u32 v240, 4294836224, v240
    v_mfma_f32_16x16x32_bf16 v[84:87], v[172:175], v[136:139], v[84:87]
    s_waitcnt lgkmcnt(10)
    ds_read_b64_tr_b16 v[164:165], v217 offset:0
    ds_read_b64_tr_b16 v[166:167], v217 offset:512
    v_mfma_f32_16x16x32_bf16 v[92:95], v[172:175], v[140:143], v[92:95]
    s_or_b32 s6, s56, s57
    s_cmp_eq_u32 s74, 0
    s_cselect_b32 s74, s6, s74
    s_add_u32 s38, s95, 2359296
    ds_read_b128 v[152:155], v241 offset:16384
    v_mfma_f32_16x16x32_bf16 v[96:99], v[176:179], v[136:139], v[96:99]
    s_waitcnt lgkmcnt(11)
    ds_read_b64_tr_b16 v[168:169], v218 offset:0
    ds_read_b64_tr_b16 v[170:171], v218 offset:512
    v_mfma_f32_16x16x32_bf16 v[104:107], v[176:179], v[140:143], v[104:107]
    s_or_b32 s6, s56, s57
    s_cmp_eq_u32 s74, 0
    s_cselect_b32 s74, s6, s74
    s_sub_u32 s100, s38, 3670016
    ds_read_b128 v[156:159], v241 offset:18432
    s_mov_b32 s41, 147456
    buffer_load_dwordx4 a[156:159], v203, s[8:11], s41 offen offset:3072 nt
    v_add_u32 v241, 4294836224, v241
    v_mfma_f32_16x16x32_bf16 v[100:103], v[180:183], v[136:139], v[100:103]
    s_waitcnt lgkmcnt(12)
    ds_read_b64_tr_b16 v[172:173], v219 offset:0
    ds_read_b64_tr_b16 v[174:175], v219 offset:512
    v_mfma_f32_16x16x32_bf16 v[108:111], v[180:183], v[140:143], v[108:111]
    s_or_b32 s6, s56, s57
    s_cmp_eq_u32 s74, 0
    s_cselect_b32 s74, s6, s74
    s_min_u32 s38, s38, s100
    v_mfma_f32_16x16x32_bf16 v[112:115], v[184:187], v[136:139], v[112:115]
    s_waitcnt lgkmcnt(12)
    ds_read_b64_tr_b16 v[176:177], v216 offset:4096
    ds_read_b64_tr_b16 v[178:179], v216 offset:4608
    v_mfma_f32_16x16x32_bf16 v[120:123], v[184:187], v[140:143], v[120:123]
    s_or_b32 s6, s56, s57
    s_cmp_eq_u32 s74, 0
    s_cselect_b32 s74, s6, s74
    buffer_load_dwordx4 v192, s[16:19], s38 offen offset:0 lds
    v_mfma_f32_16x16x32_bf16 v[116:119], v[188:191], v[136:139], v[116:119]
    s_waitcnt lgkmcnt(10)
    ds_read_b64_tr_b16 v[180:181], v217 offset:4096
    ds_read_b64_tr_b16 v[182:183], v217 offset:4608
    v_mfma_f32_16x16x32_bf16 v[124:127], v[188:191], v[140:143], v[124:127]
    s_or_b32 s6, s56, s57
    s_cmp_eq_u32 s74, 0
    s_cselect_b32 s74, s6, s74
    v_mfma_f32_16x16x32_bf16 v[0:3], v[160:163], v[144:147], v[0:3]
    s_waitcnt lgkmcnt(10)
    ds_read_b64_tr_b16 v[184:185], v218 offset:4096
    ds_read_b64_tr_b16 v[186:187], v218 offset:4608
    v_mfma_f32_16x16x32_bf16 v[8:11], v[160:163], v[148:151], v[8:11]
    s_or_b32 s6, s56, s57
    s_cmp_eq_u32 s74, 0
    s_cselect_b32 s74, s6, s74
    v_mfma_f32_16x16x32_bf16 v[4:7], v[164:167], v[144:147], v[4:7]
    s_waitcnt lgkmcnt(9)
    ds_read_b64_tr_b16 v[188:189], v219 offset:4096
    ds_read_b64_tr_b16 v[190:191], v219 offset:4608
    v_mfma_f32_16x16x32_bf16 v[12:15], v[164:167], v[148:151], v[12:15]
    s_or_b32 s6, s56, s57
    s_cmp_eq_u32 s74, 0
    s_cselect_b32 s74, s6, s74
    buffer_load_dwordx4 v193, s[16:19], s38 offen offset:1024 lds
    v_mfma_f32_16x16x32_bf16 v[16:19], v[168:171], v[144:147], v[16:19]
    s_waitcnt lgkmcnt(8)
    ds_read_b64_tr_b16 v[160:161], v216 offset:8192
    ds_read_b64_tr_b16 v[162:163], v216 offset:8704
    v_mfma_f32_16x16x32_bf16 v[24:27], v[168:171], v[148:151], v[24:27]
    s_or_b32 s6, s56, s57
    s_cmp_eq_u32 s74, 0
    s_cselect_b32 s74, s6, s74
    v_mfma_f32_16x16x32_bf16 v[20:23], v[172:175], v[144:147], v[20:23]
    s_waitcnt lgkmcnt(8)
    ds_read_b64_tr_b16 v[164:165], v217 offset:8192
    ds_read_b64_tr_b16 v[166:167], v217 offset:8704
    v_mfma_f32_16x16x32_bf16 v[28:31], v[172:175], v[148:151], v[28:31]
    s_or_b32 s6, s56, s57
    s_cmp_eq_u32 s74, 0
    s_cselect_b32 s74, s6, s74
    v_mfma_f32_16x16x32_bf16 v[32:35], v[176:179], v[144:147], v[32:35]
    s_waitcnt lgkmcnt(8)
    ds_read_b64_tr_b16 v[168:169], v218 offset:8192
    ds_read_b64_tr_b16 v[170:171], v218 offset:8704
    v_mfma_f32_16x16x32_bf16 v[40:43], v[176:179], v[148:151], v[40:43]
    s_or_b32 s6, s56, s57
    s_cmp_eq_u32 s74, 0
    s_cselect_b32 s74, s6, s74
    buffer_load_dwordx4 v194, s[16:19], s38 offen offset:2048 lds
    v_mfma_f32_16x16x32_bf16 v[36:39], v[180:183], v[144:147], v[36:39]
    s_waitcnt lgkmcnt(8)
    ds_read_b64_tr_b16 v[172:173], v219 offset:8192
    ds_read_b64_tr_b16 v[174:175], v219 offset:8704
    v_mfma_f32_16x16x32_bf16 v[44:47], v[180:183], v[148:151], v[44:47]
    s_or_b32 s6, s56, s57
    s_cmp_eq_u32 s74, 0
    s_cselect_b32 s74, s6, s74
    v_mfma_f32_16x16x32_bf16 v[48:51], v[184:187], v[144:147], v[48:51]
    s_waitcnt lgkmcnt(8)
    ds_read_b64_tr_b16 v[176:177], v216 offset:12288
    ds_read_b64_tr_b16 v[178:179], v216 offset:12800
    v_mfma_f32_16x16x32_bf16 v[56:59], v[184:187], v[148:151], v[56:59]
    s_or_b32 s6, s56, s57
    s_cmp_eq_u32 s74, 0
    s_cselect_b32 s74, s6, s74
    v_mfma_f32_16x16x32_bf16 v[52:55], v[188:191], v[144:147], v[52:55]
    s_waitcnt lgkmcnt(8)
    ds_read_b64_tr_b16 v[180:181], v217 offset:12288
    ds_read_b64_tr_b16 v[182:183], v217 offset:12800
    v_mfma_f32_16x16x32_bf16 v[60:63], v[188:191], v[148:151], v[60:63]
    s_or_b32 s6, s56, s57
    s_cmp_eq_u32 s74, 0
    s_cselect_b32 s74, s6, s74
    buffer_load_dwordx4 v195, s[16:19], s38 offen offset:3072 lds
    v_mfma_f32_16x16x32_bf16 v[64:67], v[160:163], v[144:147], v[64:67]
    s_waitcnt lgkmcnt(8)
    ds_read_b64_tr_b16 v[184:185], v218 offset:12288
    ds_read_b64_tr_b16 v[186:187], v218 offset:12800
    v_mfma_f32_16x16x32_bf16 v[72:75], v[160:163], v[148:151], v[72:75]
    s_or_b32 s6, s56, s57
    s_cmp_eq_u32 s74, 0
    s_cselect_b32 s74, s6, s74
    v_mfma_f32_16x16x32_bf16 v[68:71], v[164:167], v[144:147], v[68:71]
    s_waitcnt lgkmcnt(8)
    ds_read_b64_tr_b16 v[188:189], v219 offset:12288
    ds_read_b64_tr_b16 v[190:191], v219 offset:12800
    v_mfma_f32_16x16x32_bf16 v[76:79], v[164:167], v[148:151], v[76:79]
    s_or_b32 s6, s56, s57
    s_cmp_eq_u32 s74, 0
    s_cselect_b32 s74, s6, s74
    s_waitcnt vmcnt(16)
    s_barrier
    v_mfma_f32_16x16x32_bf16 v[80:83], v[168:171], v[144:147], v[80:83]
    s_waitcnt lgkmcnt(8)
    ds_read_b64_tr_b16 v[160:161], v216 offset:16384
    ds_read_b64_tr_b16 v[162:163], v216 offset:16896
    v_mfma_f32_16x16x32_bf16 v[88:91], v[168:171], v[148:151], v[88:91]
    s_or_b32 s6, s56, s57
    s_cmp_eq_u32 s74, 0
    s_cselect_b32 s74, s6, s74
    s_add_u32 m0, s36, 81920
    s_add_u32 s38, s94, 640
    v_mfma_f32_16x16x32_bf16 v[84:87], v[172:175], v[144:147], v[84:87]
    s_waitcnt lgkmcnt(8)
    ds_read_b64_tr_b16 v[164:165], v217 offset:16384
    ds_read_b64_tr_b16 v[166:167], v217 offset:16896
    v_mfma_f32_16x16x32_bf16 v[92:95], v[172:175], v[148:151], v[92:95]
    s_or_b32 s6, s56, s57
    s_cmp_eq_u32 s74, 0
    s_cselect_b32 s74, s6, s74
    s_sub_u32 s100, s38, 896
    s_min_u32 s38, s38, s100
    v_mfma_f32_16x16x32_bf16 v[96:99], v[176:179], v[144:147], v[96:99]
    s_waitcnt lgkmcnt(8)
    ds_read_b64_tr_b16 v[168:169], v218 offset:16384
    ds_read_b64_tr_b16 v[170:171], v218 offset:16896
    v_mfma_f32_16x16x32_bf16 v[104:107], v[176:179], v[148:151], v[104:107]
    s_cmp_eq_u32 s74, 1
    s_addc_u32 s75, s75, 0
    s_cmp_eq_u32 s74, 2
    s_subb_u32 s75, s75, 0
    buffer_load_dwordx4 v196, s[24:27], s38 offen offset:0 lds
    v_mfma_f32_16x16x32_bf16 v[100:103], v[180:183], v[144:147], v[100:103]
    s_waitcnt lgkmcnt(8)
    ds_read_b64_tr_b16 v[172:173], v219 offset:16384
    ds_read_b64_tr_b16 v[174:175], v219 offset:16896
    v_mfma_f32_16x16x32_bf16 v[108:111], v[180:183], v[148:151], v[108:111]
    buffer_load_dwordx4 v197, s[24:27], s38 offen offset:1024 lds
    v_mfma_f32_16x16x32_bf16 v[112:115], v[184:187], v[144:147], v[112:115]
    s_waitcnt lgkmcnt(8)
    ds_read_b64_tr_b16 v[176:177], v216 offset:20480
    ds_read_b64_tr_b16 v[178:179], v216 offset:20992
    v_mfma_f32_16x16x32_bf16 v[120:123], v[184:187], v[148:151], v[120:123]
    buffer_load_dwordx4 v198, s[24:27], s38 offen offset:2048 lds
    v_mfma_f32_16x16x32_bf16 v[116:119], v[188:191], v[144:147], v[116:119]
    s_waitcnt lgkmcnt(8)
    ds_read_b64_tr_b16 v[180:181], v217 offset:20480
    ds_read_b64_tr_b16 v[182:183], v217 offset:20992
    v_mfma_f32_16x16x32_bf16 v[124:127], v[188:191], v[148:151], v[124:127]
    buffer_load_dwordx4 v199, s[24:27], s38 offen offset:3072 lds
    v_mfma_f32_16x16x32_bf16 v[0:3], v[160:163], v[152:155], v[0:3]
    s_waitcnt lgkmcnt(8)
    ds_read_b64_tr_b16 v[184:185], v218 offset:20480
    ds_read_b64_tr_b16 v[186:187], v218 offset:20992
    v_mfma_f32_16x16x32_bf16 v[8:11], v[160:163], v[156:159], v[8:11]
    s_add_u32 m0, s36, 98304
    v_mfma_f32_16x16x32_bf16 v[4:7], v[164:167], v[152:155], v[4:7]
    s_waitcnt lgkmcnt(8)
    ds_read_b64_tr_b16 v[188:189], v219 offset:20480
    ds_read_b64_tr_b16 v[190:191], v219 offset:20992
    v_mfma_f32_16x16x32_bf16 v[12:15], v[164:167], v[156:159], v[12:15]
    s_add_u32 s38, s95, 2621440
    v_mfma_f32_16x16x32_bf16 v[16:19], v[168:171], v[152:155], v[16:19]
    s_waitcnt lgkmcnt(8)
    ds_read_b64_tr_b16 v[160:161], v216 offset:24576
    ds_read_b64_tr_b16 v[162:163], v216 offset:25088
    v_mfma_f32_16x16x32_bf16 v[24:27], v[168:171], v[156:159], v[24:27]
    s_sub_u32 s100, s38, 3670016
    v_mfma_f32_16x16x32_bf16 v[20:23], v[172:175], v[152:155], v[20:23]
    s_waitcnt lgkmcnt(8)
    ds_read_b64_tr_b16 v[164:165], v217 offset:24576
    ds_read_b64_tr_b16 v[166:167], v217 offset:25088
    v_mfma_f32_16x16x32_bf16 v[28:31], v[172:175], v[156:159], v[28:31]
    s_min_u32 s38, s38, s100
    v_mfma_f32_16x16x32_bf16 v[32:35], v[176:179], v[152:155], v[32:35]
    s_waitcnt lgkmcnt(8)
    ds_read_b64_tr_b16 v[168:169], v218 offset:24576
    ds_read_b64_tr_b16 v[170:171], v218 offset:25088
    v_mfma_f32_16x16x32_bf16 v[40:43], v[176:179], v[156:159], v[40:43]
    buffer_load_dwordx4 v192, s[16:19], s38 offen offset:0 lds
    v_mfma_f32_16x16x32_bf16 v[36:39], v[180:183], v[152:155], v[36:39]
    s_waitcnt lgkmcnt(8)
    ds_read_b64_tr_b16 v[172:173], v219 offset:24576
    ds_read_b64_tr_b16 v[174:175], v219 offset:25088
    v_mfma_f32_16x16x32_bf16 v[44:47], v[180:183], v[156:159], v[44:47]
    buffer_load_dwordx4 v193, s[16:19], s38 offen offset:1024 lds
    v_mfma_f32_16x16x32_bf16 v[48:51], v[184:187], v[152:155], v[48:51]
    s_waitcnt lgkmcnt(8)
    ds_read_b64_tr_b16 v[176:177], v216 offset:28672
    ds_read_b64_tr_b16 v[178:179], v216 offset:29184
    v_mfma_f32_16x16x32_bf16 v[56:59], v[184:187], v[156:159], v[56:59]
    s_mov_b32 s58, 0
    s_mov_b32 s59, 0
    s_mov_b32 s74, 0
    buffer_load_dwordx4 v194, s[16:19], s38 offen offset:2048 lds
    v_mfma_f32_16x16x32_bf16 v[52:55], v[188:191], v[152:155], v[52:55]
    s_waitcnt lgkmcnt(8)
    ds_read_b64_tr_b16 v[180:181], v217 offset:28672
    ds_read_b64_tr_b16 v[182:183], v217 offset:29184
    v_mfma_f32_16x16x32_bf16 v[60:63], v[188:191], v[156:159], v[60:63]
    s_load_dword s59, s[72:73], 12416
    s_load_dword s58, s[72:73], 4224
    v_mfma_f32_16x16x32_bf16 v[64:67], v[160:163], v[152:155], v[64:67]
    s_waitcnt lgkmcnt(8)
    ds_read_b64_tr_b16 v[184:185], v218 offset:28672
    ds_read_b64_tr_b16 v[186:187], v218 offset:29184
    v_mfma_f32_16x16x32_bf16 v[72:75], v[160:163], v[156:159], v[72:75]
    buffer_load_dwordx4 v195, s[16:19], s38 offen offset:3072 lds
    v_mfma_f32_16x16x32_bf16 v[68:71], v[164:167], v[152:155], v[68:71]
    s_waitcnt lgkmcnt(8)
    ds_read_b64_tr_b16 v[188:189], v219 offset:28672
    ds_read_b64_tr_b16 v[190:191], v219 offset:29184
    v_mfma_f32_16x16x32_bf16 v[76:79], v[164:167], v[156:159], v[76:79]
    s_waitcnt vmcnt(14)
    s_barrier
    ds_read_b128 v[128:131], v240 offset:32768
    v_mfma_f32_16x16x32_bf16 v[80:83], v[168:171], v[152:155], v[80:83]
    s_waitcnt lgkmcnt(9)
    ds_read_b64_tr_b16 v[160:161], v216 offset:49152
    ds_read_b64_tr_b16 v[162:163], v216 offset:49664
    v_mfma_f32_16x16x32_bf16 v[88:91], v[168:171], v[156:159], v[88:91]
    s_or_b32 s6, s58, s59
    s_cmp_eq_u32 s74, 0
    s_cselect_b32 s74, s6, s74
    s_add_u32 m0, s36, 114688
    ds_read_b128 v[132:135], v240 offset:34816
    v_add_u32 v240, 65536, v240
    v_mfma_f32_16x16x32_bf16 v[84:87], v[172:175], v[152:155], v[84:87]
    s_waitcnt lgkmcnt(10)
    ds_read_b64_tr_b16 v[164:165], v217 offset:49152
    ds_read_b64_tr_b16 v[166:167], v217 offset:49664
    v_mfma_f32_16x16x32_bf16 v[92:95], v[172:175], v[156:159], v[92:95]
    s_or_b32 s6, s58, s59
    s_cmp_eq_u32 s74, 0
    s_cselect_b32 s74, s6, s74
    s_add_u32 s38, s95, 2883584
    ds_read_b128 v[136:139], v241 offset:32768
    v_mfma_f32_16x16x32_bf16 v[96:99], v[176:179], v[152:155], v[96:99]
    s_waitcnt lgkmcnt(11)
    ds_read_b64_tr_b16 v[168:169], v218 offset:49152
    ds_read_b64_tr_b16 v[170:171], v218 offset:49664
    v_mfma_f32_16x16x32_bf16 v[104:107], v[176:179], v[156:159], v[104:107]
    s_or_b32 s6, s58, s59
    s_cmp_eq_u32 s74, 0
    s_cselect_b32 s74, s6, s74
    s_sub_u32 s100, s38, 3670016
    ds_read_b128 v[140:143], v241 offset:34816
    v_add_u32 v241, 65536, v241
    v_mfma_f32_16x16x32_bf16 v[100:103], v[180:183], v[152:155], v[100:103]
    s_waitcnt lgkmcnt(12)
    ds_read_b64_tr_b16 v[172:173], v219 offset:49152
    ds_read_b64_tr_b16 v[174:175], v219 offset:49664
    v_mfma_f32_16x16x32_bf16 v[108:111], v[180:183], v[156:159], v[108:111]
    s_or_b32 s6, s58, s59
    s_cmp_eq_u32 s74, 0
    s_cselect_b32 s74, s6, s74
    s_min_u32 s38, s38, s100
    v_mfma_f32_16x16x32_bf16 v[112:115], v[184:187], v[152:155], v[112:115]
    s_waitcnt lgkmcnt(12)
    ds_read_b64_tr_b16 v[176:177], v216 offset:53248
    ds_read_b64_tr_b16 v[178:179], v216 offset:53760
    v_mfma_f32_16x16x32_bf16 v[120:123], v[184:187], v[156:159], v[120:123]
    s_or_b32 s6, s58, s59
    s_cmp_eq_u32 s74, 0
    s_cselect_b32 s74, s6, s74
    buffer_load_dwordx4 v192, s[16:19], s38 offen offset:0 lds
    v_mfma_f32_16x16x32_bf16 v[116:119], v[188:191], v[152:155], v[116:119]
    s_waitcnt lgkmcnt(10)
    ds_read_b64_tr_b16 v[180:181], v217 offset:53248
    ds_read_b64_tr_b16 v[182:183], v217 offset:53760
    v_mfma_f32_16x16x32_bf16 v[124:127], v[188:191], v[156:159], v[124:127]
    s_or_b32 s6, s58, s59
    s_cmp_eq_u32 s74, 0
    s_cselect_b32 s74, s6, s74
    v_mfma_f32_16x16x32_bf16 v[0:3], v[160:163], v[128:131], v[0:3]
    s_waitcnt lgkmcnt(10)
    ds_read_b64_tr_b16 v[184:185], v218 offset:53248
    ds_read_b64_tr_b16 v[186:187], v218 offset:53760
    v_mfma_f32_16x16x32_bf16 v[8:11], v[160:163], v[132:135], v[8:11]
    s_or_b32 s6, s58, s59
    s_cmp_eq_u32 s74, 0
    s_cselect_b32 s74, s6, s74
    v_mfma_f32_16x16x32_bf16 v[4:7], v[164:167], v[128:131], v[4:7]
    s_waitcnt lgkmcnt(9)
    ds_read_b64_tr_b16 v[188:189], v219 offset:53248
    ds_read_b64_tr_b16 v[190:191], v219 offset:53760
    v_mfma_f32_16x16x32_bf16 v[12:15], v[164:167], v[132:135], v[12:15]
    s_or_b32 s6, s58, s59
    s_cmp_eq_u32 s74, 0
    s_cselect_b32 s74, s6, s74
    buffer_load_dwordx4 v193, s[16:19], s38 offen offset:1024 lds
    v_mfma_f32_16x16x32_bf16 v[16:19], v[168:171], v[128:131], v[16:19]
    s_waitcnt lgkmcnt(8)
    ds_read_b64_tr_b16 v[160:161], v216 offset:57344
    ds_read_b64_tr_b16 v[162:163], v216 offset:57856
    v_mfma_f32_16x16x32_bf16 v[24:27], v[168:171], v[132:135], v[24:27]
    s_or_b32 s6, s58, s59
    s_cmp_eq_u32 s74, 0
    s_cselect_b32 s74, s6, s74
    v_mfma_f32_16x16x32_bf16 v[20:23], v[172:175], v[128:131], v[20:23]
    s_waitcnt lgkmcnt(8)
    ds_read_b64_tr_b16 v[164:165], v217 offset:57344
    ds_read_b64_tr_b16 v[166:167], v217 offset:57856
    v_mfma_f32_16x16x32_bf16 v[28:31], v[172:175], v[132:135], v[28:31]
    s_or_b32 s6, s58, s59
    s_cmp_eq_u32 s74, 0
    s_cselect_b32 s74, s6, s74
    v_mfma_f32_16x16x32_bf16 v[32:35], v[176:179], v[128:131], v[32:35]
    s_waitcnt lgkmcnt(8)
    ds_read_b64_tr_b16 v[168:169], v218 offset:57344
    ds_read_b64_tr_b16 v[170:171], v218 offset:57856
    v_mfma_f32_16x16x32_bf16 v[40:43], v[176:179], v[132:135], v[40:43]
    s_or_b32 s6, s58, s59
    s_cmp_eq_u32 s74, 0
    s_cselect_b32 s74, s6, s74
    buffer_load_dwordx4 v194, s[16:19], s38 offen offset:2048 lds
    v_mfma_f32_16x16x32_bf16 v[36:39], v[180:183], v[128:131], v[36:39]
    s_waitcnt lgkmcnt(8)
    ds_read_b64_tr_b16 v[172:173], v219 offset:57344
    ds_read_b64_tr_b16 v[174:175], v219 offset:57856
    v_mfma_f32_16x16x32_bf16 v[44:47], v[180:183], v[132:135], v[44:47]
    s_or_b32 s6, s58, s59
    s_cmp_eq_u32 s74, 0
    s_cselect_b32 s74, s6, s74
    v_mfma_f32_16x16x32_bf16 v[48:51], v[184:187], v[128:131], v[48:51]
    s_waitcnt lgkmcnt(8)
    ds_read_b64_tr_b16 v[176:177], v216 offset:61440
    ds_read_b64_tr_b16 v[178:179], v216 offset:61952
    v_mfma_f32_16x16x32_bf16 v[56:59], v[184:187], v[132:135], v[56:59]
    s_or_b32 s6, s58, s59
    s_cmp_eq_u32 s74, 0
    s_cselect_b32 s74, s6, s74
    v_add_u32 v216, 65536, v216
    v_mfma_f32_16x16x32_bf16 v[52:55], v[188:191], v[128:131], v[52:55]
    s_waitcnt lgkmcnt(8)
    ds_read_b64_tr_b16 v[180:181], v217 offset:61440
    ds_read_b64_tr_b16 v[182:183], v217 offset:61952
    v_mfma_f32_16x16x32_bf16 v[60:63], v[188:191], v[132:135], v[60:63]
    s_or_b32 s6, s58, s59
    s_cmp_eq_u32 s74, 0
    s_cselect_b32 s74, s6, s74
    v_add_u32 v217, 65536, v217
    v_mfma_f32_16x16x32_bf16 v[64:67], v[160:163], v[128:131], v[64:67]
    s_waitcnt lgkmcnt(8)
    ds_read_b64_tr_b16 v[184:185], v218 offset:61440
    ds_read_b64_tr_b16 v[186:187], v218 offset:61952
    v_mfma_f32_16x16x32_bf16 v[72:75], v[160:163], v[132:135], v[72:75]
    s_or_b32 s6, s58, s59
    s_cmp_eq_u32 s74, 0
    s_cselect_b32 s74, s6, s74
    buffer_load_dwordx4 v195, s[16:19], s38 offen offset:3072 lds
    v_add_u32 v218, 65536, v218
    v_mfma_f32_16x16x32_bf16 v[68:71], v[164:167], v[128:131], v[68:71]
    s_waitcnt lgkmcnt(8)
    ds_read_b64_tr_b16 v[188:189], v219 offset:61440
    ds_read_b64_tr_b16 v[190:191], v219 offset:61952
    v_mfma_f32_16x16x32_bf16 v[76:79], v[164:167], v[132:135], v[76:79]
    s_or_b32 s6, s58, s59
    s_cmp_eq_u32 s74, 0
    s_cselect_b32 s74, s6, s74
    s_waitcnt vmcnt(12)
    s_barrier
    v_add_u32 v219, 65536, v219
    v_mfma_f32_16x16x32_bf16 v[80:83], v[168:171], v[128:131], v[80:83]
    s_waitcnt lgkmcnt(8)
    ds_read_b64_tr_b16 v[160:161], v216 offset:0
    ds_read_b64_tr_b16 v[162:163], v216 offset:512
    v_mfma_f32_16x16x32_bf16 v[88:91], v[168:171], v[132:135], v[88:91]
    s_or_b32 s6, s58, s59
    s_cmp_eq_u32 s74, 0
    s_cselect_b32 s74, s6, s74
    s_add_u32 m0, s36, 131072
    s_add_u32 s38, s94, 768
    s_mov_b32 s41, 229376
    buffer_load_dwordx4 a[224:227], v200, s[8:11], s41 offen offset:0 nt
    v_mfma_f32_16x16x32_bf16 v[84:87], v[172:175], v[128:131], v[84:87]
    s_waitcnt lgkmcnt(8)
    ds_read_b64_tr_b16 v[164:165], v217 offset:0
    ds_read_b64_tr_b16 v[166:167], v217 offset:512
    v_mfma_f32_16x16x32_bf16 v[92:95], v[172:175], v[132:135], v[92:95]
    s_or_b32 s6, s58, s59
    s_cmp_eq_u32 s74, 0
    s_cselect_b32 s74, s6, s74
    s_sub_u32 s100, s38, 896
    s_min_u32 s38, s38, s100
    v_mfma_f32_16x16x32_bf16 v[96:99], v[176:179], v[128:131], v[96:99]
    s_waitcnt lgkmcnt(8)
    ds_read_b64_tr_b16 v[168:169], v218 offset:0
    ds_read_b64_tr_b16 v[170:171], v218 offset:512
    v_mfma_f32_16x16x32_bf16 v[104:107], v[176:179], v[132:135], v[104:107]
    s_cmp_eq_u32 s74, 1
    s_addc_u32 s75, s75, 0
    s_cmp_eq_u32 s74, 2
    s_subb_u32 s75, s75, 0
    s_mov_b32 s41, 229376
    buffer_load_dwordx4 a[228:231], v201, s[8:11], s41 offen offset:1024 nt
    v_mfma_f32_16x16x32_bf16 v[100:103], v[180:183], v[128:131], v[100:103]
    s_waitcnt lgkmcnt(8)
    ds_read_b64_tr_b16 v[172:173], v219 offset:0
    ds_read_b64_tr_b16 v[174:175], v219 offset:512
    v_mfma_f32_16x16x32_bf16 v[108:111], v[180:183], v[132:135], v[108:111]
    buffer_load_dwordx4 v196, s[24:27], s38 offen offset:0 lds
    v_mfma_f32_16x16x32_bf16 v[112:115], v[184:187], v[128:131], v[112:115]
    s_waitcnt lgkmcnt(8)
    ds_read_b64_tr_b16 v[176:177], v216 offset:4096
    ds_read_b64_tr_b16 v[178:179], v216 offset:4608
    v_mfma_f32_16x16x32_bf16 v[120:123], v[184:187], v[132:135], v[120:123]
    s_mov_b32 s41, 229376
    buffer_load_dwordx4 a[232:235], v202, s[8:11], s41 offen offset:2048 nt
    v_mfma_f32_16x16x32_bf16 v[116:119], v[188:191], v[128:131], v[116:119]
    s_waitcnt lgkmcnt(8)
    ds_read_b64_tr_b16 v[180:181], v217 offset:4096
    ds_read_b64_tr_b16 v[182:183], v217 offset:4608
    v_mfma_f32_16x16x32_bf16 v[124:127], v[188:191], v[132:135], v[124:127]
    buffer_load_dwordx4 v197, s[24:27], s38 offen offset:1024 lds
    v_mfma_f32_16x16x32_bf16 v[0:3], v[160:163], v[136:139], v[0:3]
    s_waitcnt lgkmcnt(8)
    ds_read_b64_tr_b16 v[184:185], v218 offset:4096
    ds_read_b64_tr_b16 v[186:187], v218 offset:4608
    v_mfma_f32_16x16x32_bf16 v[8:11], v[160:163], v[140:143], v[8:11]
    s_mov_b32 s41, 229376
    buffer_load_dwordx4 a[236:239], v203, s[8:11], s41 offen offset:3072 nt
    v_mfma_f32_16x16x32_bf16 v[4:7], v[164:167], v[136:139], v[4:7]
    s_waitcnt lgkmcnt(8)
    ds_read_b64_tr_b16 v[188:189], v219 offset:4096
    ds_read_b64_tr_b16 v[190:191], v219 offset:4608
    v_mfma_f32_16x16x32_bf16 v[12:15], v[164:167], v[140:143], v[12:15]
    buffer_load_dwordx4 v198, s[24:27], s38 offen offset:2048 lds
    v_mfma_f32_16x16x32_bf16 v[16:19], v[168:171], v[136:139], v[16:19]
    s_waitcnt lgkmcnt(8)
    ds_read_b64_tr_b16 v[160:161], v216 offset:8192
    ds_read_b64_tr_b16 v[162:163], v216 offset:8704
    v_mfma_f32_16x16x32_bf16 v[24:27], v[168:171], v[140:143], v[24:27]
    buffer_load_dwordx4 v199, s[24:27], s38 offen offset:3072 lds
    v_mfma_f32_16x16x32_bf16 v[20:23], v[172:175], v[136:139], v[20:23]
    s_waitcnt lgkmcnt(8)
    ds_read_b64_tr_b16 v[164:165], v217 offset:8192
    ds_read_b64_tr_b16 v[166:167], v217 offset:8704
    v_mfma_f32_16x16x32_bf16 v[28:31], v[172:175], v[140:143], v[28:31]
    s_add_u32 m0, s36, 147456
    s_add_u32 s38, s95, 3145728
    s_sub_u32 s100, s38, 3670016
    v_mfma_f32_16x16x32_bf16 v[32:35], v[176:179], v[136:139], v[32:35]
    s_waitcnt lgkmcnt(8)
    ds_read_b64_tr_b16 v[168:169], v218 offset:8192
    ds_read_b64_tr_b16 v[170:171], v218 offset:8704
    v_mfma_f32_16x16x32_bf16 v[40:43], v[176:179], v[140:143], v[40:43]
    s_min_u32 s38, s38, s100
    v_mfma_f32_16x16x32_bf16 v[36:39], v[180:183], v[136:139], v[36:39]
    s_waitcnt lgkmcnt(8)
    ds_read_b64_tr_b16 v[172:173], v219 offset:8192
    ds_read_b64_tr_b16 v[174:175], v219 offset:8704
    v_mfma_f32_16x16x32_bf16 v[44:47], v[180:183], v[140:143], v[44:47]
    buffer_load_dwordx4 v192, s[16:19], s38 offen offset:0 lds
    v_mfma_f32_16x16x32_bf16 v[48:51], v[184:187], v[136:139], v[48:51]
    s_waitcnt lgkmcnt(8)
    ds_read_b64_tr_b16 v[176:177], v216 offset:12288
    ds_read_b64_tr_b16 v[178:179], v216 offset:12800
    v_mfma_f32_16x16x32_bf16 v[56:59], v[184:187], v[140:143], v[56:59]
    buffer_load_dwordx4 v193, s[16:19], s38 offen offset:1024 lds
    v_mfma_f32_16x16x32_bf16 v[52:55], v[188:191], v[136:139], v[52:55]
    s_waitcnt lgkmcnt(8)
    ds_read_b64_tr_b16 v[180:181], v217 offset:12288
    ds_read_b64_tr_b16 v[182:183], v217 offset:12800
    v_mfma_f32_16x16x32_bf16 v[60:63], v[188:191], v[140:143], v[60:63]
    buffer_load_dwordx4 v194, s[16:19], s38 offen offset:2048 lds
    v_mfma_f32_16x16x32_bf16 v[64:67], v[160:163], v[136:139], v[64:67]
    s_waitcnt lgkmcnt(8)
    ds_read_b64_tr_b16 v[184:185], v218 offset:12288
    ds_read_b64_tr_b16 v[186:187], v218 offset:12800
    v_mfma_f32_16x16x32_bf16 v[72:75], v[160:163], v[140:143], v[72:75]
    buffer_load_dwordx4 v195, s[16:19], s38 offen offset:3072 lds
    v_mfma_f32_16x16x32_bf16 v[68:71], v[164:167], v[136:139], v[68:71]
    s_waitcnt lgkmcnt(8)
    ds_read_b64_tr_b16 v[188:189], v219 offset:12288
    ds_read_b64_tr_b16 v[190:191], v219 offset:12800
    v_mfma_f32_16x16x32_bf16 v[76:79], v[164:167], v[140:143], v[76:79]
    s_waitcnt vmcnt(16)
    s_barrier
    ds_read_b128 v[144:147], v240 offset:16384
    v_mfma_f32_16x16x32_bf16 v[80:83], v[168:171], v[136:139], v[80:83]
    s_waitcnt lgkmcnt(9)
    ds_read_b64_tr_b16 v[160:161], v216 offset:32768
    ds_read_b64_tr_b16 v[162:163], v216 offset:33280
    v_mfma_f32_16x16x32_bf16 v[88:91], v[168:171], v[140:143], v[88:91]
    s_add_u32 m0, s36, 0
    ds_read_b128 v[148:151], v240 offset:18432
    v_add_u32 v240, 65536, v240
    v_mfma_f32_16x16x32_bf16 v[84:87], v[172:175], v[136:139], v[84:87]
    s_waitcnt lgkmcnt(10)
    ds_read_b64_tr_b16 v[164:165], v217 offset:32768
    ds_read_b64_tr_b16 v[166:167], v217 offset:33280
    v_mfma_f32_16x16x32_bf16 v[92:95], v[172:175], v[140:143], v[92:95]
    s_add_u32 s38, s95, 3407872
    ds_read_b128 v[152:155], v241 offset:16384
    v_mfma_f32_16x16x32_bf16 v[96:99], v[176:179], v[136:139], v[96:99]
    s_waitcnt lgkmcnt(11)
    ds_read_b64_tr_b16 v[168:169], v218 offset:32768
    ds_read_b64_tr_b16 v[170:171], v218 offset:33280
    v_mfma_f32_16x16x32_bf16 v[104:107], v[176:179], v[140:143], v[104:107]
    s_sub_u32 s100, s38, 3670016
    ds_read_b128 v[156:159], v241 offset:18432
    v_add_u32 v241, 65536, v241
    v_mfma_f32_16x16x32_bf16 v[100:103], v[180:183], v[136:139], v[100:103]
    s_waitcnt lgkmcnt(12)
    ds_read_b64_tr_b16 v[172:173], v219 offset:32768
    ds_read_b64_tr_b16 v[174:175], v219 offset:33280
    v_mfma_f32_16x16x32_bf16 v[108:111], v[180:183], v[140:143], v[108:111]
    s_min_u32 s38, s38, s100
    v_mfma_f32_16x16x32_bf16 v[112:115], v[184:187], v[136:139], v[112:115]
    s_waitcnt lgkmcnt(12)
    ds_read_b64_tr_b16 v[176:177], v216 offset:36864
    ds_read_b64_tr_b16 v[178:179], v216 offset:37376
    v_mfma_f32_16x16x32_bf16 v[120:123], v[184:187], v[140:143], v[120:123]
    buffer_load_dwordx4 v192, s[16:19], s38 offen offset:0 lds
    v_mfma_f32_16x16x32_bf16 v[116:119], v[188:191], v[136:139], v[116:119]
    s_waitcnt lgkmcnt(10)
    ds_read_b64_tr_b16 v[180:181], v217 offset:36864
    ds_read_b64_tr_b16 v[182:183], v217 offset:37376
    v_mfma_f32_16x16x32_bf16 v[124:127], v[188:191], v[140:143], v[124:127]
    v_mfma_f32_16x16x32_bf16 v[0:3], v[160:163], v[144:147], v[0:3]
    s_waitcnt lgkmcnt(10)
    ds_read_b64_tr_b16 v[184:185], v218 offset:36864
    ds_read_b64_tr_b16 v[186:187], v218 offset:37376
    v_mfma_f32_16x16x32_bf16 v[8:11], v[160:163], v[148:151], v[8:11]
    v_mfma_f32_16x16x32_bf16 v[4:7], v[164:167], v[144:147], v[4:7]
    s_waitcnt lgkmcnt(9)
    ds_read_b64_tr_b16 v[188:189], v219 offset:36864
    ds_read_b64_tr_b16 v[190:191], v219 offset:37376
    v_mfma_f32_16x16x32_bf16 v[12:15], v[164:167], v[148:151], v[12:15]
    buffer_load_dwordx4 v193, s[16:19], s38 offen offset:1024 lds
    v_mfma_f32_16x16x32_bf16 v[16:19], v[168:171], v[144:147], v[16:19]
    s_waitcnt lgkmcnt(8)
    ds_read_b64_tr_b16 v[160:161], v216 offset:40960
    ds_read_b64_tr_b16 v[162:163], v216 offset:41472
    v_mfma_f32_16x16x32_bf16 v[24:27], v[168:171], v[148:151], v[24:27]
    v_mfma_f32_16x16x32_bf16 v[20:23], v[172:175], v[144:147], v[20:23]
    s_waitcnt lgkmcnt(8)
    ds_read_b64_tr_b16 v[164:165], v217 offset:40960
    ds_read_b64_tr_b16 v[166:167], v217 offset:41472
    v_mfma_f32_16x16x32_bf16 v[28:31], v[172:175], v[148:151], v[28:31]
    v_mfma_f32_16x16x32_bf16 v[32:35], v[176:179], v[144:147], v[32:35]
    s_waitcnt lgkmcnt(8)
    ds_read_b64_tr_b16 v[168:169], v218 offset:40960
    ds_read_b64_tr_b16 v[170:171], v218 offset:41472
    v_mfma_f32_16x16x32_bf16 v[40:43], v[176:179], v[148:151], v[40:43]
    buffer_load_dwordx4 v194, s[16:19], s38 offen offset:2048 lds
    v_mfma_f32_16x16x32_bf16 v[36:39], v[180:183], v[144:147], v[36:39]
    s_waitcnt lgkmcnt(8)
    ds_read_b64_tr_b16 v[172:173], v219 offset:40960
    ds_read_b64_tr_b16 v[174:175], v219 offset:41472
    v_mfma_f32_16x16x32_bf16 v[44:47], v[180:183], v[148:151], v[44:47]
    v_mfma_f32_16x16x32_bf16 v[48:51], v[184:187], v[144:147], v[48:51]
    s_waitcnt lgkmcnt(8)
    ds_read_b64_tr_b16 v[176:177], v216 offset:45056
    ds_read_b64_tr_b16 v[178:179], v216 offset:45568
    v_mfma_f32_16x16x32_bf16 v[56:59], v[184:187], v[148:151], v[56:59]
    v_mfma_f32_16x16x32_bf16 v[52:55], v[188:191], v[144:147], v[52:55]
    s_waitcnt lgkmcnt(8)
    ds_read_b64_tr_b16 v[180:181], v217 offset:45056
    ds_read_b64_tr_b16 v[182:183], v217 offset:45568
    v_mfma_f32_16x16x32_bf16 v[60:63], v[188:191], v[148:151], v[60:63]
    buffer_load_dwordx4 v195, s[16:19], s38 offen offset:3072 lds
    v_mfma_f32_16x16x32_bf16 v[64:67], v[160:163], v[144:147], v[64:67]
    s_waitcnt lgkmcnt(8)
    ds_read_b64_tr_b16 v[184:185], v218 offset:45056
    ds_read_b64_tr_b16 v[186:187], v218 offset:45568
    v_mfma_f32_16x16x32_bf16 v[72:75], v[160:163], v[148:151], v[72:75]
    v_mfma_f32_16x16x32_bf16 v[68:71], v[164:167], v[144:147], v[68:71]
    s_waitcnt lgkmcnt(8)
    ds_read_b64_tr_b16 v[188:189], v219 offset:45056
    ds_read_b64_tr_b16 v[190:191], v219 offset:45568
    v_mfma_f32_16x16x32_bf16 v[76:79], v[164:167], v[148:151], v[76:79]
    s_waitcnt vmcnt(16)
    s_barrier
    v_mfma_f32_16x16x32_bf16 v[80:83], v[168:171], v[144:147], v[80:83]
    s_waitcnt lgkmcnt(8)
    ds_read_b64_tr_b16 v[160:161], v216 offset:49152
    ds_read_b64_tr_b16 v[162:163], v216 offset:49664
    v_mfma_f32_16x16x32_bf16 v[88:91], v[168:171], v[148:151], v[88:91]
    s_add_u32 m0, s36, 16384
    v_mfma_f32_16x16x32_bf16 v[84:87], v[172:175], v[144:147], v[84:87]
    s_waitcnt lgkmcnt(8)
    ds_read_b64_tr_b16 v[164:165], v217 offset:49152
    ds_read_b64_tr_b16 v[166:167], v217 offset:49664
    v_mfma_f32_16x16x32_bf16 v[92:95], v[172:175], v[148:151], v[92:95]
    buffer_load_dwordx4 v200, s[8:11], 0 offen offset:0 nt lds
    v_mfma_f32_16x16x32_bf16 v[96:99], v[176:179], v[144:147], v[96:99]
    s_waitcnt lgkmcnt(8)
    ds_read_b64_tr_b16 v[168:169], v218 offset:49152
    ds_read_b64_tr_b16 v[170:171], v218 offset:49664
    v_mfma_f32_16x16x32_bf16 v[104:107], v[176:179], v[148:151], v[104:107]
    v_mfma_f32_16x16x32_bf16 v[100:103], v[180:183], v[144:147], v[100:103]
    s_waitcnt lgkmcnt(8)
    ds_read_b64_tr_b16 v[172:173], v219 offset:49152
    ds_read_b64_tr_b16 v[174:175], v219 offset:49664
    v_mfma_f32_16x16x32_bf16 v[108:111], v[180:183], v[148:151], v[108:111]
    v_mfma_f32_16x16x32_bf16 v[112:115], v[184:187], v[144:147], v[112:115]
    s_waitcnt lgkmcnt(8)
    ds_read_b64_tr_b16 v[176:177], v216 offset:53248
    ds_read_b64_tr_b16 v[178:179], v216 offset:53760
    v_mfma_f32_16x16x32_bf16 v[120:123], v[184:187], v[148:151], v[120:123]
    buffer_load_dwordx4 v201, s[8:11], 0 offen offset:1024 nt lds
    v_mfma_f32_16x16x32_bf16 v[116:119], v[188:191], v[144:147], v[116:119]
    s_waitcnt lgkmcnt(8)
    ds_read_b64_tr_b16 v[180:181], v217 offset:53248
    ds_read_b64_tr_b16 v[182:183], v217 offset:53760
    v_mfma_f32_16x16x32_bf16 v[124:127], v[188:191], v[148:151], v[124:127]
    v_mfma_f32_16x16x32_bf16 v[0:3], v[160:163], v[152:155], v[0:3]
    s_waitcnt lgkmcnt(8)
    ds_read_b64_tr_b16 v[184:185], v218 offset:53248
    ds_read_b64_tr_b16 v[186:187], v218 offset:53760
    v_mfma_f32_16x16x32_bf16 v[8:11], v[160:163], v[156:159], v[8:11]
    v_mfma_f32_16x16x32_bf16 v[4:7], v[164:167], v[152:155], v[4:7]
    s_waitcnt lgkmcnt(8)
    ds_read_b64_tr_b16 v[188:189], v219 offset:53248
    ds_read_b64_tr_b16 v[190:191], v219 offset:53760
    v_mfma_f32_16x16x32_bf16 v[12:15], v[164:167], v[156:159], v[12:15]
    buffer_load_dwordx4 v202, s[8:11], 0 offen offset:2048 nt lds
    v_mfma_f32_16x16x32_bf16 v[16:19], v[168:171], v[152:155], v[16:19]
    s_waitcnt lgkmcnt(8)
    ds_read_b64_tr_b16 v[160:161], v216 offset:57344
    ds_read_b64_tr_b16 v[162:163], v216 offset:57856
    v_mfma_f32_16x16x32_bf16 v[24:27], v[168:171], v[156:159], v[24:27]
    v_mfma_f32_16x16x32_bf16 v[20:23], v[172:175], v[152:155], v[20:23]
    s_waitcnt lgkmcnt(8)
    ds_read_b64_tr_b16 v[164:165], v217 offset:57344
    ds_read_b64_tr_b16 v[166:167], v217 offset:57856
    v_mfma_f32_16x16x32_bf16 v[28:31], v[172:175], v[156:159], v[28:31]
    v_mfma_f32_16x16x32_bf16 v[32:35], v[176:179], v[152:155], v[32:35]
    s_waitcnt lgkmcnt(8)
    ds_read_b64_tr_b16 v[168:169], v218 offset:57344
    ds_read_b64_tr_b16 v[170:171], v218 offset:57856
    v_mfma_f32_16x16x32_bf16 v[40:43], v[176:179], v[156:159], v[40:43]
    buffer_load_dwordx4 v203, s[8:11], 0 offen offset:3072 nt lds
    v_mfma_f32_16x16x32_bf16 v[36:39], v[180:183], v[152:155], v[36:39]
    s_waitcnt lgkmcnt(8)
    ds_read_b64_tr_b16 v[172:173], v219 offset:57344
    ds_read_b64_tr_b16 v[174:175], v219 offset:57856
    v_mfma_f32_16x16x32_bf16 v[44:47], v[180:183], v[156:159], v[44:47]
    v_mfma_f32_16x16x32_bf16 v[48:51], v[184:187], v[152:155], v[48:51]
    s_waitcnt lgkmcnt(8)
    ds_read_b64_tr_b16 v[176:177], v216 offset:61440
    ds_read_b64_tr_b16 v[178:179], v216 offset:61952
    v_mfma_f32_16x16x32_bf16 v[56:59], v[184:187], v[156:159], v[56:59]
    v_add_u32 v216, 65536, v216
    v_mfma_f32_16x16x32_bf16 v[52:55], v[188:191], v[152:155], v[52:55]
    s_waitcnt lgkmcnt(8)
    ds_read_b64_tr_b16 v[180:181], v217 offset:61440
    ds_read_b64_tr_b16 v[182:183], v217 offset:61952
    v_mfma_f32_16x16x32_bf16 v[60:63], v[188:191], v[156:159], v[60:63]
    v_add_u32 v217, 65536, v217
    v_mfma_f32_16x16x32_bf16 v[64:67], v[160:163], v[152:155], v[64:67]
    s_waitcnt lgkmcnt(8)
    ds_read_b64_tr_b16 v[184:185], v218 offset:61440
    ds_read_b64_tr_b16 v[186:187], v218 offset:61952
    v_mfma_f32_16x16x32_bf16 v[72:75], v[160:163], v[156:159], v[72:75]
    v_add_u32 v218, 65536, v218
    v_mfma_f32_16x16x32_bf16 v[68:71], v[164:167], v[152:155], v[68:71]
    s_waitcnt lgkmcnt(8)
    ds_read_b64_tr_b16 v[188:189], v219 offset:61440
    ds_read_b64_tr_b16 v[190:191], v219 offset:61952
    v_mfma_f32_16x16x32_bf16 v[76:79], v[164:167], v[156:159], v[76:79]
    s_waitcnt vmcnt(8)
    s_barrier
    ds_read_b128 v[128:131], v240 offset:0
    v_add_u32 v219, 65536, v219
    v_mfma_f32_16x16x32_bf16 v[80:83], v[168:171], v[152:155], v[80:83]
    s_waitcnt lgkmcnt(9)
    ds_read_b64_tr_b16 v[160:161], v216 offset:16384
    ds_read_b64_tr_b16 v[162:163], v216 offset:16896
    v_mfma_f32_16x16x32_bf16 v[88:91], v[168:171], v[156:159], v[88:91]
    s_add_u32 m0, s36, 32768
    ds_read_b128 v[132:135], v240 offset:2048
    v_mfma_f32_16x16x32_bf16 v[84:87], v[172:175], v[152:155], v[84:87]
    s_waitcnt lgkmcnt(10)
    ds_read_b64_tr_b16 v[164:165], v217 offset:16384
    ds_read_b64_tr_b16 v[166:167], v217 offset:16896
    v_mfma_f32_16x16x32_bf16 v[92:95], v[172:175], v[156:159], v[92:95]
    s_mov_b32 s38, 16384
    ds_read_b128 v[136:139], v241 offset:0
    v_mfma_f32_16x16x32_bf16 v[96:99], v[176:179], v[152:155], v[96:99]
    s_waitcnt lgkmcnt(11)
    ds_read_b64_tr_b16 v[168:169], v218 offset:16384
    ds_read_b64_tr_b16 v[170:171], v218 offset:16896
    v_mfma_f32_16x16x32_bf16 v[104:107], v[176:179], v[156:159], v[104:107]
    ds_read_b128 v[140:143], v241 offset:2048
    v_mfma_f32_16x16x32_bf16 v[100:103], v[180:183], v[152:155], v[100:103]
    s_waitcnt lgkmcnt(12)
    ds_read_b64_tr_b16 v[172:173], v219 offset:16384
    ds_read_b64_tr_b16 v[174:175], v219 offset:16896
    v_mfma_f32_16x16x32_bf16 v[108:111], v[180:183], v[156:159], v[108:111]
    buffer_load_dwordx4 v200, s[8:11], s38 offen offset:0 nt lds
    v_mfma_f32_16x16x32_bf16 v[112:115], v[184:187], v[152:155], v[112:115]
    s_waitcnt lgkmcnt(12)
    ds_read_b64_tr_b16 v[176:177], v216 offset:20480
    ds_read_b64_tr_b16 v[178:179], v216 offset:20992
    v_mfma_f32_16x16x32_bf16 v[120:123], v[184:187], v[156:159], v[120:123]
    v_mfma_f32_16x16x32_bf16 v[116:119], v[188:191], v[152:155], v[116:119]
    s_waitcnt lgkmcnt(10)
    ds_read_b64_tr_b16 v[180:181], v217 offset:20480
    ds_read_b64_tr_b16 v[182:183], v217 offset:20992
    v_mfma_f32_16x16x32_bf16 v[124:127], v[188:191], v[156:159], v[124:127]
    buffer_load_dwordx4 v201, s[8:11], s38 offen offset:1024 nt lds
    v_mfma_f32_16x16x32_bf16 v[0:3], v[160:163], v[128:131], v[0:3]
    s_waitcnt lgkmcnt(10)
    ds_read_b64_tr_b16 v[184:185], v218 offset:20480
    ds_read_b64_tr_b16 v[186:187], v218 offset:20992
    v_mfma_f32_16x16x32_bf16 v[8:11], v[160:163], v[132:135], v[8:11]
    v_mfma_f32_16x16x32_bf16 v[4:7], v[164:167], v[128:131], v[4:7]
    s_waitcnt lgkmcnt(9)
    ds_read_b64_tr_b16 v[188:189], v219 offset:20480
    ds_read_b64_tr_b16 v[190:191], v219 offset:20992
    v_mfma_f32_16x16x32_bf16 v[12:15], v[164:167], v[132:135], v[12:15]
    buffer_load_dwordx4 v202, s[8:11], s38 offen offset:2048 nt lds
    v_mfma_f32_16x16x32_bf16 v[16:19], v[168:171], v[128:131], v[16:19]
    s_waitcnt lgkmcnt(8)
    ds_read_b64_tr_b16 v[160:161], v216 offset:24576
    ds_read_b64_tr_b16 v[162:163], v216 offset:25088
    v_mfma_f32_16x16x32_bf16 v[24:27], v[168:171], v[132:135], v[24:27]
    v_mfma_f32_16x16x32_bf16 v[20:23], v[172:175], v[128:131], v[20:23]
    s_waitcnt lgkmcnt(8)
    ds_read_b64_tr_b16 v[164:165], v217 offset:24576
    ds_read_b64_tr_b16 v[166:167], v217 offset:25088
    v_mfma_f32_16x16x32_bf16 v[28:31], v[172:175], v[132:135], v[28:31]
    buffer_load_dwordx4 v203, s[8:11], s38 offen offset:3072 nt lds
    v_mfma_f32_16x16x32_bf16 v[32:35], v[176:179], v[128:131], v[32:35]
    s_waitcnt lgkmcnt(8)
    ds_read_b64_tr_b16 v[168:169], v218 offset:24576
    ds_read_b64_tr_b16 v[170:171], v218 offset:25088
    v_mfma_f32_16x16x32_bf16 v[40:43], v[176:179], v[132:135], v[40:43]
    v_mfma_f32_16x16x32_bf16 v[36:39], v[180:183], v[128:131], v[36:39]
    s_waitcnt lgkmcnt(8)
    ds_read_b64_tr_b16 v[172:173], v219 offset:24576
    ds_read_b64_tr_b16 v[174:175], v219 offset:25088
    v_mfma_f32_16x16x32_bf16 v[44:47], v[180:183], v[132:135], v[44:47]
    v_mfma_f32_16x16x32_bf16 v[48:51], v[184:187], v[128:131], v[48:51]
    s_waitcnt lgkmcnt(8)
    ds_read_b64_tr_b16 v[176:177], v216 offset:28672
    ds_read_b64_tr_b16 v[178:179], v216 offset:29184
    v_mfma_f32_16x16x32_bf16 v[56:59], v[184:187], v[132:135], v[56:59]
    v_add_u32 v216, 4294836224, v216
    v_mfma_f32_16x16x32_bf16 v[52:55], v[188:191], v[128:131], v[52:55]
    s_waitcnt lgkmcnt(8)
    ds_read_b64_tr_b16 v[180:181], v217 offset:28672
    ds_read_b64_tr_b16 v[182:183], v217 offset:29184
    v_mfma_f32_16x16x32_bf16 v[60:63], v[188:191], v[132:135], v[60:63]
    v_add_u32 v217, 4294836224, v217
    v_mfma_f32_16x16x32_bf16 v[64:67], v[160:163], v[128:131], v[64:67]
    s_waitcnt lgkmcnt(8)
    ds_read_b64_tr_b16 v[184:185], v218 offset:28672
    ds_read_b64_tr_b16 v[186:187], v218 offset:29184
    v_mfma_f32_16x16x32_bf16 v[72:75], v[160:163], v[132:135], v[72:75]
    v_add_u32 v218, 4294836224, v218
    v_mfma_f32_16x16x32_bf16 v[68:71], v[164:167], v[128:131], v[68:71]
    s_waitcnt lgkmcnt(8)
    ds_read_b64_tr_b16 v[188:189], v219 offset:28672
    ds_read_b64_tr_b16 v[190:191], v219 offset:29184
    v_mfma_f32_16x16x32_bf16 v[76:79], v[164:167], v[132:135], v[76:79]
    s_waitcnt vmcnt(8)
    s_barrier
    v_add_u32 v219, 4294836224, v219
    v_mfma_f32_16x16x32_bf16 v[80:83], v[168:171], v[128:131], v[80:83]
    s_waitcnt lgkmcnt(8)
    ds_read_b64_tr_b16 v[160:161], v216 offset:0
    ds_read_b64_tr_b16 v[162:163], v216 offset:512
    v_mfma_f32_16x16x32_bf16 v[88:91], v[168:171], v[132:135], v[88:91]
    s_add_u32 m0, s36, 49152
    s_mov_b32 s38, 32768
    v_mfma_f32_16x16x32_bf16 v[84:87], v[172:175], v[128:131], v[84:87]
    s_waitcnt lgkmcnt(8)
    ds_read_b64_tr_b16 v[164:165], v217 offset:0
    ds_read_b64_tr_b16 v[166:167], v217 offset:512
    v_mfma_f32_16x16x32_bf16 v[92:95], v[172:175], v[132:135], v[92:95]
    buffer_load_dwordx4 v200, s[8:11], s38 offen offset:0 nt lds
    v_mfma_f32_16x16x32_bf16 v[96:99], v[176:179], v[128:131], v[96:99]
    s_waitcnt lgkmcnt(8)
    ds_read_b64_tr_b16 v[168:169], v218 offset:0
    ds_read_b64_tr_b16 v[170:171], v218 offset:512
    v_mfma_f32_16x16x32_bf16 v[104:107], v[176:179], v[132:135], v[104:107]
    v_mfma_f32_16x16x32_bf16 v[100:103], v[180:183], v[128:131], v[100:103]
    s_waitcnt lgkmcnt(8)
    ds_read_b64_tr_b16 v[172:173], v219 offset:0
    ds_read_b64_tr_b16 v[174:175], v219 offset:512
    v_mfma_f32_16x16x32_bf16 v[108:111], v[180:183], v[132:135], v[108:111]
    buffer_load_dwordx4 v201, s[8:11], s38 offen offset:1024 nt lds
    v_mfma_f32_16x16x32_bf16 v[112:115], v[184:187], v[128:131], v[112:115]
    s_waitcnt lgkmcnt(8)
    ds_read_b64_tr_b16 v[176:177], v216 offset:4096
    ds_read_b64_tr_b16 v[178:179], v216 offset:4608
    v_mfma_f32_16x16x32_bf16 v[120:123], v[184:187], v[132:135], v[120:123]
    v_mfma_f32_16x16x32_bf16 v[116:119], v[188:191], v[128:131], v[116:119]
    s_waitcnt lgkmcnt(8)
    ds_read_b64_tr_b16 v[180:181], v217 offset:4096
    ds_read_b64_tr_b16 v[182:183], v217 offset:4608
    v_mfma_f32_16x16x32_bf16 v[124:127], v[188:191], v[132:135], v[124:127]
    buffer_load_dwordx4 v202, s[8:11], s38 offen offset:2048 nt lds
    v_mfma_f32_16x16x32_bf16 v[0:3], v[160:163], v[136:139], v[0:3]
    s_waitcnt lgkmcnt(8)
    ds_read_b64_tr_b16 v[184:185], v218 offset:4096
    ds_read_b64_tr_b16 v[186:187], v218 offset:4608
    v_mfma_f32_16x16x32_bf16 v[8:11], v[160:163], v[140:143], v[8:11]
    v_mfma_f32_16x16x32_bf16 v[4:7], v[164:167], v[136:139], v[4:7]
    s_waitcnt lgkmcnt(8)
    ds_read_b64_tr_b16 v[188:189], v219 offset:4096
    ds_read_b64_tr_b16 v[190:191], v219 offset:4608
    v_mfma_f32_16x16x32_bf16 v[12:15], v[164:167], v[140:143], v[12:15]
    buffer_load_dwordx4 v203, s[8:11], s38 offen offset:3072 nt lds
    v_mfma_f32_16x16x32_bf16 v[16:19], v[168:171], v[136:139], v[16:19]
    s_waitcnt lgkmcnt(8)
    ds_read_b64_tr_b16 v[160:161], v216 offset:8192
    ds_read_b64_tr_b16 v[162:163], v216 offset:8704
    v_mfma_f32_16x16x32_bf16 v[24:27], v[168:171], v[140:143], v[24:27]
    v_mfma_f32_16x16x32_bf16 v[20:23], v[172:175], v[136:139], v[20:23]
    s_waitcnt lgkmcnt(8)
    ds_read_b64_tr_b16 v[164:165], v217 offset:8192
    ds_read_b64_tr_b16 v[166:167], v217 offset:8704
    v_mfma_f32_16x16x32_bf16 v[28:31], v[172:175], v[140:143], v[28:31]
    v_cvt_pk_bf16_f32 v0, v0, v1
    v_cvt_pk_bf16_f32 v1, v2, v3
    v_mfma_f32_16x16x32_bf16 v[32:35], v[176:179], v[136:139], v[32:35]
    s_waitcnt lgkmcnt(8)
    ds_read_b64_tr_b16 v[168:169], v218 offset:8192
    ds_read_b64_tr_b16 v[170:171], v218 offset:8704
    v_mfma_f32_16x16x32_bf16 v[40:43], v[176:179], v[140:143], v[40:43]
    v_cvt_pk_bf16_f32 v2, v4, v5
    v_cvt_pk_bf16_f32 v3, v6, v7
    v_mfma_f32_16x16x32_bf16 v[36:39], v[180:183], v[136:139], v[36:39]
    s_waitcnt lgkmcnt(8)
    ds_read_b64_tr_b16 v[172:173], v219 offset:8192
    ds_read_b64_tr_b16 v[174:175], v219 offset:8704
    v_mfma_f32_16x16x32_bf16 v[44:47], v[180:183], v[140:143], v[44:47]
    v_cvt_pk_bf16_f32 v8, v8, v9
    v_cvt_pk_bf16_f32 v9, v10, v11
    v_mfma_f32_16x16x32_bf16 v[48:51], v[184:187], v[136:139], v[48:51]
    s_waitcnt lgkmcnt(8)
    ds_read_b64_tr_b16 v[176:177], v216 offset:12288
    ds_read_b64_tr_b16 v[178:179], v216 offset:12800
    v_mfma_f32_16x16x32_bf16 v[56:59], v[184:187], v[140:143], v[56:59]
    v_cvt_pk_bf16_f32 v10, v12, v13
    v_cvt_pk_bf16_f32 v11, v14, v15
    v_mfma_f32_16x16x32_bf16 v[52:55], v[188:191], v[136:139], v[52:55]
    s_waitcnt lgkmcnt(8)
    ds_read_b64_tr_b16 v[180:181], v217 offset:12288
    ds_read_b64_tr_b16 v[182:183], v217 offset:12800
    v_mfma_f32_16x16x32_bf16 v[60:63], v[188:191], v[140:143], v[60:63]
    v_cvt_pk_bf16_f32 v16, v16, v17
    v_cvt_pk_bf16_f32 v17, v18, v19
    v_mfma_f32_16x16x32_bf16 v[64:67], v[160:163], v[136:139], v[64:67]
    s_waitcnt lgkmcnt(8)
    ds_read_b64_tr_b16 v[184:185], v218 offset:12288
    ds_read_b64_tr_b16 v[186:187], v218 offset:12800
    v_mfma_f32_16x16x32_bf16 v[72:75], v[160:163], v[140:143], v[72:75]
    v_cvt_pk_bf16_f32 v18, v20, v21
    v_cvt_pk_bf16_f32 v19, v22, v23
    v_mfma_f32_16x16x32_bf16 v[68:71], v[164:167], v[136:139], v[68:71]
    s_waitcnt lgkmcnt(8)
    ds_read_b64_tr_b16 v[188:189], v219 offset:12288
    ds_read_b64_tr_b16 v[190:191], v219 offset:12800
    v_mfma_f32_16x16x32_bf16 v[76:79], v[164:167], v[140:143], v[76:79]
    s_waitcnt vmcnt(8)
    s_barrier
    v_cvt_pk_bf16_f32 v24, v24, v25
    v_cvt_pk_bf16_f32 v25, v26, v27
    v_cvt_pk_bf16_f32 v26, v28, v29
    v_cvt_pk_bf16_f32 v27, v30, v31
    v_mfma_f32_16x16x32_bf16 v[80:83], v[168:171], v[136:139], v[80:83]
    s_waitcnt lgkmcnt(8)
    ds_read_b64 v[160:161], v212 offset:16384
    ds_read_b64 v[162:163], v213 offset:16384
    v_mfma_f32_16x16x32_bf16 v[88:91], v[168:171], v[140:143], v[88:91]
    v_cvt_pk_bf16_f32 v32, v32, v33
    v_cvt_pk_bf16_f32 v33, v34, v35
    v_mfma_f32_16x16x32_bf16 v[84:87], v[172:175], v[136:139], v[84:87]
    s_waitcnt lgkmcnt(8)
    ds_read_b64 v[164:165], v212 offset:18432
    ds_read_b64 v[166:167], v213 offset:18432
    v_mfma_f32_16x16x32_bf16 v[92:95], v[172:175], v[140:143], v[92:95]
    v_cvt_pk_bf16_f32 v34, v36, v37
    v_cvt_pk_bf16_f32 v35, v38, v39
    v_cvt_pk_bf16_f32 v40, v40, v41
    v_cvt_pk_bf16_f32 v41, v42, v43
    v_cvt_pk_bf16_f32 v42, v44, v45
    v_cvt_pk_bf16_f32 v43, v46, v47
    v_mfma_f32_16x16x32_bf16 v[96:99], v[176:179], v[136:139], v[96:99]
    s_waitcnt lgkmcnt(8)
    ds_read_b64 v[168:169], v214 offset:16384
    ds_read_b64 v[170:171], v215 offset:16384
    v_mfma_f32_16x16x32_bf16 v[104:107], v[176:179], v[140:143], v[104:107]
    v_cvt_pk_bf16_f32 v48, v48, v49
    v_cvt_pk_bf16_f32 v49, v50, v51
    v_mfma_f32_16x16x32_bf16 v[100:103], v[180:183], v[136:139], v[100:103]
    s_waitcnt lgkmcnt(8)
    ds_read_b64 v[172:173], v214 offset:18432
    ds_read_b64 v[174:175], v215 offset:18432
    v_mfma_f32_16x16x32_bf16 v[108:111], v[180:183], v[140:143], v[108:111]
    v_cvt_pk_bf16_f32 v50, v52, v53
    v_cvt_pk_bf16_f32 v51, v54, v55
    v_cvt_pk_bf16_f32 v56, v56, v57
    v_cvt_pk_bf16_f32 v57, v58, v59
    v_cvt_pk_bf16_f32 v58, v60, v61
    v_cvt_pk_bf16_f32 v59, v62, v63
    v_mfma_f32_16x16x32_bf16 v[112:115], v[184:187], v[136:139], v[112:115]
    s_waitcnt lgkmcnt(8)
    ds_read_b64 v[176:177], v212 offset:20480
    ds_read_b64 v[178:179], v213 offset:20480
    v_mfma_f32_16x16x32_bf16 v[120:123], v[184:187], v[140:143], v[120:123]
    v_cvt_pk_bf16_f32 v64, v64, v65
    v_cvt_pk_bf16_f32 v65, v66, v67
    v_mfma_f32_16x16x32_bf16 v[116:119], v[188:191], v[136:139], v[116:119]
    s_waitcnt lgkmcnt(8)
    ds_read_b64 v[180:181], v212 offset:22528
    ds_read_b64 v[182:183], v213 offset:22528
    v_mfma_f32_16x16x32_bf16 v[124:127], v[188:191], v[140:143], v[124:127]
    v_cvt_pk_bf16_f32 v66, v68, v69
    v_cvt_pk_bf16_f32 v67, v70, v71
    v_mfma_f32_16x16x32_bf16 a[0:3], v[160:163], v[0:3], 0
    s_waitcnt lgkmcnt(8)
    ds_read_b64 v[184:185], v214 offset:20480
    ds_read_b64 v[186:187], v215 offset:20480
    v_mfma_f32_16x16x32_bf16 a[8:11], v[160:163], v[8:11], 0
    v_cvt_pk_bf16_f32 v72, v72, v73
    v_cvt_pk_bf16_f32 v73, v74, v75
    v_mfma_f32_16x16x32_bf16 a[4:7], v[164:167], v[0:3], 0
    s_waitcnt lgkmcnt(8)
    ds_read_b64 v[188:189], v214 offset:22528
    ds_read_b64 v[190:191], v215 offset:22528
    v_mfma_f32_16x16x32_bf16 a[12:15], v[164:167], v[8:11], 0
    v_cvt_pk_bf16_f32 v74, v76, v77
    v_cvt_pk_bf16_f32 v75, v78, v79
    v_mfma_f32_16x16x32_bf16 a[0:3], v[168:171], v[16:19], a[0:3]
    s_waitcnt lgkmcnt(8)
    ds_read_b64 v[160:161], v212 offset:24576
    ds_read_b64 v[162:163], v213 offset:24576
    v_mfma_f32_16x16x32_bf16 a[8:11], v[168:171], v[24:27], a[8:11]
    v_cvt_pk_bf16_f32 v80, v80, v81
    v_cvt_pk_bf16_f32 v81, v82, v83
    v_mfma_f32_16x16x32_bf16 a[4:7], v[172:175], v[16:19], a[4:7]
    s_waitcnt lgkmcnt(8)
    ds_read_b64 v[164:165], v212 offset:26624
    ds_read_b64 v[166:167], v213 offset:26624
    v_mfma_f32_16x16x32_bf16 a[12:15], v[172:175], v[24:27], a[12:15]
    v_cvt_pk_bf16_f32 v82, v84, v85
    v_cvt_pk_bf16_f32 v83, v86, v87
    v_mfma_f32_16x16x32_bf16 a[0:3], v[176:179], v[32:35], a[0:3]
    s_waitcnt lgkmcnt(8)
    ds_read_b64 v[168:169], v214 offset:24576
    ds_read_b64 v[170:171], v215 offset:24576
    v_mfma_f32_16x16x32_bf16 a[8:11], v[176:179], v[40:43], a[8:11]
    v_cvt_pk_bf16_f32 v88, v88, v89
    v_cvt_pk_bf16_f32 v89, v90, v91
    v_mfma_f32_16x16x32_bf16 a[4:7], v[180:183], v[32:35], a[4:7]
    s_waitcnt lgkmcnt(8)
    ds_read_b64 v[172:173], v214 offset:26624
    ds_read_b64 v[174:175], v215 offset:26624
    v_mfma_f32_16x16x32_bf16 a[12:15], v[180:183], v[40:43], a[12:15]
    v_cvt_pk_bf16_f32 v90, v92, v93
    v_cvt_pk_bf16_f32 v91, v94, v95
    v_mfma_f32_16x16x32_bf16 a[0:3], v[184:187], v[48:51], a[0:3]
    s_waitcnt lgkmcnt(8)
    ds_read_b64 v[176:177], v212 offset:28672
    ds_read_b64 v[178:179], v213 offset:28672
    v_mfma_f32_16x16x32_bf16 a[8:11], v[184:187], v[56:59], a[8:11]
    v_cvt_pk_bf16_f32 v96, v96, v97
    v_cvt_pk_bf16_f32 v97, v98, v99
    v_mfma_f32_16x16x32_bf16 a[4:7], v[188:191], v[48:51], a[4:7]
    s_waitcnt lgkmcnt(8)
    ds_read_b64 v[180:181], v212 offset:30720
    ds_read_b64 v[182:183], v213 offset:30720
    v_mfma_f32_16x16x32_bf16 a[12:15], v[188:191], v[56:59], a[12:15]
    v_cvt_pk_bf16_f32 v98, v100, v101
    v_cvt_pk_bf16_f32 v99, v102, v103
    v_mfma_f32_16x16x32_bf16 a[0:3], v[160:163], v[64:67], a[0:3]
    s_waitcnt lgkmcnt(8)
    ds_read_b64 v[184:185], v214 offset:28672
    ds_read_b64 v[186:187], v215 offset:28672
    v_mfma_f32_16x16x32_bf16 a[8:11], v[160:163], v[72:75], a[8:11]
    v_cvt_pk_bf16_f32 v104, v104, v105
    v_cvt_pk_bf16_f32 v105, v106, v107
    v_mfma_f32_16x16x32_bf16 a[4:7], v[164:167], v[64:67], a[4:7]
    s_waitcnt lgkmcnt(8)
    ds_read_b64 v[188:189], v214 offset:30720
    ds_read_b64 v[190:191], v215 offset:30720
    v_mfma_f32_16x16x32_bf16 a[12:15], v[164:167], v[72:75], a[12:15]
    s_waitcnt vmcnt(4)
    s_barrier
    v_cvt_pk_bf16_f32 v106, v108, v109
    v_cvt_pk_bf16_f32 v107, v110, v111
    v_mfma_f32_16x16x32_bf16 a[0:3], v[168:171], v[80:83], a[0:3]
    s_waitcnt lgkmcnt(8)
    ds_read_b64 v[160:161], v212 offset:32768
    ds_read_b64 v[162:163], v213 offset:32768
    v_mfma_f32_16x16x32_bf16 a[8:11], v[168:171], v[88:91], a[8:11]
    s_add_u32 m0, s36, 65536
    s_mov_b32 s38, 49152
    v_cvt_pk_bf16_f32 v112, v112, v113
    v_cvt_pk_bf16_f32 v113, v114, v115
    v_mfma_f32_16x16x32_bf16 a[4:7], v[172:175], v[80:83], a[4:7]
    s_waitcnt lgkmcnt(8)
    ds_read_b64 v[164:165], v212 offset:34816
    ds_read_b64 v[166:167], v213 offset:34816
    v_mfma_f32_16x16x32_bf16 a[12:15], v[172:175], v[88:91], a[12:15]
    buffer_load_dwordx4 v200, s[8:11], s38 offen offset:0 nt lds
    v_cvt_pk_bf16_f32 v114, v116, v117
    v_cvt_pk_bf16_f32 v115, v118, v119
    v_mfma_f32_16x16x32_bf16 a[0:3], v[176:179], v[96:99], a[0:3]
    s_waitcnt lgkmcnt(8)
    ds_read_b64 v[168:169], v214 offset:32768
    ds_read_b64 v[170:171], v215 offset:32768
    v_mfma_f32_16x16x32_bf16 a[8:11], v[176:179], v[104:107], a[8:11]
    buffer_load_dwordx4 v201, s[8:11], s38 offen offset:1024 nt lds
    v_cvt_pk_bf16_f32 v120, v120, v121
    v_cvt_pk_bf16_f32 v121, v122, v123
    v_mfma_f32_16x16x32_bf16 a[4:7], v[180:183], v[96:99], a[4:7]
    s_waitcnt lgkmcnt(8)
    ds_read_b64 v[172:173], v214 offset:34816
    ds_read_b64 v[174:175], v215 offset:34816
    v_mfma_f32_16x16x32_bf16 a[12:15], v[180:183], v[104:107], a[12:15]
    buffer_load_dwordx4 v202, s[8:11], s38 offen offset:2048 nt lds
    v_cvt_pk_bf16_f32 v122, v124, v125
    v_cvt_pk_bf16_f32 v123, v126, v127
    v_mfma_f32_16x16x32_bf16 a[0:3], v[184:187], v[112:115], a[0:3]
    s_waitcnt lgkmcnt(8)
    ds_read_b64 v[176:177], v212 offset:36864
    ds_read_b64 v[178:179], v213 offset:36864
    v_mfma_f32_16x16x32_bf16 a[8:11], v[184:187], v[120:123], a[8:11]
    buffer_load_dwordx4 v203, s[8:11], s38 offen offset:3072 nt lds
    v_mfma_f32_16x16x32_bf16 a[4:7], v[188:191], v[112:115], a[4:7]
    s_waitcnt lgkmcnt(8)
    ds_read_b64 v[180:181], v212 offset:38912
    ds_read_b64 v[182:183], v213 offset:38912
    v_mfma_f32_16x16x32_bf16 a[12:15], v[188:191], v[120:123], a[12:15]
    v_add_u32 v223, 81920, v222
    v_mfma_f32_16x16x32_bf16 a[16:19], v[160:163], v[0:3], 0
    s_waitcnt lgkmcnt(8)
    ds_read_b64 v[184:185], v214 offset:36864
    ds_read_b64 v[186:187], v215 offset:36864
    v_mfma_f32_16x16x32_bf16 a[24:27], v[160:163], v[8:11], 0
L_pf0:
    s_bfe_u32 s7, s2, 0x20003
    s_lshl_b32 s7, s7, 2
    s_add_u32 s7, s7, s35
    s_lshl_b32 s7, s7, 10
    s_add_u32 s7, s7, L_pf0 - concat_heads__mha_block_cached__mha_block_cached__near_ridge_kernel + 3072
    v_lshlrev_b32 v194, 6, v243
    v_add_u32 v194, s7, v194
    v_min_u32 v194, CODE_END_OFF - 64, v194
    s_mov_b64 exec, 0xffff
    global_load_dword v194, v194, s[92:93]
    s_mov_b64 exec, -1
    v_mfma_f32_16x16x32_bf16 a[20:23], v[164:167], v[0:3], 0
    s_waitcnt lgkmcnt(8)
    ds_read_b64 v[188:189], v214 offset:38912
    ds_read_b64 v[190:191], v215 offset:38912
    v_mfma_f32_16x16x32_bf16 a[28:31], v[164:167], v[8:11], 0
    ds_write_b64 v223, a[64:65] offset:0
    v_mfma_f32_16x16x32_bf16 a[16:19], v[168:171], v[16:19], a[16:19]
    s_waitcnt lgkmcnt(9)
    ds_read_b64 v[160:161], v212 offset:40960
    ds_read_b64 v[162:163], v213 offset:40960
    v_mfma_f32_16x16x32_bf16 a[24:27], v[168:171], v[24:27], a[24:27]
    ds_write_b64 v223, a[66:67] offset:8
    v_accvgpr_read_b32 v224, a0
    v_accvgpr_read_b32 v225, a1
    v_accvgpr_read_b32 v226, a2
    v_accvgpr_read_b32 v227, a3
    v_mfma_f32_16x16x32_bf16 a[20:23], v[172:175], v[16:19], a[20:23]
    s_waitcnt lgkmcnt(10)
    ds_read_b64 v[164:165], v212 offset:43008
    ds_read_b64 v[166:167], v213 offset:43008
    v_mfma_f32_16x16x32_bf16 a[28:31], v[172:175], v[24:27], a[28:31]
    ds_write_b64 v223, a[68:69] offset:1024
    v_max3_f32 v220, v224, v225, v220
    v_accvgpr_read_b32 v228, a4
    v_mfma_f32_16x16x32_bf16 a[16:19], v[176:179], v[32:35], a[16:19]
    s_waitcnt lgkmcnt(11)
    ds_read_b64 v[168:169], v214 offset:40960
    ds_read_b64 v[170:171], v215 offset:40960
    v_mfma_f32_16x16x32_bf16 a[24:27], v[176:179], v[40:43], a[24:27]
    ds_write_b64 v223, a[70:71] offset:1032
    v_accvgpr_read_b32 v229, a5
    v_max3_f32 v220, v226, v227, v220
    v_mfma_f32_16x16x32_bf16 a[20:23], v[180:183], v[32:35], a[20:23]
    s_waitcnt lgkmcnt(12)
    ds_read_b64 v[172:173], v214 offset:43008
    ds_read_b64 v[174:175], v215 offset:43008
    v_mfma_f32_16x16x32_bf16 a[28:31], v[180:183], v[40:43], a[28:31]
    ds_write_b64 v223, a[72:73] offset:2048
    v_accvgpr_read_b32 v230, a6
    v_accvgpr_read_b32 v231, a7
    v_mfma_f32_16x16x32_bf16 a[16:19], v[184:187], v[48:51], a[16:19]
    s_waitcnt lgkmcnt(13)
    ds_read_b64 v[176:177], v212 offset:45056
    ds_read_b64 v[178:179], v213 offset:45056
    v_mfma_f32_16x16x32_bf16 a[24:27], v[184:187], v[56:59], a[24:27]
    ds_write_b64 v223, a[74:75] offset:2056
    v_max3_f32 v220, v228, v229, v220
    v_accvgpr_read_b32 v232, a8
    v_mfma_f32_16x16x32_bf16 a[20:23], v[188:191], v[48:51], a[20:23]
    s_waitcnt lgkmcnt(13)
    ds_read_b64 v[180:181], v212 offset:47104
    ds_read_b64 v[182:183], v213 offset:47104
    v_mfma_f32_16x16x32_bf16 a[28:31], v[188:191], v[56:59], a[28:31]
    ds_write_b64 v223, a[76:77] offset:3072
    v_accvgpr_read_b32 v233, a9
    v_max3_f32 v220, v230, v231, v220
    v_mfma_f32_16x16x32_bf16 a[16:19], v[160:163], v[64:67], a[16:19]
    s_waitcnt lgkmcnt(13)
    ds_read_b64 v[184:185], v214 offset:45056
    ds_read_b64 v[186:187], v215 offset:45056
    v_mfma_f32_16x16x32_bf16 a[24:27], v[160:163], v[72:75], a[24:27]
    ds_write_b64 v223, a[78:79] offset:3080
    v_accvgpr_read_b32 v234, a10
    v_accvgpr_read_b32 v235, a11
    v_mfma_f32_16x16x32_bf16 a[20:23], v[164:167], v[64:67], a[20:23]
    s_waitcnt lgkmcnt(13)
    ds_read_b64 v[188:189], v214 offset:47104
    ds_read_b64 v[190:191], v215 offset:47104
    v_mfma_f32_16x16x32_bf16 a[28:31], v[164:167], v[72:75], a[28:31]
    s_waitcnt vmcnt(5)
    s_barrier
    v_max3_f32 v221, v232, v233, v221
    v_accvgpr_read_b32 v236, a12
    v_mfma_f32_16x16x32_bf16 a[16:19], v[168:171], v[80:83], a[16:19]
    s_waitcnt lgkmcnt(12)
    ds_read_b64 v[160:161], v212 offset:49152
    ds_read_b64 v[162:163], v213 offset:49152
    v_mfma_f32_16x16x32_bf16 a[24:27], v[168:171], v[88:91], a[24:27]
    s_add_u32 m0, s36, 98304
    s_mov_b32 s38, 81920
    v_accvgpr_read_b32 v237, a13
    v_max3_f32 v221, v234, v235, v221
    v_mfma_f32_16x16x32_bf16 a[20:23], v[172:175], v[80:83], a[20:23]
    s_waitcnt lgkmcnt(11)
    ds_read_b64 v[164:165], v212 offset:51200
    ds_read_b64 v[166:167], v213 offset:51200
    v_mfma_f32_16x16x32_bf16 a[28:31], v[172:175], v[88:91], a[28:31]
    buffer_load_dwordx4 v200, s[8:11], s38 offen offset:0 nt lds
    v_accvgpr_read_b32 v238, a14
    v_accvgpr_read_b32 v239, a15
    v_mfma_f32_16x16x32_bf16 a[16:19], v[176:179], v[96:99], a[16:19]
    s_waitcnt lgkmcnt(10)
    ds_read_b64 v[168:169], v214 offset:49152
    ds_read_b64 v[170:171], v215 offset:49152
    v_mfma_f32_16x16x32_bf16 a[24:27], v[176:179], v[104:107], a[24:27]
    v_max3_f32 v221, v236, v237, v221
    v_max3_f32 v221, v238, v239, v221
    v_mfma_f32_16x16x32_bf16 a[20:23], v[180:183], v[96:99], a[20:23]
    s_waitcnt lgkmcnt(9)
    ds_read_b64 v[172:173], v214 offset:51200
    ds_read_b64 v[174:175], v215 offset:51200
    v_mfma_f32_16x16x32_bf16 a[28:31], v[180:183], v[104:107], a[28:31]
    buffer_load_dwordx4 v201, s[8:11], s38 offen offset:1024 nt lds
    v_sub_u32 v216, v216, v242
    v_sub_u32 v217, v217, v242
    v_mfma_f32_16x16x32_bf16 a[16:19], v[184:187], v[112:115], a[16:19]
    s_waitcnt lgkmcnt(8)
    ds_read_b64 v[176:177], v212 offset:53248
    ds_read_b64 v[178:179], v213 offset:53248
    v_mfma_f32_16x16x32_bf16 a[24:27], v[184:187], v[120:123], a[24:27]
    v_sub_u32 v218, v218, v242
    v_sub_u32 v219, v219, v242
    v_mfma_f32_16x16x32_bf16 a[20:23], v[188:191], v[112:115], a[20:23]
    s_waitcnt lgkmcnt(8)
    ds_read_b64 v[180:181], v212 offset:55296
    ds_read_b64 v[182:183], v213 offset:55296
    v_mfma_f32_16x16x32_bf16 a[28:31], v[188:191], v[120:123], a[28:31]
    buffer_load_dwordx4 v202, s[8:11], s38 offen offset:2048 nt lds
    s_lshr_b32 s5, s35, 1
    s_lshl_b32 s5, s5, 14
    v_mfma_f32_16x16x32_bf16 a[32:35], v[160:163], v[0:3], 0
    s_waitcnt lgkmcnt(8)
    ds_read_b64 v[184:185], v214 offset:53248
    ds_read_b64 v[186:187], v215 offset:53248
    v_mfma_f32_16x16x32_bf16 a[40:43], v[160:163], v[8:11], 0
    s_and_b32 s6, s35, 1
    s_lshl_b32 s6, s6, 12
    s_add_u32 s5, s5, s6
    v_mfma_f32_16x16x32_bf16 a[36:39], v[164:167], v[0:3], 0
    s_waitcnt lgkmcnt(8)
    ds_read_b64 v[188:189], v214 offset:55296
    ds_read_b64 v[190:191], v215 offset:55296
    v_mfma_f32_16x16x32_bf16 a[44:47], v[164:167], v[8:11], 0
    buffer_load_dwordx4 v203, s[8:11], s38 offen offset:3072 nt lds
    v_lshlrev_b32 v192, 4, v243
    v_mfma_f32_16x16x32_bf16 a[32:35], v[168:171], v[16:19], a[32:35]
    s_waitcnt lgkmcnt(8)
    ds_read_b64 v[160:161], v212 offset:57344
    ds_read_b64 v[162:163], v213 offset:57344
    v_mfma_f32_16x16x32_bf16 a[40:43], v[168:171], v[24:27], a[40:43]
    v_accvgpr_read_b32 v224, a16
    v_accvgpr_read_b32 v225, a17
    v_mfma_f32_16x16x32_bf16 a[36:39], v[172:175], v[16:19], a[36:39]
    s_waitcnt lgkmcnt(8)
    ds_read_b64 v[164:165], v212 offset:59392
    ds_read_b64 v[166:167], v213 offset:59392
    v_mfma_f32_16x16x32_bf16 a[44:47], v[172:175], v[24:27], a[44:47]
    v_accvgpr_read_b32 v226, a18
    v_accvgpr_read_b32 v227, a19
    v_mfma_f32_16x16x32_bf16 a[32:35], v[176:179], v[32:35], a[32:35]
    s_waitcnt lgkmcnt(8)
    ds_read_b64 v[168:169], v214 offset:57344
    ds_read_b64 v[170:171], v215 offset:57344
    v_mfma_f32_16x16x32_bf16 a[40:43], v[176:179], v[40:43], a[40:43]
    v_max3_f32 v220, v224, v225, v220
    v_accvgpr_read_b32 v228, a20
    v_mfma_f32_16x16x32_bf16 a[36:39], v[180:183], v[32:35], a[36:39]
    s_waitcnt lgkmcnt(8)
    ds_read_b64 v[172:173], v214 offset:59392
    ds_read_b64 v[174:175], v215 offset:59392
    v_mfma_f32_16x16x32_bf16 a[44:47], v[180:183], v[40:43], a[44:47]
    v_accvgpr_read_b32 v229, a21
    v_max3_f32 v220, v226, v227, v220
    v_mfma_f32_16x16x32_bf16 a[32:35], v[184:187], v[48:51], a[32:35]
    s_waitcnt lgkmcnt(8)
    ds_read_b64 v[176:177], v212 offset:61440
    ds_read_b64 v[178:179], v213 offset:61440
    v_mfma_f32_16x16x32_bf16 a[40:43], v[184:187], v[56:59], a[40:43]
    v_accvgpr_read_b32 v230, a22
    v_accvgpr_read_b32 v231, a23
    v_mfma_f32_16x16x32_bf16 a[36:39], v[188:191], v[48:51], a[36:39]
    s_waitcnt lgkmcnt(8)
    ds_read_b64 v[180:181], v212 offset:63488
    ds_read_b64 v[182:183], v213 offset:63488
    v_mfma_f32_16x16x32_bf16 a[44:47], v[188:191], v[56:59], a[44:47]
    v_add_u32 v212, 65536, v212
    v_add_u32 v213, 65536, v213
    v_max3_f32 v220, v228, v229, v220
    v_mfma_f32_16x16x32_bf16 a[32:35], v[160:163], v[64:67], a[32:35]
    s_waitcnt lgkmcnt(8)
    ds_read_b64 v[184:185], v214 offset:61440
    ds_read_b64 v[186:187], v215 offset:61440
    v_mfma_f32_16x16x32_bf16 a[40:43], v[160:163], v[72:75], a[40:43]
    v_accvgpr_read_b32 v232, a24
    v_accvgpr_read_b32 v233, a25
    v_mfma_f32_16x16x32_bf16 a[36:39], v[164:167], v[64:67], a[36:39]
    s_waitcnt lgkmcnt(8)
    ds_read_b64 v[188:189], v214 offset:63488
    ds_read_b64 v[190:191], v215 offset:63488
    v_mfma_f32_16x16x32_bf16 a[44:47], v[164:167], v[72:75], a[44:47]
    s_waitcnt vmcnt(5)
    s_barrier
    v_add_u32 v214, 65536, v214
    v_add_u32 v215, 65536, v215
    v_max3_f32 v220, v230, v231, v220
    v_accvgpr_read_b32 v234, a26
    v_mfma_f32_16x16x32_bf16 a[32:35], v[168:171], v[80:83], a[32:35]
    s_waitcnt lgkmcnt(8)
    ds_read_b64 v[160:161], v212 offset:0
    ds_read_b64 v[162:163], v213 offset:0
    v_mfma_f32_16x16x32_bf16 a[40:43], v[168:171], v[88:91], a[40:43]
    s_add_u32 m0, s36, 114688
    s_mov_b32 s38, 98304
    v_accvgpr_read_b32 v235, a27
    v_max3_f32 v221, v232, v233, v221
    v_mfma_f32_16x16x32_bf16 a[36:39], v[172:175], v[80:83], a[36:39]
    s_waitcnt lgkmcnt(8)
    ds_read_b64 v[164:165], v212 offset:2048
    ds_read_b64 v[166:167], v213 offset:2048
    v_mfma_f32_16x16x32_bf16 a[44:47], v[172:175], v[88:91], a[44:47]
    buffer_load_dwordx4 v200, s[8:11], s38 offen offset:0 nt lds
    v_accvgpr_read_b32 v236, a28
    v_accvgpr_read_b32 v237, a29
    v_mfma_f32_16x16x32_bf16 a[32:35], v[176:179], v[96:99], a[32:35]
    s_waitcnt lgkmcnt(8)
    ds_read_b64 v[168:169], v214 offset:0
    ds_read_b64 v[170:171], v215 offset:0
    v_mfma_f32_16x16x32_bf16 a[40:43], v[176:179], v[104:107], a[40:43]
    v_max3_f32 v221, v234, v235, v221
    v_accvgpr_read_b32 v238, a30
    v_mfma_f32_16x16x32_bf16 a[36:39], v[180:183], v[96:99], a[36:39]
    s_waitcnt lgkmcnt(8)
    ds_read_b64 v[172:173], v214 offset:2048
    ds_read_b64 v[174:175], v215 offset:2048
    v_mfma_f32_16x16x32_bf16 a[44:47], v[180:183], v[104:107], a[44:47]
    buffer_load_dwordx4 v201, s[8:11], s38 offen offset:1024 nt lds
    v_accvgpr_read_b32 v239, a31
    v_max3_f32 v221, v236, v237, v221
    v_mfma_f32_16x16x32_bf16 a[32:35], v[184:187], v[112:115], a[32:35]
    s_waitcnt lgkmcnt(8)
    ds_read_b64 v[176:177], v212 offset:4096
    ds_read_b64 v[178:179], v213 offset:4096
    v_mfma_f32_16x16x32_bf16 a[40:43], v[184:187], v[120:123], a[40:43]
    v_max3_f32 v221, v238, v239, v221
    v_and_b32 v192, 0x70, v192
    v_mfma_f32_16x16x32_bf16 a[36:39], v[188:191], v[112:115], a[36:39]
    s_waitcnt lgkmcnt(8)
    ds_read_b64 v[180:181], v212 offset:6144
    ds_read_b64 v[182:183], v213 offset:6144
    v_mfma_f32_16x16x32_bf16 a[44:47], v[188:191], v[120:123], a[44:47]
    buffer_load_dwordx4 v202, s[8:11], s38 offen offset:2048 nt lds
    v_lshrrev_b32 v245, 4, v243
    v_lshl_add_u32 v192, v245, 7, v192
    v_mfma_f32_16x16x32_bf16 a[48:51], v[160:163], v[0:3], 0
    s_waitcnt lgkmcnt(8)
    ds_read_b64 v[184:185], v214 offset:4096
    ds_read_b64 v[186:187], v215 offset:4096
    v_mfma_f32_16x16x32_bf16 a[56:59], v[160:163], v[8:11], 0
    v_bfe_u32 v246, v243, 3, 1
    v_lshl_add_u32 v192, v246, 10, v192
    v_mfma_f32_16x16x32_bf16 a[52:55], v[164:167], v[0:3], 0
    s_waitcnt lgkmcnt(8)
    ds_read_b64 v[188:189], v214 offset:6144
    ds_read_b64 v[190:191], v215 offset:6144
    v_mfma_f32_16x16x32_bf16 a[60:63], v[164:167], v[8:11], 0
    buffer_load_dwordx4 v203, s[8:11], s38 offen offset:3072 nt lds
    v_add_u32 v192, s5, v192
    s_lshl_b32 s5, s35, 7
    v_mfma_f32_16x16x32_bf16 a[48:51], v[168:171], v[16:19], a[48:51]
    s_waitcnt lgkmcnt(8)
    ds_read_b64 v[160:161], v212 offset:8192
    ds_read_b64 v[162:163], v213 offset:8192
    v_mfma_f32_16x16x32_bf16 a[56:59], v[168:171], v[24:27], a[56:59]
    v_accvgpr_read_b32 v224, a32
    v_accvgpr_read_b32 v225, a33
    v_mfma_f32_16x16x32_bf16 a[52:55], v[172:175], v[16:19], a[52:55]
    s_waitcnt lgkmcnt(8)
    ds_read_b64 v[164:165], v212 offset:10240
    ds_read_b64 v[166:167], v213 offset:10240
    v_mfma_f32_16x16x32_bf16 a[60:63], v[172:175], v[24:27], a[60:63]
    v_accvgpr_read_b32 v226, a34
    v_accvgpr_read_b32 v227, a35
    v_mfma_f32_16x16x32_bf16 a[48:51], v[176:179], v[32:35], a[48:51]
    s_waitcnt lgkmcnt(8)
    ds_read_b64 v[168:169], v214 offset:8192
    ds_read_b64 v[170:171], v215 offset:8192
    v_mfma_f32_16x16x32_bf16 a[56:59], v[176:179], v[40:43], a[56:59]
    v_max3_f32 v220, v224, v225, v220
    v_accvgpr_read_b32 v228, a36
    v_mfma_f32_16x16x32_bf16 a[52:55], v[180:183], v[32:35], a[52:55]
    s_waitcnt lgkmcnt(8)
    ds_read_b64 v[172:173], v214 offset:10240
    ds_read_b64 v[174:175], v215 offset:10240
    v_mfma_f32_16x16x32_bf16 a[60:63], v[180:183], v[40:43], a[60:63]
    v_accvgpr_read_b32 v229, a37
    v_max3_f32 v220, v226, v227, v220
    v_mfma_f32_16x16x32_bf16 a[48:51], v[184:187], v[48:51], a[48:51]
    s_waitcnt lgkmcnt(8)
    ds_read_b64 v[176:177], v212 offset:12288
    ds_read_b64 v[178:179], v213 offset:12288
    v_mfma_f32_16x16x32_bf16 a[56:59], v[184:187], v[56:59], a[56:59]
    v_accvgpr_read_b32 v230, a38
    v_accvgpr_read_b32 v231, a39
    v_mfma_f32_16x16x32_bf16 a[52:55], v[188:191], v[48:51], a[52:55]
    s_waitcnt lgkmcnt(8)
    ds_read_b64 v[180:181], v212 offset:14336
    ds_read_b64 v[182:183], v213 offset:14336
    v_mfma_f32_16x16x32_bf16 a[60:63], v[188:191], v[56:59], a[60:63]
    v_max3_f32 v220, v228, v229, v220
    v_accvgpr_read_b32 v232, a40
    v_mfma_f32_16x16x32_bf16 a[48:51], v[160:163], v[64:67], a[48:51]
    s_waitcnt lgkmcnt(8)
    ds_read_b64 v[184:185], v214 offset:12288
    ds_read_b64 v[186:187], v215 offset:12288
    v_mfma_f32_16x16x32_bf16 a[56:59], v[160:163], v[72:75], a[56:59]
    v_accvgpr_read_b32 v233, a41
    v_max3_f32 v220, v230, v231, v220
    v_mfma_f32_16x16x32_bf16 a[52:55], v[164:167], v[64:67], a[52:55]
    s_waitcnt lgkmcnt(8)
    ds_read_b64 v[188:189], v214 offset:14336
    ds_read_b64 v[190:191], v215 offset:14336
    v_mfma_f32_16x16x32_bf16 a[60:63], v[164:167], v[72:75], a[60:63]
    s_barrier
    v_accvgpr_read_b32 v234, a42
    v_mfma_f32_16x16x32_bf16 a[48:51], v[168:171], v[80:83], a[48:51]
    s_waitcnt lgkmcnt(8)
    ds_read_b64 v[160:161], v212 offset:16384
    ds_read_b64 v[162:163], v213 offset:16384
    v_mfma_f32_16x16x32_bf16 a[56:59], v[168:171], v[88:91], a[56:59]
    v_accvgpr_read_b32 v235, a43
    v_max3_f32 v221, v232, v233, v221
    v_mfma_f32_16x16x32_bf16 a[52:55], v[172:175], v[80:83], a[52:55]
    s_waitcnt lgkmcnt(8)
    ds_read_b64 v[164:165], v212 offset:18432
    ds_read_b64 v[166:167], v213 offset:18432
    v_mfma_f32_16x16x32_bf16 a[60:63], v[172:175], v[88:91], a[60:63]
    v_accvgpr_read_b32 v236, a44
    v_accvgpr_read_b32 v237, a45
    v_mfma_f32_16x16x32_bf16 a[48:51], v[176:179], v[96:99], a[48:51]
    s_waitcnt lgkmcnt(8)
    ds_read_b64 v[168:169], v214 offset:16384
    ds_read_b64 v[170:171], v215 offset:16384
    v_mfma_f32_16x16x32_bf16 a[56:59], v[176:179], v[104:107], a[56:59]
    v_max3_f32 v221, v234, v235, v221
    v_accvgpr_read_b32 v238, a46
    v_mfma_f32_16x16x32_bf16 a[52:55], v[180:183], v[96:99], a[52:55]
    s_waitcnt lgkmcnt(8)
    ds_read_b64 v[172:173], v214 offset:18432
    ds_read_b64 v[174:175], v215 offset:18432
    v_mfma_f32_16x16x32_bf16 a[60:63], v[180:183], v[104:107], a[60:63]
    v_accvgpr_read_b32 v239, a47
    v_max3_f32 v221, v236, v237, v221
    v_mfma_f32_16x16x32_bf16 a[48:51], v[184:187], v[112:115], a[48:51]
    s_waitcnt lgkmcnt(8)
    ds_read_b64 v[176:177], v212 offset:20480
    ds_read_b64 v[178:179], v213 offset:20480
    v_mfma_f32_16x16x32_bf16 a[56:59], v[184:187], v[120:123], a[56:59]
    s_lshl_b32 s7, s35, 2
    s_add_u32 s7, s7, 49152
    v_mov_b32 v250, s7
    v_mov_b32 v251, s75
    ds_write_b32 v250, v251
    v_max3_f32 v221, v238, v239, v221
    s_lshl_b32 s6, s34, 2
    v_mfma_f32_16x16x32_bf16 a[52:55], v[188:191], v[112:115], a[52:55]
    s_waitcnt lgkmcnt(9)
    ds_read_b64 v[180:181], v212 offset:22528
    ds_read_b64 v[182:183], v213 offset:22528
    v_mfma_f32_16x16x32_bf16 a[60:63], v[188:191], v[120:123], a[60:63]
    s_add_u32 s5, s5, s6
    v_mov_b32 v193, s5
    s_lshr_b32 s5, s34, 2
    v_mfma_f32_16x16x32_bf16 a[64:67], v[160:163], v[0:3], 0
    s_waitcnt lgkmcnt(9)
    ds_read_b64 v[184:185], v214 offset:20480
    ds_read_b64 v[186:187], v215 offset:20480
    v_mfma_f32_16x16x32_bf16 a[72:75], v[160:163], v[8:11], 0
    s_lshl_b32 s5, s5, 7
    v_and_b32 v195, 15, v243
    v_lshlrev_b32 v195, 2, v195
    v_mfma_f32_16x16x32_bf16 a[68:71], v[164:167], v[0:3], 0
    s_waitcnt lgkmcnt(9)
    ds_read_b64 v[188:189], v214 offset:22528
    ds_read_b64 v[190:191], v215 offset:22528
    v_mfma_f32_16x16x32_bf16 a[76:79], v[164:167], v[8:11], 0
    v_mfma_f32_16x16x32_bf16 a[64:67], v[168:171], v[16:19], a[64:67]
    s_waitcnt lgkmcnt(9)
    ds_read_b64 v[160:161], v212 offset:24576
    ds_read_b64 v[162:163], v213 offset:24576
    v_mfma_f32_16x16x32_bf16 a[72:75], v[168:171], v[24:27], a[72:75]
    v_accvgpr_read_b32 v224, a48
    v_accvgpr_read_b32 v225, a49
    v_mfma_f32_16x16x32_bf16 a[68:71], v[172:175], v[16:19], a[68:71]
    s_waitcnt lgkmcnt(9)
    ds_read_b64 v[164:165], v212 offset:26624
    ds_read_b64 v[166:167], v213 offset:26624
    v_mfma_f32_16x16x32_bf16 a[76:79], v[172:175], v[24:27], a[76:79]
    v_accvgpr_read_b32 v226, a50
    v_accvgpr_read_b32 v227, a51
    v_mfma_f32_16x16x32_bf16 a[64:67], v[176:179], v[32:35], a[64:67]
    s_waitcnt lgkmcnt(8)
    ds_read_b64 v[168:169], v214 offset:24576
    ds_read_b64 v[170:171], v215 offset:24576
    v_mfma_f32_16x16x32_bf16 a[72:75], v[176:179], v[40:43], a[72:75]
    v_max3_f32 v220, v224, v225, v220
    v_accvgpr_read_b32 v228, a52
    v_mfma_f32_16x16x32_bf16 a[68:71], v[180:183], v[32:35], a[68:71]
    s_waitcnt lgkmcnt(8)
    ds_read_b64 v[172:173], v214 offset:26624
    ds_read_b64 v[174:175], v215 offset:26624
    v_mfma_f32_16x16x32_bf16 a[76:79], v[180:183], v[40:43], a[76:79]
    v_accvgpr_read_b32 v229, a53
    v_max3_f32 v220, v226, v227, v220
    v_mfma_f32_16x16x32_bf16 a[64:67], v[184:187], v[48:51], a[64:67]
    s_waitcnt lgkmcnt(8)
    ds_read_b64 v[176:177], v212 offset:28672
    ds_read_b64 v[178:179], v213 offset:28672
    v_mfma_f32_16x16x32_bf16 a[72:75], v[184:187], v[56:59], a[72:75]
    v_accvgpr_read_b32 v230, a54
    v_accvgpr_read_b32 v231, a55
    v_mfma_f32_16x16x32_bf16 a[68:71], v[188:191], v[48:51], a[68:71]
    s_waitcnt lgkmcnt(8)
    ds_read_b64 v[180:181], v212 offset:30720
    ds_read_b64 v[182:183], v213 offset:30720
    v_mfma_f32_16x16x32_bf16 a[76:79], v[188:191], v[56:59], a[76:79]
    v_max3_f32 v220, v228, v229, v220
    v_accvgpr_read_b32 v232, a56
    v_mfma_f32_16x16x32_bf16 a[64:67], v[160:163], v[64:67], a[64:67]
    s_waitcnt lgkmcnt(8)
    ds_read_b64 v[184:185], v214 offset:28672
    ds_read_b64 v[186:187], v215 offset:28672
    v_mfma_f32_16x16x32_bf16 a[72:75], v[160:163], v[72:75], a[72:75]
    v_accvgpr_read_b32 v233, a57
    v_max3_f32 v220, v230, v231, v220
    v_mfma_f32_16x16x32_bf16 a[68:71], v[164:167], v[64:67], a[68:71]
    s_waitcnt lgkmcnt(8)
    ds_read_b64 v[188:189], v214 offset:30720
    ds_read_b64 v[190:191], v215 offset:30720
    v_mfma_f32_16x16x32_bf16 a[76:79], v[164:167], v[72:75], a[76:79]
    s_waitcnt vmcnt(4)
    s_barrier
    v_accvgpr_read_b32 v234, a58
    v_mfma_f32_16x16x32_bf16 a[64:67], v[168:171], v[80:83], a[64:67]
    s_waitcnt lgkmcnt(8)
    ds_read_b64 v[160:161], v212 offset:32768
    ds_read_b64 v[162:163], v213 offset:32768
    v_mfma_f32_16x16x32_bf16 a[72:75], v[168:171], v[88:91], a[72:75]
    s_add_u32 m0, s36, 131072
    s_mov_b32 s38, 114688
    v_accvgpr_read_b32 v235, a59
    v_max3_f32 v221, v232, v233, v221
    v_mfma_f32_16x16x32_bf16 a[68:71], v[172:175], v[80:83], a[68:71]
    s_waitcnt lgkmcnt(8)
    ds_read_b64 v[164:165], v212 offset:34816
    ds_read_b64 v[166:167], v213 offset:34816
    v_mfma_f32_16x16x32_bf16 a[76:79], v[172:175], v[88:91], a[76:79]
    buffer_load_dwordx4 v200, s[8:11], s38 offen offset:0 nt lds
    v_accvgpr_read_b32 v236, a60
    v_accvgpr_read_b32 v237, a61
    v_mfma_f32_16x16x32_bf16 a[64:67], v[176:179], v[96:99], a[64:67]
    s_waitcnt lgkmcnt(8)
    ds_read_b64 v[168:169], v214 offset:32768
    ds_read_b64 v[170:171], v215 offset:32768
    v_mfma_f32_16x16x32_bf16 a[72:75], v[176:179], v[104:107], a[72:75]
    v_max3_f32 v221, v234, v235, v221
    v_accvgpr_read_b32 v238, a62
    v_mfma_f32_16x16x32_bf16 a[68:71], v[180:183], v[96:99], a[68:71]
    s_waitcnt lgkmcnt(8)
    ds_read_b64 v[172:173], v214 offset:34816
    ds_read_b64 v[174:175], v215 offset:34816
    v_mfma_f32_16x16x32_bf16 a[76:79], v[180:183], v[104:107], a[76:79]
    buffer_load_dwordx4 v201, s[8:11], s38 offen offset:1024 nt lds
    v_accvgpr_read_b32 v239, a63
    v_max3_f32 v221, v236, v237, v221
    v_mfma_f32_16x16x32_bf16 a[64:67], v[184:187], v[112:115], a[64:67]
    s_waitcnt lgkmcnt(8)
    ds_read_b64 v[176:177], v212 offset:36864
    ds_read_b64 v[178:179], v213 offset:36864
    v_mfma_f32_16x16x32_bf16 a[72:75], v[184:187], v[120:123], a[72:75]
    v_max3_f32 v221, v238, v239, v221
    v_add_u32 v195, s5, v195
    v_mfma_f32_16x16x32_bf16 a[68:71], v[188:191], v[112:115], a[68:71]
    s_waitcnt lgkmcnt(8)
    ds_read_b64 v[180:181], v212 offset:38912
    ds_read_b64 v[182:183], v213 offset:38912
    v_mfma_f32_16x16x32_bf16 a[76:79], v[188:191], v[120:123], a[76:79]
    buffer_load_dwordx4 v202, s[8:11], s38 offen offset:2048 nt lds
    s_mul_i32 s5, s4, 4194304
    s_add_u32 s24, s90, s5
    s_addc_u32 s25, s91, 0
    v_mfma_f32_16x16x32_bf16 a[80:83], v[160:163], v[0:3], 0
    s_waitcnt lgkmcnt(8)
    ds_read_b64 v[184:185], v214 offset:36864
    ds_read_b64 v[186:187], v215 offset:36864
    v_mfma_f32_16x16x32_bf16 a[88:91], v[160:163], v[8:11], 0
    s_mov_b32 s26, 4194304
    s_mov_b32 s27, 0x20000
    s_mov_b32 s16, s96
    v_mfma_f32_16x16x32_bf16 a[84:87], v[164:167], v[0:3], 0
    s_waitcnt lgkmcnt(8)
    ds_read_b64 v[188:189], v214 offset:38912
    ds_read_b64 v[190:191], v215 offset:38912
    v_mfma_f32_16x16x32_bf16 a[92:95], v[164:167], v[8:11], 0
    buffer_load_dwordx4 v203, s[8:11], s38 offen offset:3072 nt lds
    s_mov_b32 s17, s97
    v_mfma_f32_16x16x32_bf16 a[80:83], v[168:171], v[16:19], a[80:83]
    s_waitcnt lgkmcnt(8)
    ds_read_b64 v[160:161], v212 offset:40960
    ds_read_b64 v[162:163], v213 offset:40960
    v_mfma_f32_16x16x32_bf16 a[88:91], v[168:171], v[24:27], a[88:91]
    v_accvgpr_read_b32 v224, a64
    v_accvgpr_read_b32 v225, a65
    v_mfma_f32_16x16x32_bf16 a[84:87], v[172:175], v[16:19], a[84:87]
    s_waitcnt lgkmcnt(8)
    ds_read_b64 v[164:165], v212 offset:43008
    ds_read_b64 v[166:167], v213 offset:43008
    v_mfma_f32_16x16x32_bf16 a[92:95], v[172:175], v[24:27], a[92:95]
    v_accvgpr_read_b32 v226, a66
    v_accvgpr_read_b32 v227, a67
    v_mfma_f32_16x16x32_bf16 a[80:83], v[176:179], v[32:35], a[80:83]
    s_waitcnt lgkmcnt(8)
    ds_read_b64 v[168:169], v214 offset:40960
    ds_read_b64 v[170:171], v215 offset:40960
    v_mfma_f32_16x16x32_bf16 a[88:91], v[176:179], v[40:43], a[88:91]
    v_max3_f32 v220, v224, v225, v220
    v_accvgpr_read_b32 v228, a68
    v_mfma_f32_16x16x32_bf16 a[84:87], v[180:183], v[32:35], a[84:87]
    s_waitcnt lgkmcnt(8)
    ds_read_b64 v[172:173], v214 offset:43008
    ds_read_b64 v[174:175], v215 offset:43008
    v_mfma_f32_16x16x32_bf16 a[92:95], v[180:183], v[40:43], a[92:95]
    v_accvgpr_read_b32 v229, a69
    v_max3_f32 v220, v226, v227, v220
    v_mfma_f32_16x16x32_bf16 a[80:83], v[184:187], v[48:51], a[80:83]
    s_waitcnt lgkmcnt(8)
    ds_read_b64 v[176:177], v212 offset:45056
    ds_read_b64 v[178:179], v213 offset:45056
    v_mfma_f32_16x16x32_bf16 a[88:91], v[184:187], v[56:59], a[88:91]
    v_accvgpr_read_b32 v230, a70
    v_accvgpr_read_b32 v231, a71
    v_mfma_f32_16x16x32_bf16 a[84:87], v[188:191], v[48:51], a[84:87]
    s_waitcnt lgkmcnt(8)
    ds_read_b64 v[180:181], v212 offset:47104
    ds_read_b64 v[182:183], v213 offset:47104
    v_mfma_f32_16x16x32_bf16 a[92:95], v[188:191], v[56:59], a[92:95]
    v_max3_f32 v220, v228, v229, v220
    v_accvgpr_read_b32 v232, a72
    v_mfma_f32_16x16x32_bf16 a[80:83], v[160:163], v[64:67], a[80:83]
    s_waitcnt lgkmcnt(8)
    ds_read_b64 v[184:185], v214 offset:45056
    ds_read_b64 v[186:187], v215 offset:45056
    v_mfma_f32_16x16x32_bf16 a[88:91], v[160:163], v[72:75], a[88:91]
    v_accvgpr_read_b32 v233, a73
    v_max3_f32 v220, v230, v231, v220
    v_mfma_f32_16x16x32_bf16 a[84:87], v[164:167], v[64:67], a[84:87]
    s_waitcnt lgkmcnt(8)
    ds_read_b64 v[188:189], v214 offset:47104
    ds_read_b64 v[190:191], v215 offset:47104
    v_mfma_f32_16x16x32_bf16 a[92:95], v[164:167], v[72:75], a[92:95]
    s_waitcnt vmcnt(4)
    s_barrier
    v_accvgpr_read_b32 v234, a74
    v_mfma_f32_16x16x32_bf16 a[80:83], v[168:171], v[80:83], a[80:83]
    s_waitcnt lgkmcnt(8)
    ds_read_b64 v[160:161], v212 offset:49152
    ds_read_b64 v[162:163], v213 offset:49152
    v_mfma_f32_16x16x32_bf16 a[88:91], v[168:171], v[88:91], a[88:91]
    s_add_u32 m0, s36, 147456
    s_mov_b32 s38, 131072
    v_accvgpr_read_b32 v235, a75
    v_max3_f32 v221, v232, v233, v221
    v_mfma_f32_16x16x32_bf16 a[84:87], v[172:175], v[80:83], a[84:87]
    s_waitcnt lgkmcnt(8)
    ds_read_b64 v[164:165], v212 offset:51200
    ds_read_b64 v[166:167], v213 offset:51200
    v_mfma_f32_16x16x32_bf16 a[92:95], v[172:175], v[88:91], a[92:95]
    buffer_load_dwordx4 v200, s[8:11], s38 offen offset:0 nt lds
    v_accvgpr_read_b32 v236, a76
    v_accvgpr_read_b32 v237, a77
    v_mfma_f32_16x16x32_bf16 a[80:83], v[176:179], v[96:99], a[80:83]
    s_waitcnt lgkmcnt(8)
    ds_read_b64 v[168:169], v214 offset:49152
    ds_read_b64 v[170:171], v215 offset:49152
    v_mfma_f32_16x16x32_bf16 a[88:91], v[176:179], v[104:107], a[88:91]
    buffer_load_dwordx4 v201, s[8:11], s38 offen offset:1024 nt lds
    v_max3_f32 v221, v234, v235, v221
    v_accvgpr_read_b32 v238, a78
    v_mfma_f32_16x16x32_bf16 a[84:87], v[180:183], v[96:99], a[84:87]
    s_waitcnt lgkmcnt(8)
    ds_read_b64 v[172:173], v214 offset:51200
    ds_read_b64 v[174:175], v215 offset:51200
    v_mfma_f32_16x16x32_bf16 a[92:95], v[180:183], v[104:107], a[92:95]
    buffer_load_dwordx4 v202, s[8:11], s38 offen offset:2048 nt lds
    v_accvgpr_read_b32 v239, a79
    v_max3_f32 v221, v236, v237, v221
    v_mfma_f32_16x16x32_bf16 a[80:83], v[184:187], v[112:115], a[80:83]
    s_waitcnt lgkmcnt(8)
    ds_read_b64 v[176:177], v212 offset:53248
    ds_read_b64 v[178:179], v213 offset:53248
    v_mfma_f32_16x16x32_bf16 a[88:91], v[184:187], v[120:123], a[88:91]
    buffer_load_dwordx4 v203, s[8:11], s38 offen offset:3072 nt lds
    v_mov_b32 v250, 49152
    ds_read_b128 v[252:255], v250
    v_max3_f32 v221, v238, v239, v221
    s_mov_b32 s18, 1835008
    v_mfma_f32_16x16x32_bf16 a[84:87], v[188:191], v[112:115], a[84:87]
    s_waitcnt lgkmcnt(9)
    ds_read_b64 v[180:181], v212 offset:55296
    ds_read_b64 v[182:183], v213 offset:55296
    v_mfma_f32_16x16x32_bf16 a[92:95], v[188:191], v[120:123], a[92:95]
    v_add_u32 v223, 0, v222
    s_mov_b32 s19, 0x20000
    s_mov_b32 s3, 200000
    v_mfma_f32_16x16x32_bf16 a[96:99], v[160:163], v[0:3], 0
    s_waitcnt lgkmcnt(9)
    ds_read_b64 v[184:185], v214 offset:53248
    ds_read_b64 v[186:187], v215 offset:53248
    v_mfma_f32_16x16x32_bf16 a[104:107], v[160:163], v[8:11], 0
    ds_write_b64 v223, a[144:145] offset:0
    v_mov_b32 v196, 0
    v_mov_b32 v197, 0
    v_mfma_f32_16x16x32_bf16 a[100:103], v[164:167], v[0:3], 0
    s_waitcnt lgkmcnt(10)
    ds_read_b64 v[188:189], v214 offset:55296
    ds_read_b64 v[190:191], v215 offset:55296
    v_mfma_f32_16x16x32_bf16 a[108:111], v[164:167], v[8:11], 0
    ds_write_b64 v223, a[146:147] offset:8
    v_mov_b32 v198, 0
    v_mov_b32 v199, 0
    v_mfma_f32_16x16x32_bf16 a[96:99], v[168:171], v[16:19], a[96:99]
    s_waitcnt lgkmcnt(11)
    ds_read_b64 v[160:161], v212 offset:57344
    ds_read_b64 v[162:163], v213 offset:57344
    v_mfma_f32_16x16x32_bf16 a[104:107], v[168:171], v[24:27], a[104:107]
    ds_write_b64 v223, a[148:149] offset:1024
    v_mfma_f32_16x16x32_bf16 a[100:103], v[172:175], v[16:19], a[100:103]
    s_waitcnt lgkmcnt(12)
    ds_read_b64 v[164:165], v212 offset:59392
    ds_read_b64 v[166:167], v213 offset:59392
    v_mfma_f32_16x16x32_bf16 a[108:111], v[172:175], v[24:27], a[108:111]
    ds_write_b64 v223, a[150:151] offset:1032
    v_mfma_f32_16x16x32_bf16 a[96:99], v[176:179], v[32:35], a[96:99]
    s_waitcnt lgkmcnt(12)
    ds_read_b64 v[168:169], v214 offset:57344
    ds_read_b64 v[170:171], v215 offset:57344
    v_mfma_f32_16x16x32_bf16 a[104:107], v[176:179], v[40:43], a[104:107]
    ds_write_b64 v223, a[152:153] offset:2048
    v_mfma_f32_16x16x32_bf16 a[100:103], v[180:183], v[32:35], a[100:103]
    s_waitcnt lgkmcnt(13)
    ds_read_b64 v[172:173], v214 offset:59392
    ds_read_b64 v[174:175], v215 offset:59392
    v_mfma_f32_16x16x32_bf16 a[108:111], v[180:183], v[40:43], a[108:111]
    ds_write_b64 v223, a[154:155] offset:2056
    v_mfma_f32_16x16x32_bf16 a[96:99], v[184:187], v[48:51], a[96:99]
    s_waitcnt lgkmcnt(13)
    ds_read_b64 v[176:177], v212 offset:61440
    ds_read_b64 v[178:179], v213 offset:61440
    v_mfma_f32_16x16x32_bf16 a[104:107], v[184:187], v[56:59], a[104:107]
    ds_write_b64 v223, a[156:157] offset:3072
    v_accvgpr_read_b32 v224, a80
    v_accvgpr_read_b32 v225, a81
    v_mfma_f32_16x16x32_bf16 a[100:103], v[188:191], v[48:51], a[100:103]
    s_waitcnt lgkmcnt(13)
    ds_read_b64 v[180:181], v212 offset:63488
    ds_read_b64 v[182:183], v213 offset:63488
    v_mfma_f32_16x16x32_bf16 a[108:111], v[188:191], v[56:59], a[108:111]
    v_add_u32 v212, 65536, v212
    v_add_u32 v213, 65536, v213
    v_accvgpr_read_b32 v226, a82
    v_accvgpr_read_b32 v227, a83
    v_mfma_f32_16x16x32_bf16 a[96:99], v[160:163], v[64:67], a[96:99]
    s_waitcnt lgkmcnt(12)
    ds_read_b64 v[184:185], v214 offset:61440
    ds_read_b64 v[186:187], v215 offset:61440
    v_mfma_f32_16x16x32_bf16 a[104:107], v[160:163], v[72:75], a[104:107]
    ds_write_b64 v223, a[158:159] offset:3080
    v_max3_f32 v220, v224, v225, v220
    v_accvgpr_read_b32 v228, a84
    v_accvgpr_read_b32 v229, a85
    v_max3_f32 v220, v226, v227, v220
    v_accvgpr_read_b32 v230, a86
    v_accvgpr_read_b32 v231, a87
    v_max3_f32 v220, v228, v229, v220
    v_accvgpr_read_b32 v232, a88
    v_accvgpr_read_b32 v233, a89
    v_max3_f32 v220, v230, v231, v220
    v_accvgpr_read_b32 v234, a90
    v_mfma_f32_16x16x32_bf16 a[100:103], v[164:167], v[64:67], a[100:103]
    s_waitcnt lgkmcnt(12)
    ds_read_b64 v[188:189], v214 offset:63488
    ds_read_b64 v[190:191], v215 offset:63488
    v_mfma_f32_16x16x32_bf16 a[108:111], v[164:167], v[72:75], a[108:111]
    s_waitcnt vmcnt(4)
    s_barrier
    v_add_u32 v214, 65536, v214
    v_add_u32 v215, 65536, v215
    v_accvgpr_read_b32 v235, a91
    v_max3_f32 v221, v232, v233, v221
    v_mfma_f32_16x16x32_bf16 a[96:99], v[168:171], v[80:83], a[96:99]
    s_waitcnt lgkmcnt(11)
    ds_read_b64 v[160:161], v212 offset:0
    ds_read_b64 v[162:163], v213 offset:0
    v_mfma_f32_16x16x32_bf16 a[104:107], v[168:171], v[88:91], a[104:107]
    s_add_u32 m0, s36, 16384
    s_mov_b32 s38, 163840
    v_accvgpr_read_b32 v236, a92
    v_accvgpr_read_b32 v237, a93
    v_mfma_f32_16x16x32_bf16 a[100:103], v[172:175], v[80:83], a[100:103]
    s_waitcnt lgkmcnt(10)
    ds_read_b64 v[164:165], v212 offset:2048
    ds_read_b64 v[166:167], v213 offset:2048
    v_mfma_f32_16x16x32_bf16 a[108:111], v[172:175], v[88:91], a[108:111]
    buffer_load_dwordx4 v200, s[8:11], s38 offen offset:0 nt lds
    v_max3_f32 v221, v234, v235, v221
    v_accvgpr_read_b32 v238, a94
    v_mfma_f32_16x16x32_bf16 a[96:99], v[176:179], v[96:99], a[96:99]
    s_waitcnt lgkmcnt(9)
    ds_read_b64 v[168:169], v214 offset:0
    ds_read_b64 v[170:171], v215 offset:0
    v_mfma_f32_16x16x32_bf16 a[104:107], v[176:179], v[104:107], a[104:107]
    v_accvgpr_read_b32 v239, a95
    v_max3_f32 v221, v236, v237, v221
    v_mfma_f32_16x16x32_bf16 a[100:103], v[180:183], v[96:99], a[100:103]
    s_waitcnt lgkmcnt(9)
    ds_read_b64 v[172:173], v214 offset:2048
    ds_read_b64 v[174:175], v215 offset:2048
    v_mfma_f32_16x16x32_bf16 a[108:111], v[180:183], v[104:107], a[108:111]
    buffer_load_dwordx4 v201, s[8:11], s38 offen offset:1024 nt lds
    v_max3_f32 v221, v238, v239, v221
    v_add_u32 v252, v252, v253
    v_mfma_f32_16x16x32_bf16 a[96:99], v[184:187], v[112:115], a[96:99]
    s_waitcnt lgkmcnt(8)
    ds_read_b64 v[176:177], v212 offset:4096
    ds_read_b64 v[178:179], v213 offset:4096
    v_mfma_f32_16x16x32_bf16 a[104:107], v[184:187], v[120:123], a[104:107]
    v_add3_u32 v252, v252, v254, v255
    s_nop 0
    v_readfirstlane_b32 s75, v252
    v_mfma_f32_16x16x32_bf16 a[100:103], v[188:191], v[112:115], a[100:103]
    s_waitcnt lgkmcnt(8)
    ds_read_b64 v[180:181], v212 offset:6144
    ds_read_b64 v[182:183], v213 offset:6144
    v_mfma_f32_16x16x32_bf16 a[108:111], v[188:191], v[120:123], a[108:111]
    buffer_load_dwordx4 v202, s[8:11], s38 offen offset:2048 nt lds
    s_lshl_b32 s6, s75, 1
    s_and_b32 s74, s35, 1
    v_mfma_f32_16x16x32_bf16 a[112:115], v[160:163], v[0:3], 0
    s_waitcnt lgkmcnt(8)
    ds_read_b64 v[184:185], v214 offset:4096
    ds_read_b64 v[186:187], v215 offset:4096
    v_mfma_f32_16x16x32_bf16 a[120:123], v[160:163], v[8:11], 0
    s_sub_u32 s6, s6, s74
    s_lshr_b32 s74, s6, 31
    s_lshl_b32 s74, s74, 13
    v_mfma_f32_16x16x32_bf16 a[116:119], v[164:167], v[0:3], 0
    s_waitcnt lgkmcnt(8)
    ds_read_b64 v[188:189], v214 offset:6144
    ds_read_b64 v[190:191], v215 offset:6144
    v_mfma_f32_16x16x32_bf16 a[124:127], v[164:167], v[8:11], 0
    buffer_load_dwordx4 v203, s[8:11], s38 offen offset:3072 nt lds
    v_add_u32 v192, s74, v192
    v_mfma_f32_16x16x32_bf16 a[112:115], v[168:171], v[16:19], a[112:115]
    s_waitcnt lgkmcnt(8)
    ds_read_b64 v[160:161], v212 offset:8192
    ds_read_b64 v[162:163], v213 offset:8192
    v_mfma_f32_16x16x32_bf16 a[120:123], v[168:171], v[24:27], a[120:123]
    v_accvgpr_read_b32 v224, a96
    v_accvgpr_read_b32 v225, a97
    v_mfma_f32_16x16x32_bf16 a[116:119], v[172:175], v[16:19], a[116:119]
    s_waitcnt lgkmcnt(8)
    ds_read_b64 v[164:165], v212 offset:10240
    ds_read_b64 v[166:167], v213 offset:10240
    v_mfma_f32_16x16x32_bf16 a[124:127], v[172:175], v[24:27], a[124:127]
    v_accvgpr_read_b32 v226, a98
    v_accvgpr_read_b32 v227, a99
    v_mfma_f32_16x16x32_bf16 a[112:115], v[176:179], v[32:35], a[112:115]
    s_waitcnt lgkmcnt(8)
    ds_read_b64 v[168:169], v214 offset:8192
    ds_read_b64 v[170:171], v215 offset:8192
    v_mfma_f32_16x16x32_bf16 a[120:123], v[176:179], v[40:43], a[120:123]
    s_cmp_lg_u32 s37, 0
    s_cbranch_scc1 L_nl
    s_add_u32 s7, s74, 1
    v_mov_b32 v249, s7
    s_mov_b64 exec, 1
    buffer_store_dword v249, v248, s[76:79], 0 offen sc0 sc1
    s_mov_b64 exec, -1
L_nl:
    v_max3_f32 v220, v224, v225, v220
    v_mfma_f32_16x16x32_bf16 a[116:119], v[180:183], v[32:35], a[116:119]
    s_waitcnt lgkmcnt(8)
    ds_read_b64 v[172:173], v214 offset:10240
    ds_read_b64 v[174:175], v215 offset:10240
    v_mfma_f32_16x16x32_bf16 a[124:127], v[180:183], v[40:43], a[124:127]
    v_accvgpr_read_b32 v228, a100
    v_accvgpr_read_b32 v229, a101
    v_mfma_f32_16x16x32_bf16 a[112:115], v[184:187], v[48:51], a[112:115]
    s_waitcnt lgkmcnt(8)
    ds_read_b64 v[176:177], v212 offset:12288
    ds_read_b64 v[178:179], v213 offset:12288
    v_mfma_f32_16x16x32_bf16 a[120:123], v[184:187], v[56:59], a[120:123]
    v_max3_f32 v220, v226, v227, v220
    v_accvgpr_read_b32 v230, a102
    v_mfma_f32_16x16x32_bf16 a[116:119], v[188:191], v[48:51], a[116:119]
    s_waitcnt lgkmcnt(8)
    ds_read_b64 v[180:181], v212 offset:14336
    ds_read_b64 v[182:183], v213 offset:14336
    v_mfma_f32_16x16x32_bf16 a[124:127], v[188:191], v[56:59], a[124:127]
    v_accvgpr_read_b32 v231, a103
    v_max3_f32 v220, v228, v229, v220
    v_mfma_f32_16x16x32_bf16 a[112:115], v[160:163], v[64:67], a[112:115]
    s_waitcnt lgkmcnt(8)
    ds_read_b64 v[184:185], v214 offset:12288
    ds_read_b64 v[186:187], v215 offset:12288
    v_mfma_f32_16x16x32_bf16 a[120:123], v[160:163], v[72:75], a[120:123]
    v_accvgpr_read_b32 v232, a104
    v_accvgpr_read_b32 v233, a105
    v_mfma_f32_16x16x32_bf16 a[116:119], v[164:167], v[64:67], a[116:119]
    s_waitcnt lgkmcnt(8)
    ds_read_b64 v[188:189], v214 offset:14336
    ds_read_b64 v[190:191], v215 offset:14336
    v_mfma_f32_16x16x32_bf16 a[124:127], v[164:167], v[72:75], a[124:127]
    s_waitcnt vmcnt(4)
    s_barrier
    v_max3_f32 v220, v230, v231, v220
    v_mfma_f32_16x16x32_bf16 a[112:115], v[168:171], v[80:83], a[112:115]
    s_waitcnt lgkmcnt(8)
    ds_read_b64 v[160:161], v212 offset:16384
    ds_read_b64 v[162:163], v213 offset:16384
    v_mfma_f32_16x16x32_bf16 a[120:123], v[168:171], v[88:91], a[120:123]
    s_add_u32 m0, s36, 32768
    s_mov_b32 s38, 180224
    v_accvgpr_read_b32 v234, a106
    v_mfma_f32_16x16x32_bf16 a[116:119], v[172:175], v[80:83], a[116:119]
    s_waitcnt lgkmcnt(8)
    ds_read_b64 v[164:165], v212 offset:18432
    ds_read_b64 v[166:167], v213 offset:18432
    v_mfma_f32_16x16x32_bf16 a[124:127], v[172:175], v[88:91], a[124:127]
    buffer_load_dwordx4 v200, s[8:11], s38 offen offset:0 nt lds
    v_mfma_f32_16x16x32_bf16 a[112:115], v[176:179], v[96:99], a[112:115]
    s_waitcnt lgkmcnt(8)
    ds_read_b64 v[168:169], v214 offset:16384
    ds_read_b64 v[170:171], v215 offset:16384
    v_mfma_f32_16x16x32_bf16 a[120:123], v[176:179], v[104:107], a[120:123]
    v_accvgpr_read_b32 v235, a107
    v_max3_f32 v221, v232, v233, v221
    v_mfma_f32_16x16x32_bf16 a[116:119], v[180:183], v[96:99], a[116:119]
    s_waitcnt lgkmcnt(8)
    ds_read_b64 v[172:173], v214 offset:18432
    ds_read_b64 v[174:175], v215 offset:18432
    v_mfma_f32_16x16x32_bf16 a[124:127], v[180:183], v[104:107], a[124:127]
    buffer_load_dwordx4 v201, s[8:11], s38 offen offset:1024 nt lds
    v_mfma_f32_16x16x32_bf16 a[112:115], v[184:187], v[112:115], a[112:115]
    s_waitcnt lgkmcnt(8)
    ds_read_b64 v[176:177], v212 offset:20480
    ds_read_b64 v[178:179], v213 offset:20480
    v_mfma_f32_16x16x32_bf16 a[120:123], v[184:187], v[120:123], a[120:123]
    v_accvgpr_read_b32 v236, a108
    v_accvgpr_read_b32 v237, a109
    v_mfma_f32_16x16x32_bf16 a[116:119], v[188:191], v[112:115], a[116:119]
    s_waitcnt lgkmcnt(8)
    ds_read_b64 v[180:181], v212 offset:22528
    ds_read_b64 v[182:183], v213 offset:22528
    v_mfma_f32_16x16x32_bf16 a[124:127], v[188:191], v[120:123], a[124:127]
    buffer_load_dwordx4 v202, s[8:11], s38 offen offset:2048 nt lds
    v_max3_f32 v221, v234, v235, v221
    v_mfma_f32_16x16x32_bf16 a[128:131], v[160:163], v[0:3], 0
    s_waitcnt lgkmcnt(8)
    ds_read_b64 v[184:185], v214 offset:20480
    ds_read_b64 v[186:187], v215 offset:20480
    v_mfma_f32_16x16x32_bf16 a[136:139], v[160:163], v[8:11], 0
    v_accvgpr_read_b32 v238, a110
    v_accvgpr_read_b32 v239, a111
    v_mfma_f32_16x16x32_bf16 a[132:135], v[164:167], v[0:3], 0
    s_waitcnt lgkmcnt(8)
    ds_read_b64 v[188:189], v214 offset:22528
    ds_read_b64 v[190:191], v215 offset:22528
    v_mfma_f32_16x16x32_bf16 a[140:143], v[164:167], v[8:11], 0
    buffer_load_dwordx4 v203, s[8:11], s38 offen offset:3072 nt lds
    v_max3_f32 v221, v236, v237, v221
    v_max3_f32 v221, v238, v239, v221
    v_mfma_f32_16x16x32_bf16 a[128:131], v[168:171], v[16:19], a[128:131]
    s_waitcnt lgkmcnt(8)
    ds_read_b64 v[160:161], v212 offset:24576
    ds_read_b64 v[162:163], v213 offset:24576
    v_mfma_f32_16x16x32_bf16 a[136:139], v[168:171], v[24:27], a[136:139]
    v_accvgpr_read_b32 v224, a112
    v_accvgpr_read_b32 v225, a113
    v_mfma_f32_16x16x32_bf16 a[132:135], v[172:175], v[16:19], a[132:135]
    s_waitcnt lgkmcnt(8)
    ds_read_b64 v[164:165], v212 offset:26624
    ds_read_b64 v[166:167], v213 offset:26624
    v_mfma_f32_16x16x32_bf16 a[140:143], v[172:175], v[24:27], a[140:143]
    v_accvgpr_read_b32 v226, a114
    v_accvgpr_read_b32 v227, a115
    v_mfma_f32_16x16x32_bf16 a[128:131], v[176:179], v[32:35], a[128:131]
    s_waitcnt lgkmcnt(8)
    ds_read_b64 v[168:169], v214 offset:24576
    ds_read_b64 v[170:171], v215 offset:24576
    v_mfma_f32_16x16x32_bf16 a[136:139], v[176:179], v[40:43], a[136:139]
    v_max3_f32 v220, v224, v225, v220
    v_accvgpr_read_b32 v228, a116
    v_mfma_f32_16x16x32_bf16 a[132:135], v[180:183], v[32:35], a[132:135]
    s_waitcnt lgkmcnt(8)
    ds_read_b64 v[172:173], v214 offset:26624
    ds_read_b64 v[174:175], v215 offset:26624
    v_mfma_f32_16x16x32_bf16 a[140:143], v[180:183], v[40:43], a[140:143]
    v_accvgpr_read_b32 v229, a117
    v_max3_f32 v220, v226, v227, v220
    v_mfma_f32_16x16x32_bf16 a[128:131], v[184:187], v[48:51], a[128:131]
    s_waitcnt lgkmcnt(8)
    ds_read_b64 v[176:177], v212 offset:28672
    ds_read_b64 v[178:179], v213 offset:28672
    v_mfma_f32_16x16x32_bf16 a[136:139], v[184:187], v[56:59], a[136:139]
    v_accvgpr_read_b32 v230, a118
    v_accvgpr_read_b32 v231, a119
    v_mfma_f32_16x16x32_bf16 a[132:135], v[188:191], v[48:51], a[132:135]
    s_waitcnt lgkmcnt(8)
    ds_read_b64 v[180:181], v212 offset:30720
    ds_read_b64 v[182:183], v213 offset:30720
    v_mfma_f32_16x16x32_bf16 a[140:143], v[188:191], v[56:59], a[140:143]
    v_add_u32 v212, 4294836224, v212
    v_add_u32 v213, 4294836224, v213
    v_mfma_f32_16x16x32_bf16 a[128:131], v[160:163], v[64:67], a[128:131]
    s_waitcnt lgkmcnt(8)
    ds_read_b64 v[184:185], v214 offset:28672
    ds_read_b64 v[186:187], v215 offset:28672
    v_mfma_f32_16x16x32_bf16 a[136:139], v[160:163], v[72:75], a[136:139]
    v_max3_f32 v220, v228, v229, v220
    v_accvgpr_read_b32 v232, a120
    v_mfma_f32_16x16x32_bf16 a[132:135], v[164:167], v[64:67], a[132:135]
    s_waitcnt lgkmcnt(8)
    ds_read_b64 v[188:189], v214 offset:30720
    ds_read_b64 v[190:191], v215 offset:30720
    v_mfma_f32_16x16x32_bf16 a[140:143], v[164:167], v[72:75], a[140:143]
    s_barrier
    v_add_u32 v214, 4294836224, v214
    v_add_u32 v215, 4294836224, v215
    v_mfma_f32_16x16x32_bf16 a[128:131], v[168:171], v[80:83], a[128:131]
    s_waitcnt lgkmcnt(8)
    ds_read_b64 v[160:161], v212 offset:0
    ds_read_b64 v[162:163], v213 offset:0
    v_mfma_f32_16x16x32_bf16 a[136:139], v[168:171], v[88:91], a[136:139]
    v_accvgpr_read_b32 v233, a121
    v_max3_f32 v220, v230, v231, v220
    v_mfma_f32_16x16x32_bf16 a[132:135], v[172:175], v[80:83], a[132:135]
    s_waitcnt lgkmcnt(8)
    ds_read_b64 v[164:165], v212 offset:2048
    ds_read_b64 v[166:167], v213 offset:2048
    v_mfma_f32_16x16x32_bf16 a[140:143], v[172:175], v[88:91], a[140:143]
    v_accvgpr_read_b32 v234, a122
    v_accvgpr_read_b32 v235, a123
    v_mfma_f32_16x16x32_bf16 a[128:131], v[176:179], v[96:99], a[128:131]
    s_waitcnt lgkmcnt(8)
    ds_read_b64 v[168:169], v214 offset:0
    ds_read_b64 v[170:171], v215 offset:0
    v_mfma_f32_16x16x32_bf16 a[136:139], v[176:179], v[104:107], a[136:139]
    v_max3_f32 v221, v232, v233, v221
    v_accvgpr_read_b32 v236, a124
    v_mfma_f32_16x16x32_bf16 a[132:135], v[180:183], v[96:99], a[132:135]
    s_waitcnt lgkmcnt(8)
    ds_read_b64 v[172:173], v214 offset:2048
    ds_read_b64 v[174:175], v215 offset:2048
    v_mfma_f32_16x16x32_bf16 a[140:143], v[180:183], v[104:107], a[140:143]
    v_accvgpr_read_b32 v237, a125
    v_max3_f32 v221, v234, v235, v221
    v_mfma_f32_16x16x32_bf16 a[128:131], v[184:187], v[112:115], a[128:131]
    s_waitcnt lgkmcnt(8)
    ds_read_b64 v[176:177], v212 offset:4096
    ds_read_b64 v[178:179], v213 offset:4096
    v_mfma_f32_16x16x32_bf16 a[136:139], v[184:187], v[120:123], a[136:139]
    v_accvgpr_read_b32 v238, a126
    v_accvgpr_read_b32 v239, a127
    v_mfma_f32_16x16x32_bf16 a[132:135], v[188:191], v[112:115], a[132:135]
    s_waitcnt lgkmcnt(8)
    ds_read_b64 v[180:181], v212 offset:6144
    ds_read_b64 v[182:183], v213 offset:6144
    v_mfma_f32_16x16x32_bf16 a[140:143], v[188:191], v[120:123], a[140:143]
    v_max3_f32 v221, v236, v237, v221
    v_max3_f32 v221, v238, v239, v221
    v_mfma_f32_16x16x32_bf16 a[144:147], v[160:163], v[0:3], 0
    s_waitcnt lgkmcnt(8)
    ds_read_b64 v[184:185], v214 offset:4096
    ds_read_b64 v[186:187], v215 offset:4096
    v_mfma_f32_16x16x32_bf16 a[152:155], v[160:163], v[8:11], 0
    v_mfma_f32_16x16x32_bf16 a[148:151], v[164:167], v[0:3], 0
    s_waitcnt lgkmcnt(8)
    ds_read_b64 v[188:189], v214 offset:6144
    ds_read_b64 v[190:191], v215 offset:6144
    v_mfma_f32_16x16x32_bf16 a[156:159], v[164:167], v[8:11], 0
    v_mfma_f32_16x16x32_bf16 a[144:147], v[168:171], v[16:19], a[144:147]
    s_waitcnt lgkmcnt(8)
    ds_read_b64 v[160:161], v212 offset:8192
    ds_read_b64 v[162:163], v213 offset:8192
    v_mfma_f32_16x16x32_bf16 a[152:155], v[168:171], v[24:27], a[152:155]
    v_accvgpr_read_b32 v224, a128
    v_accvgpr_read_b32 v225, a129
    v_mfma_f32_16x16x32_bf16 a[148:151], v[172:175], v[16:19], a[148:151]
    s_waitcnt lgkmcnt(8)
    ds_read_b64 v[164:165], v212 offset:10240
    ds_read_b64 v[166:167], v213 offset:10240
    v_mfma_f32_16x16x32_bf16 a[156:159], v[172:175], v[24:27], a[156:159]
    v_accvgpr_read_b32 v226, a130
    v_accvgpr_read_b32 v227, a131
    v_mfma_f32_16x16x32_bf16 a[144:147], v[176:179], v[32:35], a[144:147]
    s_waitcnt lgkmcnt(8)
    ds_read_b64 v[168:169], v214 offset:8192
    ds_read_b64 v[170:171], v215 offset:8192
    v_mfma_f32_16x16x32_bf16 a[152:155], v[176:179], v[40:43], a[152:155]
    v_max3_f32 v220, v224, v225, v220
    v_accvgpr_read_b32 v228, a132
    v_mfma_f32_16x16x32_bf16 a[148:151], v[180:183], v[32:35], a[148:151]
    s_waitcnt lgkmcnt(8)
    ds_read_b64 v[172:173], v214 offset:10240
    ds_read_b64 v[174:175], v215 offset:10240
    v_mfma_f32_16x16x32_bf16 a[156:159], v[180:183], v[40:43], a[156:159]
    v_accvgpr_read_b32 v229, a133
    v_max3_f32 v220, v226, v227, v220
    v_mfma_f32_16x16x32_bf16 a[144:147], v[184:187], v[48:51], a[144:147]
    s_waitcnt lgkmcnt(8)
    ds_read_b64 v[176:177], v212 offset:12288
    ds_read_b64 v[178:179], v213 offset:12288
    v_mfma_f32_16x16x32_bf16 a[152:155], v[184:187], v[56:59], a[152:155]
    v_accvgpr_read_b32 v230, a134
    v_accvgpr_read_b32 v231, a135
    v_mfma_f32_16x16x32_bf16 a[148:151], v[188:191], v[48:51], a[148:151]
    s_waitcnt lgkmcnt(8)
    ds_read_b64 v[180:181], v212 offset:14336
    ds_read_b64 v[182:183], v213 offset:14336
    v_mfma_f32_16x16x32_bf16 a[156:159], v[188:191], v[56:59], a[156:159]
    v_max3_f32 v220, v228, v229, v220
    v_accvgpr_read_b32 v232, a136
    v_mfma_f32_16x16x32_bf16 a[144:147], v[160:163], v[64:67], a[144:147]
    s_waitcnt lgkmcnt(8)
    ds_read_b64 v[184:185], v214 offset:12288
    ds_read_b64 v[186:187], v215 offset:12288
    v_mfma_f32_16x16x32_bf16 a[152:155], v[160:163], v[72:75], a[152:155]
    v_accvgpr_read_b32 v233, a137
    v_max3_f32 v220, v230, v231, v220
    v_mfma_f32_16x16x32_bf16 a[148:151], v[164:167], v[64:67], a[148:151]
    s_waitcnt lgkmcnt(8)
    ds_read_b64 v[188:189], v214 offset:14336
    ds_read_b64 v[190:191], v215 offset:14336
    v_mfma_f32_16x16x32_bf16 a[156:159], v[164:167], v[72:75], a[156:159]
    s_waitcnt vmcnt(4)
    s_barrier
    v_accvgpr_read_b32 v234, a138
    v_mfma_f32_16x16x32_bf16 a[144:147], v[168:171], v[80:83], a[144:147]
    s_waitcnt lgkmcnt(8)
    ds_read_b64 v[160:161], v212 offset:16384
    ds_read_b64 v[162:163], v213 offset:16384
    v_mfma_f32_16x16x32_bf16 a[152:155], v[168:171], v[88:91], a[152:155]
    s_add_u32 m0, s36, 65536
    s_mov_b32 s38, 196608
    v_accvgpr_read_b32 v235, a139
    v_mfma_f32_16x16x32_bf16 a[148:151], v[172:175], v[80:83], a[148:151]
    s_waitcnt lgkmcnt(8)
    ds_read_b64 v[164:165], v212 offset:18432
    ds_read_b64 v[166:167], v213 offset:18432
    v_mfma_f32_16x16x32_bf16 a[156:159], v[172:175], v[88:91], a[156:159]
    buffer_load_dwordx4 v200, s[8:11], s38 offen offset:0 nt lds
    v_mfma_f32_16x16x32_bf16 a[144:147], v[176:179], v[96:99], a[144:147]
    s_waitcnt lgkmcnt(8)
    ds_read_b64 v[168:169], v214 offset:16384
    ds_read_b64 v[170:171], v215 offset:16384
    v_mfma_f32_16x16x32_bf16 a[152:155], v[176:179], v[104:107], a[152:155]
    v_max3_f32 v221, v232, v233, v221
    v_accvgpr_read_b32 v236, a140
    v_mfma_f32_16x16x32_bf16 a[148:151], v[180:183], v[96:99], a[148:151]
    s_waitcnt lgkmcnt(8)
    ds_read_b64 v[172:173], v214 offset:18432
    ds_read_b64 v[174:175], v215 offset:18432
    v_mfma_f32_16x16x32_bf16 a[156:159], v[180:183], v[104:107], a[156:159]
    buffer_load_dwordx4 v201, s[8:11], s38 offen offset:1024 nt lds
    v_mfma_f32_16x16x32_bf16 a[144:147], v[184:187], v[112:115], a[144:147]
    s_waitcnt lgkmcnt(8)
    ds_read_b64 v[176:177], v212 offset:20480
    ds_read_b64 v[178:179], v213 offset:20480
    v_mfma_f32_16x16x32_bf16 a[152:155], v[184:187], v[120:123], a[152:155]
    v_accvgpr_read_b32 v237, a141
    v_max3_f32 v221, v234, v235, v221
    v_mfma_f32_16x16x32_bf16 a[148:151], v[188:191], v[112:115], a[148:151]
    s_waitcnt lgkmcnt(8)
    ds_read_b64 v[180:181], v212 offset:22528
    ds_read_b64 v[182:183], v213 offset:22528
    v_mfma_f32_16x16x32_bf16 a[156:159], v[188:191], v[120:123], a[156:159]
    buffer_load_dwordx4 v202, s[8:11], s38 offen offset:2048 nt lds
    v_mfma_f32_16x16x32_bf16 a[160:163], v[160:163], v[0:3], 0
    s_waitcnt lgkmcnt(8)
    ds_read_b64 v[184:185], v214 offset:20480
    ds_read_b64 v[186:187], v215 offset:20480
    v_mfma_f32_16x16x32_bf16 a[168:171], v[160:163], v[8:11], 0
    v_accvgpr_read_b32 v238, a142
    v_accvgpr_read_b32 v239, a143
    v_mfma_f32_16x16x32_bf16 a[164:167], v[164:167], v[0:3], 0
    s_waitcnt lgkmcnt(8)
    ds_read_b64 v[188:189], v214 offset:22528
    ds_read_b64 v[190:191], v215 offset:22528
    v_mfma_f32_16x16x32_bf16 a[172:175], v[164:167], v[8:11], 0
    buffer_load_dwordx4 v203, s[8:11], s38 offen offset:3072 nt lds
    v_max3_f32 v221, v236, v237, v221
    v_max3_f32 v221, v238, v239, v221
    v_mfma_f32_16x16x32_bf16 a[160:163], v[168:171], v[16:19], a[160:163]
    s_waitcnt lgkmcnt(8)
    ds_read_b64 v[160:161], v212 offset:24576
    ds_read_b64 v[162:163], v213 offset:24576
    v_mfma_f32_16x16x32_bf16 a[168:171], v[168:171], v[24:27], a[168:171]
    v_accvgpr_read_b32 v224, a144
    v_accvgpr_read_b32 v225, a145
    v_mfma_f32_16x16x32_bf16 a[164:167], v[172:175], v[16:19], a[164:167]
    s_waitcnt lgkmcnt(8)
    ds_read_b64 v[164:165], v212 offset:26624
    ds_read_b64 v[166:167], v213 offset:26624
    v_mfma_f32_16x16x32_bf16 a[172:175], v[172:175], v[24:27], a[172:175]
    v_accvgpr_read_b32 v226, a146
    v_accvgpr_read_b32 v227, a147
    v_mfma_f32_16x16x32_bf16 a[160:163], v[176:179], v[32:35], a[160:163]
    s_waitcnt lgkmcnt(8)
    ds_read_b64 v[168:169], v214 offset:24576
    ds_read_b64 v[170:171], v215 offset:24576
    v_mfma_f32_16x16x32_bf16 a[168:171], v[176:179], v[40:43], a[168:171]
    v_max3_f32 v220, v224, v225, v220
    v_accvgpr_read_b32 v228, a148
    v_mfma_f32_16x16x32_bf16 a[164:167], v[180:183], v[32:35], a[164:167]
    s_waitcnt lgkmcnt(8)
    ds_read_b64 v[172:173], v214 offset:26624
    ds_read_b64 v[174:175], v215 offset:26624
    v_mfma_f32_16x16x32_bf16 a[172:175], v[180:183], v[40:43], a[172:175]
    v_accvgpr_read_b32 v229, a149
    v_max3_f32 v220, v226, v227, v220
    v_mfma_f32_16x16x32_bf16 a[160:163], v[184:187], v[48:51], a[160:163]
    s_waitcnt lgkmcnt(8)
    ds_read_b64 v[176:177], v212 offset:28672
    ds_read_b64 v[178:179], v213 offset:28672
    v_mfma_f32_16x16x32_bf16 a[168:171], v[184:187], v[56:59], a[168:171]
    v_accvgpr_read_b32 v230, a150
    v_accvgpr_read_b32 v231, a151
    v_mfma_f32_16x16x32_bf16 a[164:167], v[188:191], v[48:51], a[164:167]
    s_waitcnt lgkmcnt(8)
    ds_read_b64 v[180:181], v212 offset:30720
    ds_read_b64 v[182:183], v213 offset:30720
    v_mfma_f32_16x16x32_bf16 a[172:175], v[188:191], v[56:59], a[172:175]
    v_max3_f32 v220, v228, v229, v220
    v_accvgpr_read_b32 v232, a152
    v_mfma_f32_16x16x32_bf16 a[160:163], v[160:163], v[64:67], a[160:163]
    s_waitcnt lgkmcnt(8)
    ds_read_b64 v[184:185], v214 offset:28672
    ds_read_b64 v[186:187], v215 offset:28672
    v_mfma_f32_16x16x32_bf16 a[168:171], v[160:163], v[72:75], a[168:171]
    v_accvgpr_read_b32 v233, a153
    v_max3_f32 v220, v230, v231, v220
    v_mfma_f32_16x16x32_bf16 a[164:167], v[164:167], v[64:67], a[164:167]
    s_waitcnt lgkmcnt(8)
    ds_read_b64 v[188:189], v214 offset:30720
    ds_read_b64 v[190:191], v215 offset:30720
    v_mfma_f32_16x16x32_bf16 a[172:175], v[164:167], v[72:75], a[172:175]
    s_waitcnt vmcnt(4)
    s_barrier
    v_accvgpr_read_b32 v234, a154
    v_mfma_f32_16x16x32_bf16 a[160:163], v[168:171], v[80:83], a[160:163]
    s_waitcnt lgkmcnt(8)
    ds_read_b64 v[160:161], v212 offset:32768
    ds_read_b64 v[162:163], v213 offset:32768
    v_mfma_f32_16x16x32_bf16 a[168:171], v[168:171], v[88:91], a[168:171]
    s_add_u32 m0, s36, 81920
    s_mov_b32 s38, 212992
    v_accvgpr_read_b32 v235, a155
    v_mfma_f32_16x16x32_bf16 a[164:167], v[172:175], v[80:83], a[164:167]
    s_waitcnt lgkmcnt(8)
    ds_read_b64 v[164:165], v212 offset:34816
    ds_read_b64 v[166:167], v213 offset:34816
    v_mfma_f32_16x16x32_bf16 a[172:175], v[172:175], v[88:91], a[172:175]
    buffer_load_dwordx4 v200, s[8:11], s38 offen offset:0 nt lds
    v_mfma_f32_16x16x32_bf16 a[160:163], v[176:179], v[96:99], a[160:163]
    s_waitcnt lgkmcnt(8)
    ds_read_b64 v[168:169], v214 offset:32768
    ds_read_b64 v[170:171], v215 offset:32768
    v_mfma_f32_16x16x32_bf16 a[168:171], v[176:179], v[104:107], a[168:171]
    buffer_load_dwordx4 v201, s[8:11], s38 offen offset:1024 nt lds
    v_mfma_f32_16x16x32_bf16 a[164:167], v[180:183], v[96:99], a[164:167]
    s_waitcnt lgkmcnt(8)
    ds_read_b64 v[172:173], v214 offset:34816
    ds_read_b64 v[174:175], v215 offset:34816
    v_mfma_f32_16x16x32_bf16 a[172:175], v[180:183], v[104:107], a[172:175]
    buffer_load_dwordx4 v202, s[8:11], s38 offen offset:2048 nt lds
    v_mfma_f32_16x16x32_bf16 a[160:163], v[184:187], v[112:115], a[160:163]
    s_waitcnt lgkmcnt(8)
    ds_read_b64 v[176:177], v212 offset:36864
    ds_read_b64 v[178:179], v213 offset:36864
    v_mfma_f32_16x16x32_bf16 a[168:171], v[184:187], v[120:123], a[168:171]
    buffer_load_dwordx4 v203, s[8:11], s38 offen offset:3072 nt lds
    v_max3_f32 v221, v232, v233, v221
    v_accvgpr_read_b32 v236, a156
    v_mfma_f32_16x16x32_bf16 a[164:167], v[188:191], v[112:115], a[164:167]
    s_waitcnt lgkmcnt(8)
    ds_read_b64 v[180:181], v212 offset:38912
    ds_read_b64 v[182:183], v213 offset:38912
    v_mfma_f32_16x16x32_bf16 a[172:175], v[188:191], v[120:123], a[172:175]
    v_add_u32 v223, 98304, v222
    v_accvgpr_read_b32 v237, a157
    v_max3_f32 v221, v234, v235, v221
    v_mfma_f32_16x16x32_bf16 a[176:179], v[160:163], v[0:3], 0
    s_waitcnt lgkmcnt(8)
    ds_read_b64 v[184:185], v214 offset:36864
    ds_read_b64 v[186:187], v215 offset:36864
    v_mfma_f32_16x16x32_bf16 a[184:187], v[160:163], v[8:11], 0
    ds_write_b64 v223, a[224:225] offset:0
    v_accvgpr_read_b32 v238, a158
    v_accvgpr_read_b32 v239, a159
    v_mfma_f32_16x16x32_bf16 a[180:183], v[164:167], v[0:3], 0
    s_waitcnt lgkmcnt(9)
    ds_read_b64 v[188:189], v214 offset:38912
    ds_read_b64 v[190:191], v215 offset:38912
    v_mfma_f32_16x16x32_bf16 a[188:191], v[164:167], v[8:11], 0
    ds_write_b64 v223, a[226:227] offset:8
    v_max3_f32 v221, v236, v237, v221
    v_max3_f32 v221, v238, v239, v221
    v_mfma_f32_16x16x32_bf16 a[176:179], v[168:171], v[16:19], a[176:179]
    s_waitcnt lgkmcnt(10)
    ds_read_b64 v[160:161], v212 offset:40960
    ds_read_b64 v[162:163], v213 offset:40960
    v_mfma_f32_16x16x32_bf16 a[184:187], v[168:171], v[24:27], a[184:187]
    ds_write_b64 v223, a[228:229] offset:1024
    v_mfma_f32_16x16x32_bf16 a[180:183], v[172:175], v[16:19], a[180:183]
    s_waitcnt lgkmcnt(11)
    ds_read_b64 v[164:165], v212 offset:43008
    ds_read_b64 v[166:167], v213 offset:43008
    v_mfma_f32_16x16x32_bf16 a[188:191], v[172:175], v[24:27], a[188:191]
    ds_write_b64 v223, a[230:231] offset:1032
    v_mfma_f32_16x16x32_bf16 a[176:179], v[176:179], v[32:35], a[176:179]
    s_waitcnt lgkmcnt(12)
    ds_read_b64 v[168:169], v214 offset:40960
    ds_read_b64 v[170:171], v215 offset:40960
    v_mfma_f32_16x16x32_bf16 a[184:187], v[176:179], v[40:43], a[184:187]
    ds_write_b64 v223, a[232:233] offset:2048
    v_mfma_f32_16x16x32_bf16 a[180:183], v[180:183], v[32:35], a[180:183]
    s_waitcnt lgkmcnt(13)
    ds_read_b64 v[172:173], v214 offset:43008
    ds_read_b64 v[174:175], v215 offset:43008
    v_mfma_f32_16x16x32_bf16 a[188:191], v[180:183], v[40:43], a[188:191]
    ds_write_b64 v223, a[234:235] offset:2056
    v_mfma_f32_16x16x32_bf16 a[176:179], v[184:187], v[48:51], a[176:179]
    s_waitcnt lgkmcnt(13)
    ds_read_b64 v[176:177], v212 offset:45056
    ds_read_b64 v[178:179], v213 offset:45056
    v_mfma_f32_16x16x32_bf16 a[184:187], v[184:187], v[56:59], a[184:187]
    ds_write_b64 v223, a[236:237] offset:3072
    v_accvgpr_read_b32 v224, a160
    v_accvgpr_read_b32 v225, a161
    v_mfma_f32_16x16x32_bf16 a[180:183], v[188:191], v[48:51], a[180:183]
    s_waitcnt lgkmcnt(13)
    ds_read_b64 v[180:181], v212 offset:47104
    ds_read_b64 v[182:183], v213 offset:47104
    v_mfma_f32_16x16x32_bf16 a[188:191], v[188:191], v[56:59], a[188:191]
    v_add_u32 v212, 65536, v212
    v_add_u32 v213, 65536, v213
    v_accvgpr_read_b32 v226, a162
    v_accvgpr_read_b32 v227, a163
    v_mfma_f32_16x16x32_bf16 a[176:179], v[160:163], v[64:67], a[176:179]
    s_waitcnt lgkmcnt(12)
    ds_read_b64 v[184:185], v214 offset:45056
    ds_read_b64 v[186:187], v215 offset:45056
    v_mfma_f32_16x16x32_bf16 a[184:187], v[160:163], v[72:75], a[184:187]
    ds_write_b64 v223, a[238:239] offset:3080
    v_max3_f32 v220, v224, v225, v220
    v_accvgpr_read_b32 v228, a164
    v_mfma_f32_16x16x32_bf16 a[180:183], v[164:167], v[64:67], a[180:183]
    s_waitcnt lgkmcnt(12)
    ds_read_b64 v[188:189], v214 offset:47104
    ds_read_b64 v[190:191], v215 offset:47104
    v_mfma_f32_16x16x32_bf16 a[188:191], v[164:167], v[72:75], a[188:191]
    s_waitcnt vmcnt(4)
    s_barrier
    v_add_u32 v214, 65536, v214
    v_add_u32 v215, 65536, v215
    v_accvgpr_read_b32 v229, a165
    v_max3_f32 v220, v226, v227, v220
    v_mfma_f32_16x16x32_bf16 a[176:179], v[168:171], v[80:83], a[176:179]
    s_waitcnt lgkmcnt(11)
    ds_read_b64 v[160:161], v212 offset:0
    ds_read_b64 v[162:163], v213 offset:0
    v_mfma_f32_16x16x32_bf16 a[184:187], v[168:171], v[88:91], a[184:187]
    s_add_u32 m0, s36, 114688
    s_mov_b32 s38, 245760
    v_accvgpr_read_b32 v230, a166
    v_accvgpr_read_b32 v231, a167
    v_mfma_f32_16x16x32_bf16 a[180:183], v[172:175], v[80:83], a[180:183]
    s_waitcnt lgkmcnt(10)
    ds_read_b64 v[164:165], v212 offset:2048
    ds_read_b64 v[166:167], v213 offset:2048
    v_mfma_f32_16x16x32_bf16 a[188:191], v[172:175], v[88:91], a[188:191]
    buffer_load_dwordx4 v200, s[8:11], s38 offen offset:0 nt lds
    v_max3_f32 v220, v228, v229, v220
    v_accvgpr_read_b32 v232, a168
    v_mfma_f32_16x16x32_bf16 a[176:179], v[176:179], v[96:99], a[176:179]
    s_waitcnt lgkmcnt(9)
    ds_read_b64 v[168:169], v214 offset:0
    ds_read_b64 v[170:171], v215 offset:0
    v_mfma_f32_16x16x32_bf16 a[184:187], v[176:179], v[104:107], a[184:187]
    v_accvgpr_read_b32 v233, a169
    v_max3_f32 v220, v230, v231, v220
    v_mfma_f32_16x16x32_bf16 a[180:183], v[180:183], v[96:99], a[180:183]
    s_waitcnt lgkmcnt(9)
    ds_read_b64 v[172:173], v214 offset:2048
    ds_read_b64 v[174:175], v215 offset:2048
    v_mfma_f32_16x16x32_bf16 a[188:191], v[180:183], v[104:107], a[188:191]
    buffer_load_dwordx4 v201, s[8:11], s38 offen offset:1024 nt lds
    v_accvgpr_read_b32 v234, a170
    v_accvgpr_read_b32 v235, a171
    v_mfma_f32_16x16x32_bf16 a[176:179], v[184:187], v[112:115], a[176:179]
    s_waitcnt lgkmcnt(8)
    ds_read_b64 v[176:177], v212 offset:4096
    ds_read_b64 v[178:179], v213 offset:4096
    v_mfma_f32_16x16x32_bf16 a[184:187], v[184:187], v[120:123], a[184:187]
    v_max3_f32 v221, v232, v233, v221
    v_accvgpr_read_b32 v236, a172
    v_mfma_f32_16x16x32_bf16 a[180:183], v[188:191], v[112:115], a[180:183]
    s_waitcnt lgkmcnt(8)
    ds_read_b64 v[180:181], v212 offset:6144
    ds_read_b64 v[182:183], v213 offset:6144
    v_mfma_f32_16x16x32_bf16 a[188:191], v[188:191], v[120:123], a[188:191]
    buffer_load_dwordx4 v202, s[8:11], s38 offen offset:2048 nt lds
    v_accvgpr_read_b32 v237, a173
    v_max3_f32 v221, v234, v235, v221
    v_mfma_f32_16x16x32_bf16 a[192:195], v[160:163], v[0:3], 0
    s_waitcnt lgkmcnt(8)
    ds_read_b64 v[184:185], v214 offset:4096
    ds_read_b64 v[186:187], v215 offset:4096
    v_mfma_f32_16x16x32_bf16 a[200:203], v[160:163], v[8:11], 0
    v_accvgpr_read_b32 v238, a174
    v_accvgpr_read_b32 v239, a175
    v_mfma_f32_16x16x32_bf16 a[196:199], v[164:167], v[0:3], 0
    s_waitcnt lgkmcnt(8)
    ds_read_b64 v[188:189], v214 offset:6144
    ds_read_b64 v[190:191], v215 offset:6144
    v_mfma_f32_16x16x32_bf16 a[204:207], v[164:167], v[8:11], 0
    buffer_load_dwordx4 v203, s[8:11], s38 offen offset:3072 nt lds
    v_max3_f32 v221, v236, v237, v221
    v_max3_f32 v221, v238, v239, v221
    v_mfma_f32_16x16x32_bf16 a[192:195], v[168:171], v[16:19], a[192:195]
    s_waitcnt lgkmcnt(8)
    ds_read_b64 v[160:161], v212 offset:8192
    ds_read_b64 v[162:163], v213 offset:8192
    v_mfma_f32_16x16x32_bf16 a[200:203], v[168:171], v[24:27], a[200:203]
    v_accvgpr_read_b32 v224, a176
    v_accvgpr_read_b32 v225, a177
    v_mfma_f32_16x16x32_bf16 a[196:199], v[172:175], v[16:19], a[196:199]
    s_waitcnt lgkmcnt(8)
    ds_read_b64 v[164:165], v212 offset:10240
    ds_read_b64 v[166:167], v213 offset:10240
    v_mfma_f32_16x16x32_bf16 a[204:207], v[172:175], v[24:27], a[204:207]
    v_accvgpr_read_b32 v226, a178
    v_accvgpr_read_b32 v227, a179
    v_mfma_f32_16x16x32_bf16 a[192:195], v[176:179], v[32:35], a[192:195]
    s_waitcnt lgkmcnt(8)
    ds_read_b64 v[168:169], v214 offset:8192
    ds_read_b64 v[170:171], v215 offset:8192
    v_mfma_f32_16x16x32_bf16 a[200:203], v[176:179], v[40:43], a[200:203]
    v_max3_f32 v220, v224, v225, v220
    v_accvgpr_read_b32 v228, a180
    v_mfma_f32_16x16x32_bf16 a[196:199], v[180:183], v[32:35], a[196:199]
    s_waitcnt lgkmcnt(8)
    ds_read_b64 v[172:173], v214 offset:10240
    ds_read_b64 v[174:175], v215 offset:10240
    v_mfma_f32_16x16x32_bf16 a[204:207], v[180:183], v[40:43], a[204:207]
    v_accvgpr_read_b32 v229, a181
    v_max3_f32 v220, v226, v227, v220
    v_mfma_f32_16x16x32_bf16 a[192:195], v[184:187], v[48:51], a[192:195]
    s_waitcnt lgkmcnt(8)
    ds_read_b64 v[176:177], v212 offset:12288
    ds_read_b64 v[178:179], v213 offset:12288
    v_mfma_f32_16x16x32_bf16 a[200:203], v[184:187], v[56:59], a[200:203]
    v_accvgpr_read_b32 v230, a182
    v_accvgpr_read_b32 v231, a183
    v_mfma_f32_16x16x32_bf16 a[196:199], v[188:191], v[48:51], a[196:199]
    s_waitcnt lgkmcnt(8)
    ds_read_b64 v[180:181], v212 offset:14336
    ds_read_b64 v[182:183], v213 offset:14336
    v_mfma_f32_16x16x32_bf16 a[204:207], v[188:191], v[56:59], a[204:207]
    v_max3_f32 v220, v228, v229, v220
    v_accvgpr_read_b32 v232, a184
    v_mfma_f32_16x16x32_bf16 a[192:195], v[160:163], v[64:67], a[192:195]
    s_waitcnt lgkmcnt(8)
    ds_read_b64 v[184:185], v214 offset:12288
    ds_read_b64 v[186:187], v215 offset:12288
    v_mfma_f32_16x16x32_bf16 a[200:203], v[160:163], v[72:75], a[200:203]
    v_accvgpr_read_b32 v233, a185
    v_max3_f32 v220, v230, v231, v220
    v_mfma_f32_16x16x32_bf16 a[196:199], v[164:167], v[64:67], a[196:199]
    s_waitcnt lgkmcnt(8)
    ds_read_b64 v[188:189], v214 offset:14336
    ds_read_b64 v[190:191], v215 offset:14336
    v_mfma_f32_16x16x32_bf16 a[204:207], v[164:167], v[72:75], a[204:207]
    s_waitcnt vmcnt(4)
    s_barrier
    v_accvgpr_read_b32 v234, a186
    v_mfma_f32_16x16x32_bf16 a[192:195], v[168:171], v[80:83], a[192:195]
    s_waitcnt lgkmcnt(8)
    ds_read_b64 v[160:161], v212 offset:16384
    ds_read_b64 v[162:163], v213 offset:16384
    v_mfma_f32_16x16x32_bf16 a[200:203], v[168:171], v[88:91], a[200:203]
    s_add_u32 m0, s36, 131072
    v_accvgpr_read_b32 v235, a187
    v_max3_f32 v221, v232, v233, v221
    v_mfma_f32_16x16x32_bf16 a[196:199], v[172:175], v[80:83], a[196:199]
    s_waitcnt lgkmcnt(8)
    ds_read_b64 v[164:165], v212 offset:18432
    ds_read_b64 v[166:167], v213 offset:18432
    v_mfma_f32_16x16x32_bf16 a[204:207], v[172:175], v[88:91], a[204:207]
    buffer_load_dwordx4 v204, s[12:15], 0 offen offset:0 nt lds
    v_mfma_f32_16x16x32_bf16 a[192:195], v[176:179], v[96:99], a[192:195]
    s_waitcnt lgkmcnt(8)
    ds_read_b64 v[168:169], v214 offset:16384
    ds_read_b64 v[170:171], v215 offset:16384
    v_mfma_f32_16x16x32_bf16 a[200:203], v[176:179], v[104:107], a[200:203]
    buffer_load_dwordx4 v205, s[12:15], 0 offen offset:1024 nt lds
    v_mfma_f32_16x16x32_bf16 a[196:199], v[180:183], v[96:99], a[196:199]
    s_waitcnt lgkmcnt(8)
    ds_read_b64 v[172:173], v214 offset:18432
    ds_read_b64 v[174:175], v215 offset:18432
    v_mfma_f32_16x16x32_bf16 a[204:207], v[180:183], v[104:107], a[204:207]
    buffer_load_dwordx4 v206, s[12:15], 0 offen offset:2048 nt lds
    v_mfma_f32_16x16x32_bf16 a[192:195], v[184:187], v[112:115], a[192:195]
    s_waitcnt lgkmcnt(8)
    ds_read_b64 v[176:177], v212 offset:20480
    ds_read_b64 v[178:179], v213 offset:20480
    v_mfma_f32_16x16x32_bf16 a[200:203], v[184:187], v[120:123], a[200:203]
    buffer_load_dwordx4 v207, s[12:15], 0 offen offset:3072 nt lds
    v_accvgpr_read_b32 v236, a188
    v_accvgpr_read_b32 v237, a189
    v_max3_f32 v221, v234, v235, v221
    v_accvgpr_read_b32 v238, a190
    v_accvgpr_read_b32 v239, a191
    v_max3_f32 v221, v236, v237, v221
    v_max3_f32 v221, v238, v239, v221
    v_mfma_f32_16x16x32_bf16 a[196:199], v[188:191], v[112:115], a[196:199]
    s_waitcnt lgkmcnt(8)
    ds_read_b64 v[180:181], v212 offset:22528
    ds_read_b64 v[182:183], v213 offset:22528
    v_mfma_f32_16x16x32_bf16 a[204:207], v[188:191], v[120:123], a[204:207]
    s_add_u32 m0, s36, 49152
    v_mfma_f32_16x16x32_bf16 a[208:211], v[160:163], v[0:3], 0
    s_waitcnt lgkmcnt(8)
    ds_read_b64 v[184:185], v214 offset:20480
    ds_read_b64 v[186:187], v215 offset:20480
    v_mfma_f32_16x16x32_bf16 a[216:219], v[160:163], v[8:11], 0
    buffer_load_dwordx4 v208, s[20:23], s64 offen offset:0 lds
    v_mfma_f32_16x16x32_bf16 a[212:215], v[164:167], v[0:3], 0
    s_waitcnt lgkmcnt(8)
    ds_read_b64 v[188:189], v214 offset:22528
    ds_read_b64 v[190:191], v215 offset:22528
    v_mfma_f32_16x16x32_bf16 a[220:223], v[164:167], v[8:11], 0
    v_mfma_f32_16x16x32_bf16 a[208:211], v[168:171], v[16:19], a[208:211]
    s_waitcnt lgkmcnt(8)
    ds_read_b64 v[160:161], v212 offset:24576
    ds_read_b64 v[162:163], v213 offset:24576
    v_mfma_f32_16x16x32_bf16 a[216:219], v[168:171], v[24:27], a[216:219]
    buffer_load_dwordx4 v209, s[20:23], s64 offen offset:1024 lds
    v_accvgpr_read_b32 v224, a192
    v_accvgpr_read_b32 v225, a193
    v_accvgpr_read_b32 v226, a194
    v_accvgpr_read_b32 v227, a195
    v_max3_f32 v220, v224, v225, v220
    v_accvgpr_read_b32 v228, a196
    v_accvgpr_read_b32 v229, a197
    v_max3_f32 v220, v226, v227, v220
    v_accvgpr_read_b32 v230, a198
    v_accvgpr_read_b32 v231, a199
    v_max3_f32 v220, v228, v229, v220
    v_mfma_f32_16x16x32_bf16 a[212:215], v[172:175], v[16:19], a[212:215]
    s_waitcnt lgkmcnt(8)
    ds_read_b64 v[164:165], v212 offset:26624
    ds_read_b64 v[166:167], v213 offset:26624
    v_mfma_f32_16x16x32_bf16 a[220:223], v[172:175], v[24:27], a[220:223]
    v_accvgpr_read_b32 v232, a200
    v_accvgpr_read_b32 v233, a201
    v_mfma_f32_16x16x32_bf16 a[208:211], v[176:179], v[32:35], a[208:211]
    s_waitcnt lgkmcnt(8)
    ds_read_b64 v[168:169], v214 offset:24576
    ds_read_b64 v[170:171], v215 offset:24576
    v_mfma_f32_16x16x32_bf16 a[216:219], v[176:179], v[40:43], a[216:219]
    buffer_load_dwordx4 v210, s[20:23], s64 offen offset:2048 lds
    v_max3_f32 v220, v230, v231, v220
    v_accvgpr_read_b32 v234, a202
    v_mfma_f32_16x16x32_bf16 a[212:215], v[180:183], v[32:35], a[212:215]
    s_waitcnt lgkmcnt(8)
    ds_read_b64 v[172:173], v214 offset:26624
    ds_read_b64 v[174:175], v215 offset:26624
    v_mfma_f32_16x16x32_bf16 a[220:223], v[180:183], v[40:43], a[220:223]
    v_accvgpr_read_b32 v235, a203
    v_max3_f32 v221, v232, v233, v221
    v_mfma_f32_16x16x32_bf16 a[208:211], v[184:187], v[48:51], a[208:211]
    s_waitcnt lgkmcnt(8)
    ds_read_b64 v[176:177], v212 offset:28672
    ds_read_b64 v[178:179], v213 offset:28672
    v_mfma_f32_16x16x32_bf16 a[216:219], v[184:187], v[56:59], a[216:219]
    buffer_load_dwordx4 v211, s[20:23], s64 offen offset:3072 lds
    v_accvgpr_read_b32 v236, a204
    v_accvgpr_read_b32 v237, a205
    v_mfma_f32_16x16x32_bf16 a[212:215], v[188:191], v[48:51], a[212:215]
    s_waitcnt lgkmcnt(8)
    ds_read_b64 v[180:181], v212 offset:30720
    ds_read_b64 v[182:183], v213 offset:30720
    v_mfma_f32_16x16x32_bf16 a[220:223], v[188:191], v[56:59], a[220:223]
    v_max3_f32 v221, v234, v235, v221
    v_accvgpr_read_b32 v238, a206
    v_mfma_f32_16x16x32_bf16 a[208:211], v[160:163], v[64:67], a[208:211]
    s_waitcnt lgkmcnt(8)
    ds_read_b64 v[184:185], v214 offset:28672
    ds_read_b64 v[186:187], v215 offset:28672
    v_mfma_f32_16x16x32_bf16 a[216:219], v[160:163], v[72:75], a[216:219]
L_pf1:
    s_bfe_u32 s7, s2, 0x20003
    s_lshl_b32 s7, s7, 2
    s_add_u32 s7, s7, s35
    s_lshl_b32 s7, s7, 10
    s_add_u32 s7, s7, L_pf1 - concat_heads__mha_block_cached__mha_block_cached__near_ridge_kernel + 3072
    v_lshlrev_b32 v194, 6, v243
    v_add_u32 v194, s7, v194
    v_min_u32 v194, CODE_END_OFF - 64, v194
    s_mov_b64 exec, 0xffff
    global_load_dword v194, v194, s[92:93]
    s_mov_b64 exec, -1
    v_accvgpr_read_b32 v239, a207
    v_max3_f32 v221, v236, v237, v221
    v_mfma_f32_16x16x32_bf16 a[212:215], v[164:167], v[64:67], a[212:215]
    s_waitcnt lgkmcnt(8)
    ds_read_b64 v[188:189], v214 offset:30720
    ds_read_b64 v[190:191], v215 offset:30720
    v_mfma_f32_16x16x32_bf16 a[220:223], v[164:167], v[72:75], a[220:223]
    s_barrier
    v_max3_f32 v221, v238, v239, v221
    s_lshr_b32 s5, s34, 3
    v_mfma_f32_16x16x32_bf16 a[208:211], v[168:171], v[80:83], a[208:211]
    s_waitcnt lgkmcnt(8)
    ds_read_b64 v[160:161], v212 offset:32768
    ds_read_b64 v[162:163], v213 offset:32768
    v_mfma_f32_16x16x32_bf16 a[216:219], v[168:171], v[88:91], a[216:219]
    s_lshl_b32 s5, s5, 14
    s_bfe_u32 s6, s34, 0x10002
    s_lshl_b32 s6, s6, 12
    v_mfma_f32_16x16x32_bf16 a[212:215], v[172:175], v[80:83], a[212:215]
    s_waitcnt lgkmcnt(8)
    ds_read_b64 v[164:165], v212 offset:34816
    ds_read_b64 v[166:167], v213 offset:34816
    v_mfma_f32_16x16x32_bf16 a[220:223], v[172:175], v[88:91], a[220:223]
    s_add_u32 s5, s5, s6
    s_and_b32 s6, s34, 3
    s_lshl_b32 s6, s6, 10
    v_mfma_f32_16x16x32_bf16 a[208:211], v[176:179], v[96:99], a[208:211]
    s_waitcnt lgkmcnt(8)
    ds_read_b64 v[168:169], v214 offset:32768
    ds_read_b64 v[170:171], v215 offset:32768
    v_mfma_f32_16x16x32_bf16 a[216:219], v[176:179], v[104:107], a[216:219]
    s_add_u32 s5, s5, s6
    s_lshl_b32 s6, s35, 8
    s_add_u32 s5, s5, s6
    v_mfma_f32_16x16x32_bf16 a[212:215], v[180:183], v[96:99], a[212:215]
    s_waitcnt lgkmcnt(8)
    ds_read_b64 v[172:173], v214 offset:34816
    ds_read_b64 v[174:175], v215 offset:34816
    v_mfma_f32_16x16x32_bf16 a[220:223], v[180:183], v[104:107], a[220:223]
    s_mov_b32 s6, 262144
    v_mul_lo_u32 v200, v245, s6
    v_lshl_add_u32 v200, v246, 7, v200
    v_mfma_f32_16x16x32_bf16 a[208:211], v[184:187], v[112:115], a[208:211]
    s_waitcnt lgkmcnt(8)
    ds_read_b64 v[176:177], v212 offset:36864
    ds_read_b64 v[178:179], v213 offset:36864
    v_mfma_f32_16x16x32_bf16 a[216:219], v[184:187], v[120:123], a[216:219]
    v_and_b32 v247, 7, v243
    v_lshl_add_u32 v200, v247, 4, v200
    v_add_u32 v200, s5, v200
    s_lshl_b32 s5, s33, 7
    v_mfma_f32_16x16x32_bf16 a[212:215], v[188:191], v[112:115], a[212:215]
    s_waitcnt lgkmcnt(8)
    ds_read_b64 v[180:181], v212 offset:38912
    ds_read_b64 v[182:183], v213 offset:38912
    v_mfma_f32_16x16x32_bf16 a[220:223], v[188:191], v[120:123], a[220:223]
    v_mfma_f32_16x16x32_bf16 a[224:227], v[160:163], v[0:3], 0
    s_waitcnt lgkmcnt(8)
    ds_read_b64 v[184:185], v214 offset:36864
    ds_read_b64 v[186:187], v215 offset:36864
    v_mfma_f32_16x16x32_bf16 a[232:235], v[160:163], v[8:11], 0
    v_mfma_f32_16x16x32_bf16 a[228:231], v[164:167], v[0:3], 0
    s_waitcnt lgkmcnt(8)
    ds_read_b64 v[188:189], v214 offset:38912
    ds_read_b64 v[190:191], v215 offset:38912
    v_mfma_f32_16x16x32_bf16 a[236:239], v[164:167], v[8:11], 0
    v_mfma_f32_16x16x32_bf16 a[224:227], v[168:171], v[16:19], a[224:227]
    s_waitcnt lgkmcnt(8)
    ds_read_b64 v[160:161], v212 offset:40960
    ds_read_b64 v[162:163], v213 offset:40960
    v_mfma_f32_16x16x32_bf16 a[232:235], v[168:171], v[24:27], a[232:235]
    v_accvgpr_read_b32 v224, a208
    v_accvgpr_read_b32 v225, a209
    v_accvgpr_read_b32 v226, a210
    v_accvgpr_read_b32 v227, a211
    v_max3_f32 v220, v224, v225, v220
    v_accvgpr_read_b32 v228, a212
    v_accvgpr_read_b32 v229, a213
    v_max3_f32 v220, v226, v227, v220
    v_accvgpr_read_b32 v230, a214
    v_accvgpr_read_b32 v231, a215
    v_mfma_f32_16x16x32_bf16 a[228:231], v[172:175], v[16:19], a[228:231]
    s_waitcnt lgkmcnt(8)
    ds_read_b64 v[164:165], v212 offset:43008
    ds_read_b64 v[166:167], v213 offset:43008
    v_mfma_f32_16x16x32_bf16 a[236:239], v[172:175], v[24:27], a[236:239]
    v_max3_f32 v220, v228, v229, v220
    v_accvgpr_read_b32 v232, a216
    v_mfma_f32_16x16x32_bf16 a[224:227], v[176:179], v[32:35], a[224:227]
    s_waitcnt lgkmcnt(8)
    ds_read_b64 v[168:169], v214 offset:40960
    ds_read_b64 v[170:171], v215 offset:40960
    v_mfma_f32_16x16x32_bf16 a[232:235], v[176:179], v[40:43], a[232:235]
    v_accvgpr_read_b32 v233, a217
    v_max3_f32 v220, v230, v231, v220
    v_mfma_f32_16x16x32_bf16 a[228:231], v[180:183], v[32:35], a[228:231]
    s_waitcnt lgkmcnt(8)
    ds_read_b64 v[172:173], v214 offset:43008
    ds_read_b64 v[174:175], v215 offset:43008
    v_mfma_f32_16x16x32_bf16 a[236:239], v[180:183], v[40:43], a[236:239]
    v_accvgpr_read_b32 v234, a218
    v_accvgpr_read_b32 v235, a219
    v_mfma_f32_16x16x32_bf16 a[224:227], v[184:187], v[48:51], a[224:227]
    s_waitcnt lgkmcnt(8)
    ds_read_b64 v[176:177], v212 offset:45056
    ds_read_b64 v[178:179], v213 offset:45056
    v_mfma_f32_16x16x32_bf16 a[232:235], v[184:187], v[56:59], a[232:235]
    v_max3_f32 v221, v232, v233, v221
    v_accvgpr_read_b32 v236, a220
    v_mfma_f32_16x16x32_bf16 a[228:231], v[188:191], v[48:51], a[228:231]
    s_waitcnt lgkmcnt(8)
    ds_read_b64 v[180:181], v212 offset:47104
    ds_read_b64 v[182:183], v213 offset:47104
    v_mfma_f32_16x16x32_bf16 a[236:239], v[188:191], v[56:59], a[236:239]
    v_accvgpr_read_b32 v237, a221
    v_max3_f32 v221, v234, v235, v221
    v_mfma_f32_16x16x32_bf16 a[224:227], v[160:163], v[64:67], a[224:227]
    s_waitcnt lgkmcnt(8)
    ds_read_b64 v[184:185], v214 offset:45056
    ds_read_b64 v[186:187], v215 offset:45056
    v_mfma_f32_16x16x32_bf16 a[232:235], v[160:163], v[72:75], a[232:235]
    v_accvgpr_read_b32 v238, a222
    v_accvgpr_read_b32 v239, a223
    v_mfma_f32_16x16x32_bf16 a[228:231], v[164:167], v[64:67], a[228:231]
    s_waitcnt lgkmcnt(8)
    ds_read_b64 v[188:189], v214 offset:47104
    ds_read_b64 v[190:191], v215 offset:47104
    v_mfma_f32_16x16x32_bf16 a[236:239], v[164:167], v[72:75], a[236:239]
    s_waitcnt vmcnt(9)
    s_barrier
    v_max3_f32 v221, v236, v237, v221
    v_max3_f32 v221, v238, v239, v221
    v_mfma_f32_16x16x32_bf16 a[224:227], v[168:171], v[80:83], a[224:227]
    s_waitcnt lgkmcnt(8)
    ds_read_b64 v[160:161], v212 offset:49152
    ds_read_b64 v[162:163], v213 offset:49152
    v_mfma_f32_16x16x32_bf16 a[232:235], v[168:171], v[88:91], a[232:235]
    s_add_u32 m0, s36, 147456
    s_mov_b32 s38, 16384
    s_lshl_b32 s6, s34, 3
    s_add_u32 s5, s5, s6
    v_mfma_f32_16x16x32_bf16 a[228:231], v[172:175], v[80:83], a[228:231]
    s_waitcnt lgkmcnt(8)
    ds_read_b64 v[164:165], v212 offset:51200
    ds_read_b64 v[166:167], v213 offset:51200
    v_mfma_f32_16x16x32_bf16 a[236:239], v[172:175], v[88:91], a[236:239]
    buffer_load_dwordx4 v204, s[12:15], s38 offen offset:0 nt lds
    s_mul_i32 s5, s5, 1792
    s_mul_i32 s6, s32, 896
    v_mfma_f32_16x16x32_bf16 a[224:227], v[176:179], v[96:99], a[224:227]
    s_waitcnt lgkmcnt(8)
    ds_read_b64 v[168:169], v214 offset:49152
    ds_read_b64 v[170:171], v215 offset:49152
    v_mfma_f32_16x16x32_bf16 a[232:235], v[176:179], v[104:107], a[232:235]
    s_add_u32 s5, s5, s6
    s_lshr_b32 s6, s35, 1
    s_lshl_b32 s6, s6, 6
    v_mfma_f32_16x16x32_bf16 a[228:231], v[180:183], v[96:99], a[228:231]
    s_waitcnt lgkmcnt(8)
    ds_read_b64 v[172:173], v214 offset:51200
    ds_read_b64 v[174:175], v215 offset:51200
    v_mfma_f32_16x16x32_bf16 a[236:239], v[180:183], v[104:107], a[236:239]
    buffer_load_dwordx4 v205, s[12:15], s38 offen offset:1024 nt lds
    s_add_u32 s5, s5, s6
    v_mfma_f32_16x16x32_bf16 a[224:227], v[184:187], v[112:115], a[224:227]
    s_waitcnt lgkmcnt(8)
    ds_read_b64 v[176:177], v212 offset:53248
    ds_read_b64 v[178:179], v213 offset:53248
    v_mfma_f32_16x16x32_bf16 a[232:235], v[184:187], v[120:123], a[232:235]
    s_and_b32 s6, s35, 1
    s_lshl_b32 s6, s6, 4
    s_add_u32 s5, s5, s6
    v_mfma_f32_16x16x32_bf16 a[228:231], v[188:191], v[112:115], a[228:231]
    s_waitcnt lgkmcnt(8)
    ds_read_b64 v[180:181], v212 offset:55296
    ds_read_b64 v[182:183], v213 offset:55296
    v_mfma_f32_16x16x32_bf16 a[236:239], v[188:191], v[120:123], a[236:239]
    buffer_load_dwordx4 v206, s[12:15], s38 offen offset:2048 nt lds
    v_mul_u32_u24 v201, 1792, v247
    v_mfma_f32_16x16x32_bf16 a[240:243], v[160:163], v[0:3], 0
    s_waitcnt lgkmcnt(8)
    ds_read_b64 v[184:185], v214 offset:53248
    ds_read_b64 v[186:187], v215 offset:53248
    v_mfma_f32_16x16x32_bf16 a[248:251], v[160:163], v[8:11], 0
    v_lshl_add_u32 v201, v246, 3, v201
    v_and_b32 v246, 1, v245
    v_mfma_f32_16x16x32_bf16 a[244:247], v[164:167], v[0:3], 0
    s_waitcnt lgkmcnt(8)
    ds_read_b64 v[188:189], v214 offset:55296
    ds_read_b64 v[190:191], v215 offset:55296
    v_mfma_f32_16x16x32_bf16 a[252:255], v[164:167], v[8:11], 0
    buffer_load_dwordx4 v207, s[12:15], s38 offen offset:3072 nt lds
    v_lshl_add_u32 v201, v246, 5, v201
    v_add_u32 v201, s5, v201
    v_mfma_f32_16x16x32_bf16 a[240:243], v[168:171], v[16:19], a[240:243]
    s_waitcnt lgkmcnt(8)
    ds_read_b64 v[160:161], v212 offset:57344
    ds_read_b64 v[162:163], v213 offset:57344
    v_mfma_f32_16x16x32_bf16 a[248:251], v[168:171], v[24:27], a[248:251]
    v_accvgpr_read_b32 v224, a224
    v_accvgpr_read_b32 v225, a225
    v_mfma_f32_16x16x32_bf16 a[244:247], v[172:175], v[16:19], a[244:247]
    s_waitcnt lgkmcnt(8)
    ds_read_b64 v[164:165], v212 offset:59392
    ds_read_b64 v[166:167], v213 offset:59392
    v_mfma_f32_16x16x32_bf16 a[252:255], v[172:175], v[24:27], a[252:255]
    v_accvgpr_read_b32 v226, a226
    v_accvgpr_read_b32 v227, a227
    v_mfma_f32_16x16x32_bf16 a[240:243], v[176:179], v[32:35], a[240:243]
    s_waitcnt lgkmcnt(8)
    ds_read_b64 v[168:169], v214 offset:57344
    ds_read_b64 v[170:171], v215 offset:57344
    v_mfma_f32_16x16x32_bf16 a[248:251], v[176:179], v[40:43], a[248:251]
    v_max3_f32 v220, v224, v225, v220
    v_accvgpr_read_b32 v228, a228
    v_mfma_f32_16x16x32_bf16 a[244:247], v[180:183], v[32:35], a[244:247]
    s_waitcnt lgkmcnt(8)
    ds_read_b64 v[172:173], v214 offset:59392
    ds_read_b64 v[174:175], v215 offset:59392
    v_mfma_f32_16x16x32_bf16 a[252:255], v[180:183], v[40:43], a[252:255]
    v_accvgpr_read_b32 v229, a229
    v_max3_f32 v220, v226, v227, v220
    v_mfma_f32_16x16x32_bf16 a[240:243], v[184:187], v[48:51], a[240:243]
    s_waitcnt lgkmcnt(8)
    ds_read_b64 v[176:177], v212 offset:61440
    ds_read_b64 v[178:179], v213 offset:61440
    v_mfma_f32_16x16x32_bf16 a[248:251], v[184:187], v[56:59], a[248:251]
    v_accvgpr_read_b32 v230, a230
    v_accvgpr_read_b32 v231, a231
    v_mfma_f32_16x16x32_bf16 a[244:247], v[188:191], v[48:51], a[244:247]
    s_waitcnt lgkmcnt(8)
    ds_read_b64 v[180:181], v212 offset:63488
    ds_read_b64 v[182:183], v213 offset:63488
    v_mfma_f32_16x16x32_bf16 a[252:255], v[188:191], v[56:59], a[252:255]
    v_max3_f32 v220, v228, v229, v220
    v_accvgpr_read_b32 v232, a232
    v_mfma_f32_16x16x32_bf16 a[240:243], v[160:163], v[64:67], a[240:243]
    s_waitcnt lgkmcnt(8)
    ds_read_b64 v[184:185], v214 offset:61440
    ds_read_b64 v[186:187], v215 offset:61440
    v_mfma_f32_16x16x32_bf16 a[248:251], v[160:163], v[72:75], a[248:251]
    v_accvgpr_read_b32 v233, a233
    v_max3_f32 v220, v230, v231, v220
    v_mfma_f32_16x16x32_bf16 a[244:247], v[164:167], v[64:67], a[244:247]
    s_waitcnt lgkmcnt(8)
    ds_read_b64 v[188:189], v214 offset:63488
    ds_read_b64 v[190:191], v215 offset:63488
    v_mfma_f32_16x16x32_bf16 a[252:255], v[164:167], v[72:75], a[252:255]
    s_waitcnt vmcnt(5)
    s_barrier
    v_accvgpr_read_b32 v234, a234
    v_accvgpr_read_b32 v235, a235
    v_mfma_f32_16x16x32_bf16 a[240:243], v[168:171], v[80:83], a[240:243]
    s_waitcnt lgkmcnt(8)
    v_add_u32 v216, 131072, v216
    ds_read_b64_tr_b16 v[160:161], v216 offset:0
    ds_read_b64_tr_b16 v[162:163], v216 offset:2048
    v_mfma_f32_16x16x32_bf16 a[248:251], v[168:171], v[88:91], a[248:251]
    s_add_u32 m0, s36, 0
    s_mov_b32 s38, 32768
    v_max3_f32 v221, v232, v233, v221
    v_accvgpr_read_b32 v236, a236
    v_mfma_f32_16x16x32_bf16 a[244:247], v[172:175], v[80:83], a[244:247]
    s_waitcnt lgkmcnt(8)
    v_add_u32 v217, 131072, v217
    ds_read_b64_tr_b16 v[164:165], v217 offset:0
    ds_read_b64_tr_b16 v[166:167], v217 offset:2048
    v_mfma_f32_16x16x32_bf16 a[252:255], v[172:175], v[88:91], a[252:255]
    buffer_load_dwordx4 v204, s[12:15], s38 offen offset:0 nt lds
    v_accvgpr_read_b32 v237, a237
    v_max3_f32 v221, v234, v235, v221
    v_mfma_f32_16x16x32_bf16 a[240:243], v[176:179], v[96:99], a[240:243]
    s_waitcnt lgkmcnt(8)
    v_add_u32 v218, 131072, v218
    ds_read_b64_tr_b16 v[168:169], v218 offset:0
    ds_read_b64_tr_b16 v[170:171], v218 offset:2048
    v_mfma_f32_16x16x32_bf16 a[248:251], v[176:179], v[104:107], a[248:251]
    v_accvgpr_read_b32 v238, a238
    v_accvgpr_read_b32 v239, a239
    v_mfma_f32_16x16x32_bf16 a[244:247], v[180:183], v[96:99], a[244:247]
    s_waitcnt lgkmcnt(8)
    v_add_u32 v219, 131072, v219
    ds_read_b64_tr_b16 v[172:173], v219 offset:0
    ds_read_b64_tr_b16 v[174:175], v219 offset:2048
    v_mfma_f32_16x16x32_bf16 a[252:255], v[180:183], v[104:107], a[252:255]
    buffer_load_dwordx4 v205, s[12:15], s38 offen offset:1024 nt lds
    v_max3_f32 v221, v236, v237, v221
    v_max3_f32 v221, v238, v239, v221
    v_mfma_f32_16x16x32_bf16 a[240:243], v[184:187], v[112:115], a[240:243]
    s_waitcnt lgkmcnt(8)
    ds_read_b64_tr_b16 v[176:177], v216 offset:4096
    ds_read_b64_tr_b16 v[178:179], v216 offset:6144
    v_mfma_f32_16x16x32_bf16 a[248:251], v[184:187], v[120:123], a[248:251]
    v_mov_b32 v244, 0x3f803f80
    v_mov_b32 v245, 0x3f803f80
    v_mfma_f32_16x16x32_bf16 a[244:247], v[188:191], v[112:115], a[244:247]
    ds_read_b64_tr_b16 v[180:181], v217 offset:4096
    ds_read_b64_tr_b16 v[182:183], v217 offset:6144
    v_mfma_f32_16x16x32_bf16 a[252:255], v[188:191], v[120:123], a[252:255]
    buffer_load_dwordx4 v206, s[12:15], s38 offen offset:2048 nt lds
    v_mov_b32 v246, 0x3f803f80
    v_mov_b32 v247, 0x3f803f80
    v_mov_b32 v212, v216
    v_mov_b32 v213, v217
    v_mov_b32 v214, v218
    v_mov_b32 v215, v219
    v_accvgpr_read_b32 v224, a240
    v_accvgpr_read_b32 v225, a241
    v_accvgpr_read_b32 v226, a242
    v_accvgpr_read_b32 v227, a243
    v_max3_f32 v220, v224, v225, v220
    v_accvgpr_read_b32 v228, a244
    v_accvgpr_read_b32 v229, a245
    v_max3_f32 v220, v226, v227, v220
    v_accvgpr_read_b32 v230, a246
    v_accvgpr_read_b32 v231, a247
    v_max3_f32 v220, v228, v229, v220
    v_accvgpr_read_b32 v232, a248
    v_accvgpr_read_b32 v233, a249
    v_max3_f32 v220, v230, v231, v220
    v_accvgpr_read_b32 v234, a250
    v_accvgpr_read_b32 v235, a251
    v_max3_f32 v221, v232, v233, v221
    v_accvgpr_read_b32 v236, a252
    v_accvgpr_read_b32 v237, a253
    v_max3_f32 v221, v234, v235, v221
    v_accvgpr_read_b32 v238, a254
    v_accvgpr_read_b32 v239, a255
    v_max3_f32 v221, v236, v237, v221
    v_max3_f32 v221, v238, v239, v221
    v_mov_b32 v224, v220
    v_mov_b32 v225, v221
    s_nop 0
    v_permlane32_swap_b32 v224, v220
    v_permlane32_swap_b32 v225, v221
    v_max_f32 v220, v220, v224
    v_max_f32 v221, v221, v225
    v_mov_b32 v224, v220
    v_mov_b32 v225, v221
    s_nop 0
    v_permlane16_swap_b32 v224, v220
    v_permlane16_swap_b32 v225, v221
    v_max_f32 v220, v220, v224
    v_max_f32 v221, v221, v225
    v_mul_f32 v222, s39, v220
    v_mul_f32 v223, s39, v221
    v_accvgpr_read_b32 v144, a0
    v_fma_f32 v144, v144, s39, -v222
    v_accvgpr_read_b32 v145, a1
    v_exp_f32 v144, v144
    v_fma_f32 v145, v145, s39, -v222
    v_accvgpr_read_b32 v146, a2
    v_exp_f32 v145, v145
    v_fma_f32 v146, v146, s39, -v222
    v_accvgpr_read_b32 v147, a3
    v_exp_f32 v146, v146
    v_fma_f32 v147, v147, s39, -v222
    v_accvgpr_read_b32 v148, a4
    v_cvt_pk_bf16_f32 v128, v144, v145
    v_exp_f32 v147, v147
    v_fma_f32 v148, v148, s39, -v222
    v_accvgpr_read_b32 v149, a5
    v_exp_f32 v148, v148
    v_fma_f32 v149, v149, s39, -v222
    v_accvgpr_read_b32 v150, a6
    v_cvt_pk_bf16_f32 v129, v146, v147
    v_exp_f32 v149, v149
    v_fma_f32 v150, v150, s39, -v222
    v_accvgpr_read_b32 v151, a7
    v_exp_f32 v150, v150
    v_fma_f32 v151, v151, s39, -v222
    v_accvgpr_read_b32 v152, a8
    v_cvt_pk_bf16_f32 v130, v148, v149
    v_exp_f32 v151, v151
    v_fma_f32 v152, v152, s39, -v223
    v_accvgpr_read_b32 v153, a9
    v_exp_f32 v152, v152
    v_fma_f32 v153, v153, s39, -v223
    v_accvgpr_read_b32 v154, a10
    v_cvt_pk_bf16_f32 v131, v150, v151
    v_exp_f32 v153, v153
    v_fma_f32 v154, v154, s39, -v223
    v_accvgpr_read_b32 v155, a11
    v_exp_f32 v154, v154
    v_fma_f32 v155, v155, s39, -v223
    v_accvgpr_read_b32 v156, a12
    v_cvt_pk_bf16_f32 v132, v152, v153
    v_exp_f32 v155, v155
    v_fma_f32 v156, v156, s39, -v223
    v_accvgpr_read_b32 v157, a13
    v_exp_f32 v156, v156
    v_fma_f32 v157, v157, s39, -v223
    v_accvgpr_read_b32 v158, a14
    v_cvt_pk_bf16_f32 v133, v154, v155
    v_exp_f32 v157, v157
    v_fma_f32 v158, v158, s39, -v223
    v_accvgpr_read_b32 v159, a15
    v_exp_f32 v158, v158
    v_fma_f32 v159, v159, s39, -v223
    v_cvt_pk_bf16_f32 v134, v156, v157
    v_exp_f32 v159, v159
    s_nop 0
    v_cvt_pk_bf16_f32 v135, v158, v159
    v_mfma_f32_16x16x32_bf16 v[248:251], v[244:247], v[128:131], 0
    s_waitcnt lgkmcnt(10)
    v_accvgpr_read_b32 v144, a16
    v_fma_f32 v144, v144, s39, -v222
    v_mfma_f32_16x16x32_bf16 v[252:255], v[244:247], v[132:135], 0
    v_accvgpr_read_b32 v145, a17
    v_mfma_f32_16x16x32_bf16 v[0:3], v[160:163], v[128:131], 0
    s_waitcnt lgkmcnt(8)
    ds_read_b64_tr_b16 v[184:185], v218 offset:4096
    ds_read_b64_tr_b16 v[186:187], v218 offset:6144
    v_mfma_f32_16x16x32_bf16 v[8:11], v[160:163], v[132:135], 0
    v_add_u32 v212, 4294836224, v212
    ds_read_b64_tr_b16 a[0:1], v212 offset:49152
    buffer_load_dwordx4 v207, s[12:15], s38 offen offset:3072 nt lds
    v_exp_f32 v144, v144
    v_fma_f32 v145, v145, s39, -v222
    v_accvgpr_read_b32 v146, a18
    v_mfma_f32_16x16x32_bf16 v[4:7], v[164:167], v[128:131], 0
    s_waitcnt lgkmcnt(9)
    ds_read_b64_tr_b16 v[188:189], v219 offset:4096
    ds_read_b64_tr_b16 v[190:191], v219 offset:6144
    v_mfma_f32_16x16x32_bf16 v[12:15], v[164:167], v[132:135], 0
    v_exp_f32 v145, v145
    v_fma_f32 v146, v146, s39, -v222
    v_accvgpr_read_b32 v147, a19
    v_mfma_f32_16x16x32_bf16 v[16:19], v[168:171], v[128:131], 0
    s_waitcnt lgkmcnt(9)
    ds_read_b64_tr_b16 v[160:161], v216 offset:8192
    ds_read_b64_tr_b16 v[162:163], v216 offset:10240
    v_mfma_f32_16x16x32_bf16 v[24:27], v[168:171], v[132:135], 0
    ds_read_b64_tr_b16 a[2:3], v212 offset:51200
    v_exp_f32 v146, v146
    v_fma_f32 v147, v147, s39, -v222
    v_accvgpr_read_b32 v148, a20
    v_cvt_pk_bf16_f32 v136, v144, v145
    v_mfma_f32_16x16x32_bf16 v[20:23], v[172:175], v[128:131], 0
    s_waitcnt lgkmcnt(10)
    ds_read_b64_tr_b16 v[164:165], v217 offset:8192
    ds_read_b64_tr_b16 v[166:167], v217 offset:10240
    v_mfma_f32_16x16x32_bf16 v[28:31], v[172:175], v[132:135], 0
    v_exp_f32 v147, v147
    v_fma_f32 v148, v148, s39, -v222
    v_accvgpr_read_b32 v149, a21
    v_mfma_f32_16x16x32_bf16 v[32:35], v[176:179], v[128:131], 0
    s_waitcnt lgkmcnt(10)
    ds_read_b64_tr_b16 v[168:169], v218 offset:8192
    ds_read_b64_tr_b16 v[170:171], v218 offset:10240
    v_mfma_f32_16x16x32_bf16 v[40:43], v[176:179], v[132:135], 0
    v_add_u32 v213, 4294836224, v213
    ds_read_b64_tr_b16 a[4:5], v213 offset:49152
    v_exp_f32 v148, v148
    v_fma_f32 v149, v149, s39, -v222
    v_accvgpr_read_b32 v150, a22
    v_mfma_f32_16x16x32_bf16 v[36:39], v[180:183], v[128:131], 0
    s_waitcnt lgkmcnt(11)
    ds_read_b64_tr_b16 v[172:173], v219 offset:8192
    ds_read_b64_tr_b16 v[174:175], v219 offset:10240
    v_mfma_f32_16x16x32_bf16 v[44:47], v[180:183], v[132:135], 0
    v_cvt_pk_bf16_f32 v137, v146, v147
    v_exp_f32 v149, v149
    v_fma_f32 v150, v150, s39, -v222
    v_accvgpr_read_b32 v151, a23
    v_mfma_f32_16x16x32_bf16 v[48:51], v[184:187], v[128:131], 0
    s_waitcnt lgkmcnt(10)
    ds_read_b64_tr_b16 v[176:177], v216 offset:12288
    ds_read_b64_tr_b16 v[178:179], v216 offset:14336
    v_mfma_f32_16x16x32_bf16 v[56:59], v[184:187], v[132:135], 0
    ds_read_b64_tr_b16 a[6:7], v213 offset:51200
    v_exp_f32 v150, v150
    v_fma_f32 v151, v151, s39, -v222
    v_accvgpr_read_b32 v152, a24
    v_mfma_f32_16x16x32_bf16 v[52:55], v[188:191], v[128:131], 0
    s_waitcnt lgkmcnt(11)
    ds_read_b64_tr_b16 v[180:181], v217 offset:12288
    ds_read_b64_tr_b16 v[182:183], v217 offset:14336
    v_mfma_f32_16x16x32_bf16 v[60:63], v[188:191], v[132:135], 0
    v_cvt_pk_bf16_f32 v138, v148, v149
    v_exp_f32 v151, v151
    v_fma_f32 v152, v152, s39, -v223
    v_mfma_f32_16x16x32_bf16 v[64:67], v[160:163], v[128:131], 0
    s_waitcnt lgkmcnt(10)
    ds_read_b64_tr_b16 v[184:185], v218 offset:12288
    ds_read_b64_tr_b16 v[186:187], v218 offset:14336
    v_mfma_f32_16x16x32_bf16 v[72:75], v[160:163], v[132:135], 0
    v_add_u32 v214, 4294836224, v214
    ds_read_b64_tr_b16 a[8:9], v214 offset:49152
    v_accvgpr_read_b32 v153, a25
    v_exp_f32 v152, v152
    v_fma_f32 v153, v153, s39, -v223
    v_mfma_f32_16x16x32_bf16 v[68:71], v[164:167], v[128:131], 0
    s_waitcnt lgkmcnt(11)
    ds_read_b64_tr_b16 v[188:189], v219 offset:12288
    ds_read_b64_tr_b16 v[190:191], v219 offset:14336
    v_mfma_f32_16x16x32_bf16 v[76:79], v[164:167], v[132:135], 0
    s_waitcnt vmcnt(4)
    s_barrier
    v_accvgpr_read_b32 v154, a26
    v_cvt_pk_bf16_f32 v139, v150, v151
    v_exp_f32 v153, v153
    v_fma_f32 v154, v154, s39, -v223
    v_mfma_f32_16x16x32_bf16 v[80:83], v[168:171], v[128:131], 0
    s_waitcnt lgkmcnt(10)
    ds_read_b64_tr_b16 v[160:161], v216 offset:16384
    ds_read_b64_tr_b16 v[162:163], v216 offset:18432
    v_mfma_f32_16x16x32_bf16 v[88:91], v[168:171], v[132:135], 0
    ds_read_b64_tr_b16 a[10:11], v214 offset:51200
    s_add_u32 m0, s36, 16384
    s_mov_b32 s38, 49152
    v_accvgpr_read_b32 v155, a27
    v_exp_f32 v154, v154
    v_fma_f32 v155, v155, s39, -v223
    v_mfma_f32_16x16x32_bf16 v[84:87], v[172:175], v[128:131], 0
    s_waitcnt lgkmcnt(11)
    ds_read_b64_tr_b16 v[164:165], v217 offset:16384
    ds_read_b64_tr_b16 v[166:167], v217 offset:18432
    v_mfma_f32_16x16x32_bf16 v[92:95], v[172:175], v[132:135], 0
    buffer_load_dwordx4 v204, s[12:15], s38 offen offset:0 nt lds
    v_accvgpr_read_b32 v156, a28
    v_cvt_pk_bf16_f32 v140, v152, v153
    v_exp_f32 v155, v155
    v_mfma_f32_16x16x32_bf16 v[96:99], v[176:179], v[128:131], 0
    s_waitcnt lgkmcnt(10)
    ds_read_b64_tr_b16 v[168:169], v218 offset:16384
    ds_read_b64_tr_b16 v[170:171], v218 offset:18432
    v_mfma_f32_16x16x32_bf16 v[104:107], v[176:179], v[132:135], 0
    v_add_u32 v215, 4294836224, v215
    ds_read_b64_tr_b16 a[12:13], v215 offset:49152
    buffer_load_dwordx4 v205, s[12:15], s38 offen offset:1024 nt lds
    v_fma_f32 v156, v156, s39, -v223
    v_accvgpr_read_b32 v157, a29
    v_exp_f32 v156, v156
    v_fma_f32 v157, v157, s39, -v223
    v_mfma_f32_16x16x32_bf16 v[100:103], v[180:183], v[128:131], 0
    s_waitcnt lgkmcnt(11)
    ds_read_b64_tr_b16 v[172:173], v219 offset:16384
    ds_read_b64_tr_b16 v[174:175], v219 offset:18432
    v_mfma_f32_16x16x32_bf16 v[108:111], v[180:183], v[132:135], 0
    buffer_load_dwordx4 v206, s[12:15], s38 offen offset:2048 nt lds
    v_accvgpr_read_b32 v158, a30
    v_cvt_pk_bf16_f32 v141, v154, v155
    v_exp_f32 v157, v157
    v_mfma_f32_16x16x32_bf16 v[112:115], v[184:187], v[128:131], 0
    s_waitcnt lgkmcnt(10)
    ds_read_b64_tr_b16 v[176:177], v216 offset:20480
    ds_read_b64_tr_b16 v[178:179], v216 offset:22528
    v_mfma_f32_16x16x32_bf16 v[120:123], v[184:187], v[132:135], 0
    ds_read_b64_tr_b16 a[14:15], v215 offset:51200
    buffer_load_dwordx4 v207, s[12:15], s38 offen offset:3072 nt lds
    v_fma_f32 v158, v158, s39, -v223
    v_accvgpr_read_b32 v159, a31
    v_exp_f32 v158, v158
    v_mfma_f32_16x16x32_bf16 v[116:119], v[188:191], v[128:131], 0
    ds_read_b64_tr_b16 v[180:181], v217 offset:20480
    ds_read_b64_tr_b16 v[182:183], v217 offset:22528
    v_mfma_f32_16x16x32_bf16 v[124:127], v[188:191], v[132:135], 0
    s_add_u32 m0, s36, 32768
    s_add_u32 s38, s64, 114688
    v_fma_f32 v159, v159, s39, -v223
    v_cvt_pk_bf16_f32 v142, v156, v157
    v_exp_f32 v159, v159
    s_nop 0
    v_cvt_pk_bf16_f32 v143, v158, v159
    v_mfma_f32_16x16x32_bf16 v[248:251], v[244:247], v[136:139], v[248:251]
    s_waitcnt lgkmcnt(13)
    v_accvgpr_read_b32 v144, a32
    v_fma_f32 v144, v144, s39, -v222
    v_mfma_f32_16x16x32_bf16 v[252:255], v[244:247], v[140:143], v[252:255]
    buffer_load_dwordx4 v208, s[20:23], s38 offen offset:0 lds
    v_accvgpr_read_b32 v145, a33
    v_mfma_f32_16x16x32_bf16 v[0:3], v[160:163], v[136:139], v[0:3]
    s_waitcnt lgkmcnt(10)
    ds_read_b64_tr_b16 v[184:185], v218 offset:20480
    ds_read_b64_tr_b16 v[186:187], v218 offset:22528
    v_mfma_f32_16x16x32_bf16 v[8:11], v[160:163], v[140:143], v[8:11]
    ds_read_b64_tr_b16 a[16:17], v212 offset:53248
    v_exp_f32 v144, v144
    v_fma_f32 v145, v145, s39, -v222
    v_accvgpr_read_b32 v146, a34
    v_mfma_f32_16x16x32_bf16 v[4:7], v[164:167], v[136:139], v[4:7]
    s_waitcnt lgkmcnt(11)
    ds_read_b64_tr_b16 v[188:189], v219 offset:20480
    ds_read_b64_tr_b16 v[190:191], v219 offset:22528
    v_mfma_f32_16x16x32_bf16 v[12:15], v[164:167], v[140:143], v[12:15]
    buffer_load_dwordx4 v209, s[20:23], s38 offen offset:1024 lds
    v_exp_f32 v145, v145
    v_fma_f32 v146, v146, s39, -v222
    v_accvgpr_read_b32 v147, a35
    v_mfma_f32_16x16x32_bf16 v[16:19], v[168:171], v[136:139], v[16:19]
    s_waitcnt lgkmcnt(10)
    ds_read_b64_tr_b16 v[160:161], v216 offset:24576
    ds_read_b64_tr_b16 v[162:163], v216 offset:26624
    v_mfma_f32_16x16x32_bf16 v[24:27], v[168:171], v[140:143], v[24:27]
    ds_read_b64_tr_b16 a[18:19], v212 offset:55296
    v_exp_f32 v146, v146
    v_fma_f32 v147, v147, s39, -v222
    v_accvgpr_read_b32 v148, a36
    v_cvt_pk_bf16_f32 v128, v144, v145
    v_mfma_f32_16x16x32_bf16 v[20:23], v[172:175], v[136:139], v[20:23]
    s_waitcnt lgkmcnt(11)
    ds_read_b64_tr_b16 v[164:165], v217 offset:24576
    ds_read_b64_tr_b16 v[166:167], v217 offset:26624
    v_mfma_f32_16x16x32_bf16 v[28:31], v[172:175], v[140:143], v[28:31]
    buffer_load_dwordx4 v210, s[20:23], s38 offen offset:2048 lds
    v_exp_f32 v147, v147
    v_fma_f32 v148, v148, s39, -v222
    v_accvgpr_read_b32 v149, a37
    v_mfma_f32_16x16x32_bf16 v[32:35], v[176:179], v[136:139], v[32:35]
    s_waitcnt lgkmcnt(10)
    ds_read_b64_tr_b16 v[168:169], v218 offset:24576
    ds_read_b64_tr_b16 v[170:171], v218 offset:26624
    v_mfma_f32_16x16x32_bf16 v[40:43], v[176:179], v[140:143], v[40:43]
    ds_read_b64_tr_b16 a[20:21], v213 offset:53248
    v_exp_f32 v148, v148
    v_fma_f32 v149, v149, s39, -v222
    v_accvgpr_read_b32 v150, a38
    v_mfma_f32_16x16x32_bf16 v[36:39], v[180:183], v[136:139], v[36:39]
    s_waitcnt lgkmcnt(11)
    ds_read_b64_tr_b16 v[172:173], v219 offset:24576
    ds_read_b64_tr_b16 v[174:175], v219 offset:26624
    v_mfma_f32_16x16x32_bf16 v[44:47], v[180:183], v[140:143], v[44:47]
    buffer_load_dwordx4 v211, s[20:23], s38 offen offset:3072 lds
    v_cvt_pk_bf16_f32 v129, v146, v147
    v_exp_f32 v149, v149
    v_fma_f32 v150, v150, s39, -v222
    v_accvgpr_read_b32 v151, a39
    v_mfma_f32_16x16x32_bf16 v[48:51], v[184:187], v[136:139], v[48:51]
    s_waitcnt lgkmcnt(10)
    ds_read_b64_tr_b16 v[176:177], v216 offset:28672
    ds_read_b64_tr_b16 v[178:179], v216 offset:30720
    v_mfma_f32_16x16x32_bf16 v[56:59], v[184:187], v[140:143], v[56:59]
    ds_read_b64_tr_b16 a[22:23], v213 offset:55296
    v_add_u32 v216, 4294836224, v216
    v_exp_f32 v150, v150
    v_fma_f32 v151, v151, s39, -v222
    v_accvgpr_read_b32 v152, a40
    v_mfma_f32_16x16x32_bf16 v[52:55], v[188:191], v[136:139], v[52:55]
    s_waitcnt lgkmcnt(11)
    ds_read_b64_tr_b16 v[180:181], v217 offset:28672
    ds_read_b64_tr_b16 v[182:183], v217 offset:30720
    v_mfma_f32_16x16x32_bf16 v[60:63], v[188:191], v[140:143], v[60:63]
    v_add_u32 v217, 4294836224, v217
    v_cvt_pk_bf16_f32 v130, v148, v149
    v_exp_f32 v151, v151
    v_fma_f32 v152, v152, s39, -v223
    v_mfma_f32_16x16x32_bf16 v[64:67], v[160:163], v[136:139], v[64:67]
    s_waitcnt lgkmcnt(10)
    ds_read_b64_tr_b16 v[184:185], v218 offset:28672
    ds_read_b64_tr_b16 v[186:187], v218 offset:30720
    v_mfma_f32_16x16x32_bf16 v[72:75], v[160:163], v[140:143], v[72:75]
    ds_read_b64_tr_b16 a[24:25], v214 offset:53248
    v_add_u32 v218, 4294836224, v218
    v_accvgpr_read_b32 v153, a41
    v_exp_f32 v152, v152
    v_fma_f32 v153, v153, s39, -v223
    v_mfma_f32_16x16x32_bf16 v[68:71], v[164:167], v[136:139], v[68:71]
    s_waitcnt lgkmcnt(11)
    ds_read_b64_tr_b16 v[188:189], v219 offset:28672
    ds_read_b64_tr_b16 v[190:191], v219 offset:30720
    v_mfma_f32_16x16x32_bf16 v[76:79], v[164:167], v[140:143], v[76:79]
    s_waitcnt vmcnt(8)
    s_barrier
    v_add_u32 v219, 4294836224, v219
    v_accvgpr_read_b32 v154, a42
    v_cvt_pk_bf16_f32 v131, v150, v151
    v_exp_f32 v153, v153
    v_fma_f32 v154, v154, s39, -v223
    v_mfma_f32_16x16x32_bf16 v[80:83], v[168:171], v[136:139], v[80:83]
    s_waitcnt lgkmcnt(10)
    ds_read_b64_tr_b16 v[160:161], v216 offset:0
    ds_read_b64_tr_b16 v[162:163], v216 offset:2048
    v_mfma_f32_16x16x32_bf16 v[88:91], v[168:171], v[140:143], v[88:91]
    ds_read_b64_tr_b16 a[26:27], v214 offset:55296
    s_add_u32 m0, s36, 65536
    s_mov_b32 s38, 65536
    v_accvgpr_read_b32 v155, a43
    v_exp_f32 v154, v154
    v_fma_f32 v155, v155, s39, -v223
    v_mfma_f32_16x16x32_bf16 v[84:87], v[172:175], v[136:139], v[84:87]
    s_waitcnt lgkmcnt(11)
    ds_read_b64_tr_b16 v[164:165], v217 offset:0
    ds_read_b64_tr_b16 v[166:167], v217 offset:2048
    v_mfma_f32_16x16x32_bf16 v[92:95], v[172:175], v[140:143], v[92:95]
    buffer_load_dwordx4 v204, s[12:15], s38 offen offset:0 nt lds
    v_accvgpr_read_b32 v156, a44
    v_cvt_pk_bf16_f32 v132, v152, v153
    v_exp_f32 v155, v155
    v_mfma_f32_16x16x32_bf16 v[96:99], v[176:179], v[136:139], v[96:99]
    s_waitcnt lgkmcnt(10)
    ds_read_b64_tr_b16 v[168:169], v218 offset:0
    ds_read_b64_tr_b16 v[170:171], v218 offset:2048
    v_mfma_f32_16x16x32_bf16 v[104:107], v[176:179], v[140:143], v[104:107]
    ds_read_b64_tr_b16 a[28:29], v215 offset:53248
    v_fma_f32 v156, v156, s39, -v223
    v_accvgpr_read_b32 v157, a45
    v_exp_f32 v156, v156
    v_fma_f32 v157, v157, s39, -v223
    v_mfma_f32_16x16x32_bf16 v[100:103], v[180:183], v[136:139], v[100:103]
    s_waitcnt lgkmcnt(11)
    ds_read_b64_tr_b16 v[172:173], v219 offset:0
    ds_read_b64_tr_b16 v[174:175], v219 offset:2048
    v_mfma_f32_16x16x32_bf16 v[108:111], v[180:183], v[140:143], v[108:111]
    buffer_load_dwordx4 v205, s[12:15], s38 offen offset:1024 nt lds
    v_accvgpr_read_b32 v158, a46
    v_cvt_pk_bf16_f32 v133, v154, v155
    v_exp_f32 v157, v157
    v_mfma_f32_16x16x32_bf16 v[112:115], v[184:187], v[136:139], v[112:115]
    s_waitcnt lgkmcnt(10)
    ds_read_b64_tr_b16 v[176:177], v216 offset:4096
    ds_read_b64_tr_b16 v[178:179], v216 offset:6144
    v_mfma_f32_16x16x32_bf16 v[120:123], v[184:187], v[140:143], v[120:123]
    ds_read_b64_tr_b16 a[30:31], v215 offset:55296
    v_fma_f32 v158, v158, s39, -v223
    v_accvgpr_read_b32 v159, a47
    v_exp_f32 v158, v158
    v_mfma_f32_16x16x32_bf16 v[116:119], v[188:191], v[136:139], v[116:119]
    ds_read_b64_tr_b16 v[180:181], v217 offset:4096
    ds_read_b64_tr_b16 v[182:183], v217 offset:6144
    v_mfma_f32_16x16x32_bf16 v[124:127], v[188:191], v[140:143], v[124:127]
    buffer_load_dwordx4 v206, s[12:15], s38 offen offset:2048 nt lds
    v_fma_f32 v159, v159, s39, -v223
    v_cvt_pk_bf16_f32 v134, v156, v157
    v_exp_f32 v159, v159
    s_nop 0
    v_cvt_pk_bf16_f32 v135, v158, v159
    v_mfma_f32_16x16x32_bf16 v[248:251], v[244:247], v[128:131], v[248:251]
    s_waitcnt lgkmcnt(13)
    v_accvgpr_read_b32 v144, a48
    v_fma_f32 v144, v144, s39, -v222
    v_mfma_f32_16x16x32_bf16 v[252:255], v[244:247], v[132:135], v[252:255]
    v_accvgpr_read_b32 v145, a49
    v_mfma_f32_16x16x32_bf16 v[0:3], v[160:163], v[128:131], v[0:3]
    s_waitcnt lgkmcnt(10)
    ds_read_b64_tr_b16 v[184:185], v218 offset:4096
    ds_read_b64_tr_b16 v[186:187], v218 offset:6144
    v_mfma_f32_16x16x32_bf16 v[8:11], v[160:163], v[132:135], v[8:11]
    ds_read_b64_tr_b16 a[32:33], v212 offset:57344
    buffer_load_dwordx4 v207, s[12:15], s38 offen offset:3072 nt lds
    v_exp_f32 v144, v144
    v_fma_f32 v145, v145, s39, -v222
    v_accvgpr_read_b32 v146, a50
    v_mfma_f32_16x16x32_bf16 v[4:7], v[164:167], v[128:131], v[4:7]
    s_waitcnt lgkmcnt(11)
    ds_read_b64_tr_b16 v[188:189], v219 offset:4096
    ds_read_b64_tr_b16 v[190:191], v219 offset:6144
    v_mfma_f32_16x16x32_bf16 v[12:15], v[164:167], v[132:135], v[12:15]
    v_exp_f32 v145, v145
    v_fma_f32 v146, v146, s39, -v222
    v_accvgpr_read_b32 v147, a51
    v_mfma_f32_16x16x32_bf16 v[16:19], v[168:171], v[128:131], v[16:19]
    s_waitcnt lgkmcnt(10)
    ds_read_b64_tr_b16 v[160:161], v216 offset:8192
    ds_read_b64_tr_b16 v[162:163], v216 offset:10240
    v_mfma_f32_16x16x32_bf16 v[24:27], v[168:171], v[132:135], v[24:27]
    ds_read_b64_tr_b16 a[34:35], v212 offset:59392
    v_exp_f32 v146, v146
    v_fma_f32 v147, v147, s39, -v222
    v_accvgpr_read_b32 v148, a52
    v_cvt_pk_bf16_f32 v136, v144, v145
    v_mfma_f32_16x16x32_bf16 v[20:23], v[172:175], v[128:131], v[20:23]
    s_waitcnt lgkmcnt(11)
    ds_read_b64_tr_b16 v[164:165], v217 offset:8192
    ds_read_b64_tr_b16 v[166:167], v217 offset:10240
    v_mfma_f32_16x16x32_bf16 v[28:31], v[172:175], v[132:135], v[28:31]
    v_exp_f32 v147, v147
    v_fma_f32 v148, v148, s39, -v222
    v_accvgpr_read_b32 v149, a53
    v_mfma_f32_16x16x32_bf16 v[32:35], v[176:179], v[128:131], v[32:35]
    s_waitcnt lgkmcnt(10)
    ds_read_b64_tr_b16 v[168:169], v218 offset:8192
    ds_read_b64_tr_b16 v[170:171], v218 offset:10240
    v_mfma_f32_16x16x32_bf16 v[40:43], v[176:179], v[132:135], v[40:43]
    ds_read_b64_tr_b16 a[36:37], v213 offset:57344
    v_exp_f32 v148, v148
    v_fma_f32 v149, v149, s39, -v222
    v_accvgpr_read_b32 v150, a54
    v_mfma_f32_16x16x32_bf16 v[36:39], v[180:183], v[128:131], v[36:39]
    s_waitcnt lgkmcnt(11)
    ds_read_b64_tr_b16 v[172:173], v219 offset:8192
    ds_read_b64_tr_b16 v[174:175], v219 offset:10240
    v_mfma_f32_16x16x32_bf16 v[44:47], v[180:183], v[132:135], v[44:47]
    v_cvt_pk_bf16_f32 v137, v146, v147
    v_exp_f32 v149, v149
    v_fma_f32 v150, v150, s39, -v222
    v_accvgpr_read_b32 v151, a55
    v_mfma_f32_16x16x32_bf16 v[48:51], v[184:187], v[128:131], v[48:51]
    s_waitcnt lgkmcnt(10)
    ds_read_b64_tr_b16 v[176:177], v216 offset:12288
    ds_read_b64_tr_b16 v[178:179], v216 offset:14336
    v_mfma_f32_16x16x32_bf16 v[56:59], v[184:187], v[132:135], v[56:59]
    ds_read_b64_tr_b16 a[38:39], v213 offset:59392
    v_exp_f32 v150, v150
    v_fma_f32 v151, v151, s39, -v222
    v_accvgpr_read_b32 v152, a56
    v_mfma_f32_16x16x32_bf16 v[52:55], v[188:191], v[128:131], v[52:55]
    s_waitcnt lgkmcnt(11)
    ds_read_b64_tr_b16 v[180:181], v217 offset:12288
    ds_read_b64_tr_b16 v[182:183], v217 offset:14336
    v_mfma_f32_16x16x32_bf16 v[60:63], v[188:191], v[132:135], v[60:63]
    v_cvt_pk_bf16_f32 v138, v148, v149
    v_exp_f32 v151, v151
    v_fma_f32 v152, v152, s39, -v223
    v_mfma_f32_16x16x32_bf16 v[64:67], v[160:163], v[128:131], v[64:67]
    s_waitcnt lgkmcnt(10)
    ds_read_b64_tr_b16 v[184:185], v218 offset:12288
    ds_read_b64_tr_b16 v[186:187], v218 offset:14336
    v_mfma_f32_16x16x32_bf16 v[72:75], v[160:163], v[132:135], v[72:75]
    ds_read_b64_tr_b16 a[40:41], v214 offset:57344
    v_accvgpr_read_b32 v153, a57
    v_exp_f32 v152, v152
    v_fma_f32 v153, v153, s39, -v223
    v_mfma_f32_16x16x32_bf16 v[68:71], v[164:167], v[128:131], v[68:71]
    s_waitcnt lgkmcnt(11)
    ds_read_b64_tr_b16 v[188:189], v219 offset:12288
    ds_read_b64_tr_b16 v[190:191], v219 offset:14336
    v_mfma_f32_16x16x32_bf16 v[76:79], v[164:167], v[132:135], v[76:79]
    s_waitcnt vmcnt(8)
    s_barrier
    v_accvgpr_read_b32 v154, a58
    v_cvt_pk_bf16_f32 v139, v150, v151
    v_exp_f32 v153, v153
    v_fma_f32 v154, v154, s39, -v223
    v_mfma_f32_16x16x32_bf16 v[80:83], v[168:171], v[128:131], v[80:83]
    s_waitcnt lgkmcnt(10)
    ds_read_b64_tr_b16 v[160:161], v216 offset:16384
    ds_read_b64_tr_b16 v[162:163], v216 offset:18432
    v_mfma_f32_16x16x32_bf16 v[88:91], v[168:171], v[132:135], v[88:91]
    ds_read_b64_tr_b16 a[42:43], v214 offset:59392
    s_add_u32 m0, s36, 81920
    s_mov_b32 s38, 81920
    v_accvgpr_read_b32 v155, a59
    v_exp_f32 v154, v154
    v_fma_f32 v155, v155, s39, -v223
    v_mfma_f32_16x16x32_bf16 v[84:87], v[172:175], v[128:131], v[84:87]
    s_waitcnt lgkmcnt(11)
    ds_read_b64_tr_b16 v[164:165], v217 offset:16384
    ds_read_b64_tr_b16 v[166:167], v217 offset:18432
    v_mfma_f32_16x16x32_bf16 v[92:95], v[172:175], v[132:135], v[92:95]
    buffer_load_dwordx4 v204, s[12:15], s38 offen offset:0 nt lds
    v_accvgpr_read_b32 v156, a60
    v_cvt_pk_bf16_f32 v140, v152, v153
    v_exp_f32 v155, v155
    v_mfma_f32_16x16x32_bf16 v[96:99], v[176:179], v[128:131], v[96:99]
    s_waitcnt lgkmcnt(10)
    ds_read_b64_tr_b16 v[168:169], v218 offset:16384
    ds_read_b64_tr_b16 v[170:171], v218 offset:18432
    v_mfma_f32_16x16x32_bf16 v[104:107], v[176:179], v[132:135], v[104:107]
    ds_read_b64_tr_b16 a[44:45], v215 offset:57344
    v_fma_f32 v156, v156, s39, -v223
    v_accvgpr_read_b32 v157, a61
    v_exp_f32 v156, v156
    v_fma_f32 v157, v157, s39, -v223
    v_mfma_f32_16x16x32_bf16 v[100:103], v[180:183], v[128:131], v[100:103]
    s_waitcnt lgkmcnt(11)
    ds_read_b64_tr_b16 v[172:173], v219 offset:16384
    ds_read_b64_tr_b16 v[174:175], v219 offset:18432
    v_mfma_f32_16x16x32_bf16 v[108:111], v[180:183], v[132:135], v[108:111]
    buffer_load_dwordx4 v205, s[12:15], s38 offen offset:1024 nt lds
    v_accvgpr_read_b32 v158, a62
    v_cvt_pk_bf16_f32 v141, v154, v155
    v_exp_f32 v157, v157
    v_mfma_f32_16x16x32_bf16 v[112:115], v[184:187], v[128:131], v[112:115]
    s_waitcnt lgkmcnt(10)
    ds_read_b64_tr_b16 v[176:177], v216 offset:20480
    ds_read_b64_tr_b16 v[178:179], v216 offset:22528
    v_mfma_f32_16x16x32_bf16 v[120:123], v[184:187], v[132:135], v[120:123]
    ds_read_b64_tr_b16 a[46:47], v215 offset:59392
    v_fma_f32 v158, v158, s39, -v223
    v_accvgpr_read_b32 v159, a63
    v_exp_f32 v158, v158
    v_mfma_f32_16x16x32_bf16 v[116:119], v[188:191], v[128:131], v[116:119]
    ds_read_b64_tr_b16 v[180:181], v217 offset:20480
    ds_read_b64_tr_b16 v[182:183], v217 offset:22528
    v_mfma_f32_16x16x32_bf16 v[124:127], v[188:191], v[132:135], v[124:127]
    buffer_load_dwordx4 v206, s[12:15], s38 offen offset:2048 nt lds
    v_fma_f32 v159, v159, s39, -v223
    v_cvt_pk_bf16_f32 v142, v156, v157
    v_exp_f32 v159, v159
    s_nop 0
    v_cvt_pk_bf16_f32 v143, v158, v159
    v_mfma_f32_16x16x32_bf16 v[248:251], v[244:247], v[136:139], v[248:251]
    s_waitcnt lgkmcnt(13)
    v_accvgpr_read_b32 v144, a64
    v_fma_f32 v144, v144, s39, -v222
    v_mfma_f32_16x16x32_bf16 v[252:255], v[244:247], v[140:143], v[252:255]
    v_accvgpr_read_b32 v145, a65
    v_mfma_f32_16x16x32_bf16 v[0:3], v[160:163], v[136:139], v[0:3]
    s_waitcnt lgkmcnt(10)
    ds_read_b64_tr_b16 v[184:185], v218 offset:20480
    ds_read_b64_tr_b16 v[186:187], v218 offset:22528
    v_mfma_f32_16x16x32_bf16 v[8:11], v[160:163], v[140:143], v[8:11]
    ds_read_b64_tr_b16 a[48:49], v212 offset:61440
    buffer_load_dwordx4 v207, s[12:15], s38 offen offset:3072 nt lds
    v_exp_f32 v144, v144
    v_fma_f32 v145, v145, s39, -v222
    v_accvgpr_read_b32 v146, a66
    v_mfma_f32_16x16x32_bf16 v[4:7], v[164:167], v[136:139], v[4:7]
    s_waitcnt lgkmcnt(11)
    ds_read_b64_tr_b16 v[188:189], v219 offset:20480
    ds_read_b64_tr_b16 v[190:191], v219 offset:22528
    v_mfma_f32_16x16x32_bf16 v[12:15], v[164:167], v[140:143], v[12:15]
    v_exp_f32 v145, v145
    v_fma_f32 v146, v146, s39, -v222
    v_accvgpr_read_b32 v147, a67
    v_mfma_f32_16x16x32_bf16 v[16:19], v[168:171], v[136:139], v[16:19]
    s_waitcnt lgkmcnt(10)
    ds_read_b64_tr_b16 v[160:161], v216 offset:24576
    ds_read_b64_tr_b16 v[162:163], v216 offset:26624
    v_mfma_f32_16x16x32_bf16 v[24:27], v[168:171], v[140:143], v[24:27]
    ds_read_b64_tr_b16 a[50:51], v212 offset:63488
    v_exp_f32 v146, v146
    v_fma_f32 v147, v147, s39, -v222
    v_accvgpr_read_b32 v148, a68
    v_cvt_pk_bf16_f32 v128, v144, v145
    v_mfma_f32_16x16x32_bf16 v[20:23], v[172:175], v[136:139], v[20:23]
    s_waitcnt lgkmcnt(11)
    ds_read_b64_tr_b16 v[164:165], v217 offset:24576
    ds_read_b64_tr_b16 v[166:167], v217 offset:26624
    v_mfma_f32_16x16x32_bf16 v[28:31], v[172:175], v[140:143], v[28:31]
    v_exp_f32 v147, v147
    v_fma_f32 v148, v148, s39, -v222
    v_accvgpr_read_b32 v149, a69
    v_mfma_f32_16x16x32_bf16 v[32:35], v[176:179], v[136:139], v[32:35]
    s_waitcnt lgkmcnt(10)
    ds_read_b64_tr_b16 v[168:169], v218 offset:24576
    ds_read_b64_tr_b16 v[170:171], v218 offset:26624
    v_mfma_f32_16x16x32_bf16 v[40:43], v[176:179], v[140:143], v[40:43]
    ds_read_b64_tr_b16 a[52:53], v213 offset:61440
    v_exp_f32 v148, v148
    v_fma_f32 v149, v149, s39, -v222
    v_accvgpr_read_b32 v150, a70
    v_mfma_f32_16x16x32_bf16 v[36:39], v[180:183], v[136:139], v[36:39]
    s_waitcnt lgkmcnt(11)
    ds_read_b64_tr_b16 v[172:173], v219 offset:24576
    ds_read_b64_tr_b16 v[174:175], v219 offset:26624
    v_mfma_f32_16x16x32_bf16 v[44:47], v[180:183], v[140:143], v[44:47]
    v_cvt_pk_bf16_f32 v129, v146, v147
    v_exp_f32 v149, v149
    v_fma_f32 v150, v150, s39, -v222
    v_accvgpr_read_b32 v151, a71
    v_mfma_f32_16x16x32_bf16 v[48:51], v[184:187], v[136:139], v[48:51]
    s_waitcnt lgkmcnt(10)
    ds_read_b64_tr_b16 v[176:177], v216 offset:28672
    ds_read_b64_tr_b16 v[178:179], v216 offset:30720
    v_mfma_f32_16x16x32_bf16 v[56:59], v[184:187], v[140:143], v[56:59]
    ds_read_b64_tr_b16 a[54:55], v213 offset:63488
    v_add_u32 v216, 65536, v216
    v_exp_f32 v150, v150
    v_fma_f32 v151, v151, s39, -v222
    v_accvgpr_read_b32 v152, a72
    v_mfma_f32_16x16x32_bf16 v[52:55], v[188:191], v[136:139], v[52:55]
    s_waitcnt lgkmcnt(11)
    ds_read_b64_tr_b16 v[180:181], v217 offset:28672
    ds_read_b64_tr_b16 v[182:183], v217 offset:30720
    v_mfma_f32_16x16x32_bf16 v[60:63], v[188:191], v[140:143], v[60:63]
    v_add_u32 v217, 65536, v217
    v_cvt_pk_bf16_f32 v130, v148, v149
    v_exp_f32 v151, v151
    v_fma_f32 v152, v152, s39, -v223
    v_mfma_f32_16x16x32_bf16 v[64:67], v[160:163], v[136:139], v[64:67]
    s_waitcnt lgkmcnt(10)
    ds_read_b64_tr_b16 v[184:185], v218 offset:28672
    ds_read_b64_tr_b16 v[186:187], v218 offset:30720
    v_mfma_f32_16x16x32_bf16 v[72:75], v[160:163], v[140:143], v[72:75]
    ds_read_b64_tr_b16 a[56:57], v214 offset:61440
    v_add_u32 v218, 65536, v218
    v_accvgpr_read_b32 v153, a73
    v_exp_f32 v152, v152
    v_fma_f32 v153, v153, s39, -v223
    v_mfma_f32_16x16x32_bf16 v[68:71], v[164:167], v[136:139], v[68:71]
    s_waitcnt lgkmcnt(11)
    ds_read_b64_tr_b16 v[188:189], v219 offset:28672
    ds_read_b64_tr_b16 v[190:191], v219 offset:30720
    v_mfma_f32_16x16x32_bf16 v[76:79], v[164:167], v[140:143], v[76:79]
    s_waitcnt vmcnt(4)
    s_barrier
    v_add_u32 v219, 65536, v219
    v_accvgpr_read_b32 v154, a74
    v_cvt_pk_bf16_f32 v131, v150, v151
    v_exp_f32 v153, v153
    v_fma_f32 v154, v154, s39, -v223
    v_mfma_f32_16x16x32_bf16 v[80:83], v[168:171], v[136:139], v[80:83]
    s_waitcnt lgkmcnt(10)
    ds_read_b64_tr_b16 v[160:161], v216 offset:0
    ds_read_b64_tr_b16 v[162:163], v216 offset:2048
    v_mfma_f32_16x16x32_bf16 v[88:91], v[168:171], v[140:143], v[88:91]
    ds_read_b64_tr_b16 a[58:59], v214 offset:63488
    s_add_u32 m0, s36, 98304
    s_mov_b32 s38, 98304
    v_accvgpr_read_b32 v155, a75
    v_exp_f32 v154, v154
    v_fma_f32 v155, v155, s39, -v223
    v_mfma_f32_16x16x32_bf16 v[84:87], v[172:175], v[136:139], v[84:87]
    s_waitcnt lgkmcnt(11)
    ds_read_b64_tr_b16 v[164:165], v217 offset:0
    ds_read_b64_tr_b16 v[166:167], v217 offset:2048
    v_mfma_f32_16x16x32_bf16 v[92:95], v[172:175], v[140:143], v[92:95]
    buffer_load_dwordx4 v204, s[12:15], s38 offen offset:0 nt lds
    v_accvgpr_read_b32 v156, a76
    v_cvt_pk_bf16_f32 v132, v152, v153
    v_exp_f32 v155, v155
    v_mfma_f32_16x16x32_bf16 v[96:99], v[176:179], v[136:139], v[96:99]
    s_waitcnt lgkmcnt(10)
    ds_read_b64_tr_b16 v[168:169], v218 offset:0
    ds_read_b64_tr_b16 v[170:171], v218 offset:2048
    v_mfma_f32_16x16x32_bf16 v[104:107], v[176:179], v[140:143], v[104:107]
    ds_read_b64_tr_b16 a[60:61], v215 offset:61440
    v_fma_f32 v156, v156, s39, -v223
    v_accvgpr_read_b32 v157, a77
    v_exp_f32 v156, v156
    v_fma_f32 v157, v157, s39, -v223
    v_mfma_f32_16x16x32_bf16 v[100:103], v[180:183], v[136:139], v[100:103]
    s_waitcnt lgkmcnt(11)
    ds_read_b64_tr_b16 v[172:173], v219 offset:0
    ds_read_b64_tr_b16 v[174:175], v219 offset:2048
    v_mfma_f32_16x16x32_bf16 v[108:111], v[180:183], v[140:143], v[108:111]
    buffer_load_dwordx4 v205, s[12:15], s38 offen offset:1024 nt lds
    v_accvgpr_read_b32 v158, a78
    v_cvt_pk_bf16_f32 v133, v154, v155
    v_exp_f32 v157, v157
    v_mfma_f32_16x16x32_bf16 v[112:115], v[184:187], v[136:139], v[112:115]
    s_waitcnt lgkmcnt(10)
    ds_read_b64_tr_b16 v[176:177], v216 offset:4096
    ds_read_b64_tr_b16 v[178:179], v216 offset:6144
    v_mfma_f32_16x16x32_bf16 v[120:123], v[184:187], v[140:143], v[120:123]
    ds_read_b64_tr_b16 a[62:63], v215 offset:63488
    v_fma_f32 v158, v158, s39, -v223
    v_accvgpr_read_b32 v159, a79
    v_exp_f32 v158, v158
    v_mfma_f32_16x16x32_bf16 v[116:119], v[188:191], v[136:139], v[116:119]
    ds_read_b64_tr_b16 v[180:181], v217 offset:4096
    ds_read_b64_tr_b16 v[182:183], v217 offset:6144
    v_mfma_f32_16x16x32_bf16 v[124:127], v[188:191], v[140:143], v[124:127]
    buffer_load_dwordx4 v206, s[12:15], s38 offen offset:2048 nt lds
    v_fma_f32 v159, v159, s39, -v223
    v_cvt_pk_bf16_f32 v134, v156, v157
    v_exp_f32 v159, v159
    s_nop 0
    v_cvt_pk_bf16_f32 v135, v158, v159
    v_mfma_f32_16x16x32_bf16 v[248:251], v[244:247], v[128:131], v[248:251]
    s_waitcnt lgkmcnt(13)
    v_accvgpr_read_b32 v144, a80
    v_fma_f32 v144, v144, s39, -v222
    v_mfma_f32_16x16x32_bf16 v[252:255], v[244:247], v[132:135], v[252:255]
    v_accvgpr_read_b32 v145, a81
    v_mfma_f32_16x16x32_bf16 v[0:3], v[160:163], v[128:131], v[0:3]
    s_waitcnt lgkmcnt(10)
    ds_read_b64_tr_b16 v[184:185], v218 offset:4096
    ds_read_b64_tr_b16 v[186:187], v218 offset:6144
    v_mfma_f32_16x16x32_bf16 v[8:11], v[160:163], v[132:135], v[8:11]
    ds_read_b64_tr_b16 a[64:65], v212 offset:32768
    buffer_load_dwordx4 v207, s[12:15], s38 offen offset:3072 nt lds
    v_exp_f32 v144, v144
    v_fma_f32 v145, v145, s39, -v222
    v_accvgpr_read_b32 v146, a82
    v_mfma_f32_16x16x32_bf16 v[4:7], v[164:167], v[128:131], v[4:7]
    s_waitcnt lgkmcnt(11)
    ds_read_b64_tr_b16 v[188:189], v219 offset:4096
    ds_read_b64_tr_b16 v[190:191], v219 offset:6144
    v_mfma_f32_16x16x32_bf16 v[12:15], v[164:167], v[132:135], v[12:15]
    v_exp_f32 v145, v145
    v_fma_f32 v146, v146, s39, -v222
    v_accvgpr_read_b32 v147, a83
    v_mfma_f32_16x16x32_bf16 v[16:19], v[168:171], v[128:131], v[16:19]
    s_waitcnt lgkmcnt(10)
    ds_read_b64_tr_b16 v[160:161], v216 offset:8192
    ds_read_b64_tr_b16 v[162:163], v216 offset:10240
    v_mfma_f32_16x16x32_bf16 v[24:27], v[168:171], v[132:135], v[24:27]
    ds_read_b64_tr_b16 a[66:67], v212 offset:34816
    v_exp_f32 v146, v146
    v_fma_f32 v147, v147, s39, -v222
    v_accvgpr_read_b32 v148, a84
    v_cvt_pk_bf16_f32 v136, v144, v145
    v_mfma_f32_16x16x32_bf16 v[20:23], v[172:175], v[128:131], v[20:23]
    s_waitcnt lgkmcnt(11)
    ds_read_b64_tr_b16 v[164:165], v217 offset:8192
    ds_read_b64_tr_b16 v[166:167], v217 offset:10240
    v_mfma_f32_16x16x32_bf16 v[28:31], v[172:175], v[132:135], v[28:31]
    v_exp_f32 v147, v147
    v_fma_f32 v148, v148, s39, -v222
    v_accvgpr_read_b32 v149, a85
    v_mfma_f32_16x16x32_bf16 v[32:35], v[176:179], v[128:131], v[32:35]
    s_waitcnt lgkmcnt(10)
    ds_read_b64_tr_b16 v[168:169], v218 offset:8192
    ds_read_b64_tr_b16 v[170:171], v218 offset:10240
    v_mfma_f32_16x16x32_bf16 v[40:43], v[176:179], v[132:135], v[40:43]
    ds_read_b64_tr_b16 a[68:69], v213 offset:32768
    v_exp_f32 v148, v148
    v_fma_f32 v149, v149, s39, -v222
    v_accvgpr_read_b32 v150, a86
    v_mfma_f32_16x16x32_bf16 v[36:39], v[180:183], v[128:131], v[36:39]
    s_waitcnt lgkmcnt(11)
    ds_read_b64_tr_b16 v[172:173], v219 offset:8192
    ds_read_b64_tr_b16 v[174:175], v219 offset:10240
    v_mfma_f32_16x16x32_bf16 v[44:47], v[180:183], v[132:135], v[44:47]
    v_cvt_pk_bf16_f32 v137, v146, v147
    v_exp_f32 v149, v149
    v_fma_f32 v150, v150, s39, -v222
    v_accvgpr_read_b32 v151, a87
    v_mfma_f32_16x16x32_bf16 v[48:51], v[184:187], v[128:131], v[48:51]
    s_waitcnt lgkmcnt(10)
    ds_read_b64_tr_b16 v[176:177], v216 offset:12288
    ds_read_b64_tr_b16 v[178:179], v216 offset:14336
    v_mfma_f32_16x16x32_bf16 v[56:59], v[184:187], v[132:135], v[56:59]
    ds_read_b64_tr_b16 a[70:71], v213 offset:34816
    v_exp_f32 v150, v150
    v_fma_f32 v151, v151, s39, -v222
    v_accvgpr_read_b32 v152, a88
    v_mfma_f32_16x16x32_bf16 v[52:55], v[188:191], v[128:131], v[52:55]
    s_waitcnt lgkmcnt(11)
    ds_read_b64_tr_b16 v[180:181], v217 offset:12288
    ds_read_b64_tr_b16 v[182:183], v217 offset:14336
    v_mfma_f32_16x16x32_bf16 v[60:63], v[188:191], v[132:135], v[60:63]
    v_cvt_pk_bf16_f32 v138, v148, v149
    v_exp_f32 v151, v151
    v_fma_f32 v152, v152, s39, -v223
    v_mfma_f32_16x16x32_bf16 v[64:67], v[160:163], v[128:131], v[64:67]
    s_waitcnt lgkmcnt(10)
    ds_read_b64_tr_b16 v[184:185], v218 offset:12288
    ds_read_b64_tr_b16 v[186:187], v218 offset:14336
    v_mfma_f32_16x16x32_bf16 v[72:75], v[160:163], v[132:135], v[72:75]
    ds_read_b64_tr_b16 a[72:73], v214 offset:32768
    v_accvgpr_read_b32 v153, a89
    v_exp_f32 v152, v152
    v_fma_f32 v153, v153, s39, -v223
    v_mfma_f32_16x16x32_bf16 v[68:71], v[164:167], v[128:131], v[68:71]
    s_waitcnt lgkmcnt(11)
    ds_read_b64_tr_b16 v[188:189], v219 offset:12288
    ds_read_b64_tr_b16 v[190:191], v219 offset:14336
    v_mfma_f32_16x16x32_bf16 v[76:79], v[164:167], v[132:135], v[76:79]
    s_waitcnt vmcnt(4)
    s_barrier
    v_accvgpr_read_b32 v154, a90
    v_cvt_pk_bf16_f32 v139, v150, v151
    v_exp_f32 v153, v153
    v_fma_f32 v154, v154, s39, -v223
    v_mfma_f32_16x16x32_bf16 v[80:83], v[168:171], v[128:131], v[80:83]
    s_waitcnt lgkmcnt(10)
    ds_read_b64_tr_b16 v[160:161], v216 offset:16384
    ds_read_b64_tr_b16 v[162:163], v216 offset:18432
    v_mfma_f32_16x16x32_bf16 v[88:91], v[168:171], v[132:135], v[88:91]
    ds_read_b64_tr_b16 a[74:75], v214 offset:34816
    s_add_u32 m0, s36, 114688
    s_mov_b32 s38, 114688
    v_accvgpr_read_b32 v155, a91
    v_exp_f32 v154, v154
    v_fma_f32 v155, v155, s39, -v223
    v_mfma_f32_16x16x32_bf16 v[84:87], v[172:175], v[128:131], v[84:87]
    s_waitcnt lgkmcnt(11)
    ds_read_b64_tr_b16 v[164:165], v217 offset:16384
    ds_read_b64_tr_b16 v[166:167], v217 offset:18432
    v_mfma_f32_16x16x32_bf16 v[92:95], v[172:175], v[132:135], v[92:95]
    buffer_load_dwordx4 v204, s[12:15], s38 offen offset:0 nt lds
    v_accvgpr_read_b32 v156, a92
    v_cvt_pk_bf16_f32 v140, v152, v153
    v_exp_f32 v155, v155
    v_mfma_f32_16x16x32_bf16 v[96:99], v[176:179], v[128:131], v[96:99]
    s_waitcnt lgkmcnt(10)
    ds_read_b64_tr_b16 v[168:169], v218 offset:16384
    ds_read_b64_tr_b16 v[170:171], v218 offset:18432
    v_mfma_f32_16x16x32_bf16 v[104:107], v[176:179], v[132:135], v[104:107]
    ds_read_b64_tr_b16 a[76:77], v215 offset:32768
    buffer_load_dwordx4 v205, s[12:15], s38 offen offset:1024 nt lds
    v_fma_f32 v156, v156, s39, -v223
    v_accvgpr_read_b32 v157, a93
    v_exp_f32 v156, v156
    v_fma_f32 v157, v157, s39, -v223
    v_mfma_f32_16x16x32_bf16 v[100:103], v[180:183], v[128:131], v[100:103]
    s_waitcnt lgkmcnt(11)
    ds_read_b64_tr_b16 v[172:173], v219 offset:16384
    ds_read_b64_tr_b16 v[174:175], v219 offset:18432
    v_mfma_f32_16x16x32_bf16 v[108:111], v[180:183], v[132:135], v[108:111]
    buffer_load_dwordx4 v206, s[12:15], s38 offen offset:2048 nt lds
    v_accvgpr_read_b32 v158, a94
    v_cvt_pk_bf16_f32 v141, v154, v155
    v_exp_f32 v157, v157
    v_mfma_f32_16x16x32_bf16 v[112:115], v[184:187], v[128:131], v[112:115]
    s_waitcnt lgkmcnt(10)
    ds_read_b64_tr_b16 v[176:177], v216 offset:20480
    ds_read_b64_tr_b16 v[178:179], v216 offset:22528
    v_mfma_f32_16x16x32_bf16 v[120:123], v[184:187], v[132:135], v[120:123]
    ds_read_b64_tr_b16 a[78:79], v215 offset:34816
    v_fma_f32 v158, v158, s39, -v223
    v_accvgpr_read_b32 v159, a95
    v_exp_f32 v158, v158
    v_mfma_f32_16x16x32_bf16 v[116:119], v[188:191], v[128:131], v[116:119]
    ds_read_b64_tr_b16 v[180:181], v217 offset:20480
    ds_read_b64_tr_b16 v[182:183], v217 offset:22528
    v_mfma_f32_16x16x32_bf16 v[124:127], v[188:191], v[132:135], v[124:127]
    buffer_load_dwordx4 v207, s[12:15], s38 offen offset:3072 nt lds
    v_fma_f32 v159, v159, s39, -v223
    v_cvt_pk_bf16_f32 v142, v156, v157
    v_exp_f32 v159, v159
    s_nop 0
    v_cvt_pk_bf16_f32 v143, v158, v159
    v_mfma_f32_16x16x32_bf16 v[248:251], v[244:247], v[136:139], v[248:251]
    s_waitcnt lgkmcnt(13)
    v_accvgpr_read_b32 v144, a96
    v_fma_f32 v144, v144, s39, -v222
    v_mfma_f32_16x16x32_bf16 v[252:255], v[244:247], v[140:143], v[252:255]
    s_add_u32 m0, s36, 131072
    v_accvgpr_read_b32 v145, a97
    v_mfma_f32_16x16x32_bf16 v[0:3], v[160:163], v[136:139], v[0:3]
    s_waitcnt lgkmcnt(10)
    ds_read_b64_tr_b16 v[184:185], v218 offset:20480
    ds_read_b64_tr_b16 v[186:187], v218 offset:22528
    v_mfma_f32_16x16x32_bf16 v[8:11], v[160:163], v[140:143], v[8:11]
    ds_read_b64_tr_b16 a[80:81], v212 offset:36864
    buffer_load_dwordx4 v208, s[20:23], s65 offen offset:0 lds
    v_exp_f32 v144, v144
    v_fma_f32 v145, v145, s39, -v222
    v_accvgpr_read_b32 v146, a98
    v_mfma_f32_16x16x32_bf16 v[4:7], v[164:167], v[136:139], v[4:7]
    s_waitcnt lgkmcnt(11)
    ds_read_b64_tr_b16 v[188:189], v219 offset:20480
    ds_read_b64_tr_b16 v[190:191], v219 offset:22528
    v_mfma_f32_16x16x32_bf16 v[12:15], v[164:167], v[140:143], v[12:15]
    v_exp_f32 v145, v145
    v_fma_f32 v146, v146, s39, -v222
    v_accvgpr_read_b32 v147, a99
    v_mfma_f32_16x16x32_bf16 v[16:19], v[168:171], v[136:139], v[16:19]
    s_waitcnt lgkmcnt(10)
    ds_read_b64_tr_b16 v[160:161], v216 offset:24576
    ds_read_b64_tr_b16 v[162:163], v216 offset:26624
    v_mfma_f32_16x16x32_bf16 v[24:27], v[168:171], v[140:143], v[24:27]
    ds_read_b64_tr_b16 a[82:83], v212 offset:38912
    buffer_load_dwordx4 v209, s[20:23], s65 offen offset:1024 lds
    v_exp_f32 v146, v146
    v_fma_f32 v147, v147, s39, -v222
    v_accvgpr_read_b32 v148, a100
    v_cvt_pk_bf16_f32 v128, v144, v145
    v_mfma_f32_16x16x32_bf16 v[20:23], v[172:175], v[136:139], v[20:23]
    s_waitcnt lgkmcnt(11)
    ds_read_b64_tr_b16 v[164:165], v217 offset:24576
    ds_read_b64_tr_b16 v[166:167], v217 offset:26624
    v_mfma_f32_16x16x32_bf16 v[28:31], v[172:175], v[140:143], v[28:31]
    v_exp_f32 v147, v147
    v_fma_f32 v148, v148, s39, -v222
    v_accvgpr_read_b32 v149, a101
    v_mfma_f32_16x16x32_bf16 v[32:35], v[176:179], v[136:139], v[32:35]
    s_waitcnt lgkmcnt(10)
    ds_read_b64_tr_b16 v[168:169], v218 offset:24576
    ds_read_b64_tr_b16 v[170:171], v218 offset:26624
    v_mfma_f32_16x16x32_bf16 v[40:43], v[176:179], v[140:143], v[40:43]
    ds_read_b64_tr_b16 a[84:85], v213 offset:36864
    buffer_load_dwordx4 v210, s[20:23], s65 offen offset:2048 lds
    v_exp_f32 v148, v148
    v_fma_f32 v149, v149, s39, -v222
    v_accvgpr_read_b32 v150, a102
    v_mfma_f32_16x16x32_bf16 v[36:39], v[180:183], v[136:139], v[36:39]
    s_waitcnt lgkmcnt(11)
    ds_read_b64_tr_b16 v[172:173], v219 offset:24576
    ds_read_b64_tr_b16 v[174:175], v219 offset:26624
    v_mfma_f32_16x16x32_bf16 v[44:47], v[180:183], v[140:143], v[44:47]
    v_cvt_pk_bf16_f32 v129, v146, v147
    v_exp_f32 v149, v149
    v_fma_f32 v150, v150, s39, -v222
    v_accvgpr_read_b32 v151, a103
    v_mfma_f32_16x16x32_bf16 v[48:51], v[184:187], v[136:139], v[48:51]
    s_waitcnt lgkmcnt(10)
    ds_read_b64_tr_b16 v[176:177], v216 offset:28672
    ds_read_b64_tr_b16 v[178:179], v216 offset:30720
    v_mfma_f32_16x16x32_bf16 v[56:59], v[184:187], v[140:143], v[56:59]
    ds_read_b64_tr_b16 a[86:87], v213 offset:38912
    buffer_load_dwordx4 v211, s[20:23], s65 offen offset:3072 lds
    v_exp_f32 v150, v150
    v_fma_f32 v151, v151, s39, -v222
    v_accvgpr_read_b32 v152, a104
    v_mfma_f32_16x16x32_bf16 v[52:55], v[188:191], v[136:139], v[52:55]
    s_waitcnt lgkmcnt(11)
    ds_read_b64_tr_b16 v[180:181], v217 offset:28672
    ds_read_b64_tr_b16 v[182:183], v217 offset:30720
    v_mfma_f32_16x16x32_bf16 v[60:63], v[188:191], v[140:143], v[60:63]
    v_cvt_pk_bf16_f32 v130, v148, v149
    v_exp_f32 v151, v151
    v_fma_f32 v152, v152, s39, -v223
    v_mfma_f32_16x16x32_bf16 v[64:67], v[160:163], v[136:139], v[64:67]
    s_waitcnt lgkmcnt(10)
    ds_read_b64_tr_b16 v[184:185], v218 offset:28672
    ds_read_b64_tr_b16 v[186:187], v218 offset:30720
    v_mfma_f32_16x16x32_bf16 v[72:75], v[160:163], v[140:143], v[72:75]
    ds_read_b64_tr_b16 a[88:89], v214 offset:36864
    v_accvgpr_read_b32 v153, a105
    v_exp_f32 v152, v152
    v_fma_f32 v153, v153, s39, -v223
    v_mfma_f32_16x16x32_bf16 v[68:71], v[164:167], v[136:139], v[68:71]
    s_waitcnt lgkmcnt(11)
    ds_read_b64_tr_b16 v[188:189], v219 offset:28672
    ds_read_b64_tr_b16 v[190:191], v219 offset:30720
    v_mfma_f32_16x16x32_bf16 v[76:79], v[164:167], v[140:143], v[76:79]
    s_waitcnt vmcnt(8)
    s_barrier
    v_accvgpr_read_b32 v154, a106
    v_cvt_pk_bf16_f32 v131, v150, v151
    v_exp_f32 v153, v153
    v_fma_f32 v154, v154, s39, -v223
    v_mfma_f32_16x16x32_bf16 v[80:83], v[168:171], v[136:139], v[80:83]
    s_waitcnt lgkmcnt(10)
    ds_read_b64_tr_b16 v[160:161], v216 offset:32768
    ds_read_b64_tr_b16 v[162:163], v216 offset:34816
    v_mfma_f32_16x16x32_bf16 v[88:91], v[168:171], v[140:143], v[88:91]
    ds_read_b64_tr_b16 a[90:91], v214 offset:38912
    s_add_u32 m0, s36, 147456
    s_mov_b32 s38, 131072
    v_accvgpr_read_b32 v155, a107
    v_exp_f32 v154, v154
    v_fma_f32 v155, v155, s39, -v223
    v_mfma_f32_16x16x32_bf16 v[84:87], v[172:175], v[136:139], v[84:87]
    s_waitcnt lgkmcnt(11)
    ds_read_b64_tr_b16 v[164:165], v217 offset:32768
    ds_read_b64_tr_b16 v[166:167], v217 offset:34816
    v_mfma_f32_16x16x32_bf16 v[92:95], v[172:175], v[140:143], v[92:95]
    buffer_load_dwordx4 v204, s[12:15], s38 offen offset:0 nt lds
    v_accvgpr_read_b32 v156, a108
    v_cvt_pk_bf16_f32 v132, v152, v153
    v_exp_f32 v155, v155
    v_mfma_f32_16x16x32_bf16 v[96:99], v[176:179], v[136:139], v[96:99]
    s_waitcnt lgkmcnt(10)
    ds_read_b64_tr_b16 v[168:169], v218 offset:32768
    ds_read_b64_tr_b16 v[170:171], v218 offset:34816
    v_mfma_f32_16x16x32_bf16 v[104:107], v[176:179], v[140:143], v[104:107]
    ds_read_b64_tr_b16 a[92:93], v215 offset:36864
    v_fma_f32 v156, v156, s39, -v223
    v_accvgpr_read_b32 v157, a109
    v_exp_f32 v156, v156
    v_fma_f32 v157, v157, s39, -v223
    v_mfma_f32_16x16x32_bf16 v[100:103], v[180:183], v[136:139], v[100:103]
    s_waitcnt lgkmcnt(11)
    ds_read_b64_tr_b16 v[172:173], v219 offset:32768
    ds_read_b64_tr_b16 v[174:175], v219 offset:34816
    v_mfma_f32_16x16x32_bf16 v[108:111], v[180:183], v[140:143], v[108:111]
    buffer_load_dwordx4 v205, s[12:15], s38 offen offset:1024 nt lds
    v_accvgpr_read_b32 v158, a110
    v_cvt_pk_bf16_f32 v133, v154, v155
    v_exp_f32 v157, v157
    v_mfma_f32_16x16x32_bf16 v[112:115], v[184:187], v[136:139], v[112:115]
    s_waitcnt lgkmcnt(10)
    ds_read_b64_tr_b16 v[176:177], v216 offset:36864
    ds_read_b64_tr_b16 v[178:179], v216 offset:38912
    v_mfma_f32_16x16x32_bf16 v[120:123], v[184:187], v[140:143], v[120:123]
    ds_read_b64_tr_b16 a[94:95], v215 offset:38912
    v_fma_f32 v158, v158, s39, -v223
    v_accvgpr_read_b32 v159, a111
    v_exp_f32 v158, v158
    v_mfma_f32_16x16x32_bf16 v[116:119], v[188:191], v[136:139], v[116:119]
    ds_read_b64_tr_b16 v[180:181], v217 offset:36864
    ds_read_b64_tr_b16 v[182:183], v217 offset:38912
    v_mfma_f32_16x16x32_bf16 v[124:127], v[188:191], v[140:143], v[124:127]
    buffer_load_dwordx4 v206, s[12:15], s38 offen offset:2048 nt lds
    v_fma_f32 v159, v159, s39, -v223
    v_cvt_pk_bf16_f32 v134, v156, v157
    v_exp_f32 v159, v159
    s_nop 0
    v_cvt_pk_bf16_f32 v135, v158, v159
    v_mfma_f32_16x16x32_bf16 v[248:251], v[244:247], v[128:131], v[248:251]
    s_waitcnt lgkmcnt(13)
    v_accvgpr_read_b32 v144, a112
    v_fma_f32 v144, v144, s39, -v222
    v_mfma_f32_16x16x32_bf16 v[252:255], v[244:247], v[132:135], v[252:255]
    v_accvgpr_read_b32 v145, a113
    v_mfma_f32_16x16x32_bf16 v[0:3], v[160:163], v[128:131], v[0:3]
    s_waitcnt lgkmcnt(10)
    ds_read_b64_tr_b16 v[184:185], v218 offset:36864
    ds_read_b64_tr_b16 v[186:187], v218 offset:38912
    v_mfma_f32_16x16x32_bf16 v[8:11], v[160:163], v[132:135], v[8:11]
    ds_read_b64_tr_b16 a[96:97], v212 offset:40960
    buffer_load_dwordx4 v207, s[12:15], s38 offen offset:3072 nt lds
    v_exp_f32 v144, v144
    v_fma_f32 v145, v145, s39, -v222
    v_accvgpr_read_b32 v146, a114
    v_mfma_f32_16x16x32_bf16 v[4:7], v[164:167], v[128:131], v[4:7]
    s_waitcnt lgkmcnt(11)
    ds_read_b64_tr_b16 v[188:189], v219 offset:36864
    ds_read_b64_tr_b16 v[190:191], v219 offset:38912
    v_mfma_f32_16x16x32_bf16 v[12:15], v[164:167], v[132:135], v[12:15]
    v_exp_f32 v145, v145
    v_fma_f32 v146, v146, s39, -v222
    v_accvgpr_read_b32 v147, a115
    v_mfma_f32_16x16x32_bf16 v[16:19], v[168:171], v[128:131], v[16:19]
    s_waitcnt lgkmcnt(10)
    ds_read_b64_tr_b16 v[160:161], v216 offset:40960
    ds_read_b64_tr_b16 v[162:163], v216 offset:43008
    v_mfma_f32_16x16x32_bf16 v[24:27], v[168:171], v[132:135], v[24:27]
    ds_read_b64_tr_b16 a[98:99], v212 offset:43008
    v_exp_f32 v146, v146
    v_fma_f32 v147, v147, s39, -v222
    v_accvgpr_read_b32 v148, a116
    v_cvt_pk_bf16_f32 v136, v144, v145
    v_mfma_f32_16x16x32_bf16 v[20:23], v[172:175], v[128:131], v[20:23]
    s_waitcnt lgkmcnt(11)
    ds_read_b64_tr_b16 v[164:165], v217 offset:40960
    ds_read_b64_tr_b16 v[166:167], v217 offset:43008
    v_mfma_f32_16x16x32_bf16 v[28:31], v[172:175], v[132:135], v[28:31]
    v_exp_f32 v147, v147
    v_fma_f32 v148, v148, s39, -v222
    v_accvgpr_read_b32 v149, a117
    v_mfma_f32_16x16x32_bf16 v[32:35], v[176:179], v[128:131], v[32:35]
    s_waitcnt lgkmcnt(10)
    ds_read_b64_tr_b16 v[168:169], v218 offset:40960
    ds_read_b64_tr_b16 v[170:171], v218 offset:43008
    v_mfma_f32_16x16x32_bf16 v[40:43], v[176:179], v[132:135], v[40:43]
    ds_read_b64_tr_b16 a[100:101], v213 offset:40960
    v_exp_f32 v148, v148
    v_fma_f32 v149, v149, s39, -v222
    v_accvgpr_read_b32 v150, a118
    v_mfma_f32_16x16x32_bf16 v[36:39], v[180:183], v[128:131], v[36:39]
    s_waitcnt lgkmcnt(11)
    ds_read_b64_tr_b16 v[172:173], v219 offset:40960
    ds_read_b64_tr_b16 v[174:175], v219 offset:43008
    v_mfma_f32_16x16x32_bf16 v[44:47], v[180:183], v[132:135], v[44:47]
    v_cvt_pk_bf16_f32 v137, v146, v147
    v_exp_f32 v149, v149
    v_fma_f32 v150, v150, s39, -v222
    v_accvgpr_read_b32 v151, a119
    v_mfma_f32_16x16x32_bf16 v[48:51], v[184:187], v[128:131], v[48:51]
    s_waitcnt lgkmcnt(10)
    ds_read_b64_tr_b16 v[176:177], v216 offset:45056
    ds_read_b64_tr_b16 v[178:179], v216 offset:47104
    v_mfma_f32_16x16x32_bf16 v[56:59], v[184:187], v[132:135], v[56:59]
    ds_read_b64_tr_b16 a[102:103], v213 offset:43008
    v_exp_f32 v150, v150
    v_fma_f32 v151, v151, s39, -v222
    v_accvgpr_read_b32 v152, a120
    v_mfma_f32_16x16x32_bf16 v[52:55], v[188:191], v[128:131], v[52:55]
    s_waitcnt lgkmcnt(11)
    ds_read_b64_tr_b16 v[180:181], v217 offset:45056
    ds_read_b64_tr_b16 v[182:183], v217 offset:47104
    v_mfma_f32_16x16x32_bf16 v[60:63], v[188:191], v[132:135], v[60:63]
L_pf2:
    s_bfe_u32 s7, s2, 0x20003
    s_lshl_b32 s7, s7, 2
    s_add_u32 s7, s7, s35
    s_lshl_b32 s7, s7, 10
    s_add_u32 s7, s7, L_pf2 - concat_heads__mha_block_cached__mha_block_cached__near_ridge_kernel + 3072
    v_lshlrev_b32 v226, 6, v243
    v_add_u32 v226, s7, v226
    v_min_u32 v226, CODE_END_OFF - 64, v226
    s_mov_b64 exec, 0xffff
    global_load_dword v226, v226, s[92:93]
    s_mov_b64 exec, -1
    v_cvt_pk_bf16_f32 v138, v148, v149
    v_exp_f32 v151, v151
    v_fma_f32 v152, v152, s39, -v223
    v_mfma_f32_16x16x32_bf16 v[64:67], v[160:163], v[128:131], v[64:67]
    s_waitcnt lgkmcnt(10)
    ds_read_b64_tr_b16 v[184:185], v218 offset:45056
    ds_read_b64_tr_b16 v[186:187], v218 offset:47104
    v_mfma_f32_16x16x32_bf16 v[72:75], v[160:163], v[132:135], v[72:75]
    ds_read_b64_tr_b16 a[104:105], v214 offset:40960
    v_accvgpr_read_b32 v153, a121
    v_exp_f32 v152, v152
    v_fma_f32 v153, v153, s39, -v223
    v_mfma_f32_16x16x32_bf16 v[68:71], v[164:167], v[128:131], v[68:71]
    s_waitcnt lgkmcnt(11)
    ds_read_b64_tr_b16 v[188:189], v219 offset:45056
    ds_read_b64_tr_b16 v[190:191], v219 offset:47104
    v_mfma_f32_16x16x32_bf16 v[76:79], v[164:167], v[132:135], v[76:79]
    s_waitcnt vmcnt(9)
    s_barrier
    v_accvgpr_read_b32 v154, a122
    v_cvt_pk_bf16_f32 v139, v150, v151
    v_exp_f32 v153, v153
    v_fma_f32 v154, v154, s39, -v223
    v_mfma_f32_16x16x32_bf16 v[80:83], v[168:171], v[128:131], v[80:83]
    s_waitcnt lgkmcnt(10)
    ds_read_b64_tr_b16 v[160:161], v216 offset:49152
    ds_read_b64_tr_b16 v[162:163], v216 offset:51200
    v_mfma_f32_16x16x32_bf16 v[88:91], v[168:171], v[132:135], v[88:91]
    ds_read_b64_tr_b16 a[106:107], v214 offset:43008
    s_add_u32 m0, s36, 0
    s_mov_b32 s38, 147456
    v_accvgpr_read_b32 v155, a123
    v_exp_f32 v154, v154
    v_fma_f32 v155, v155, s39, -v223
    v_mfma_f32_16x16x32_bf16 v[84:87], v[172:175], v[128:131], v[84:87]
    s_waitcnt lgkmcnt(11)
    ds_read_b64_tr_b16 v[164:165], v217 offset:49152
    ds_read_b64_tr_b16 v[166:167], v217 offset:51200
    v_mfma_f32_16x16x32_bf16 v[92:95], v[172:175], v[132:135], v[92:95]
    buffer_load_dwordx4 v204, s[12:15], s38 offen offset:0 nt lds
    v_accvgpr_read_b32 v156, a124
    v_cvt_pk_bf16_f32 v140, v152, v153
    v_exp_f32 v155, v155
    v_mfma_f32_16x16x32_bf16 v[96:99], v[176:179], v[128:131], v[96:99]
    s_waitcnt lgkmcnt(10)
    ds_read_b64_tr_b16 v[168:169], v218 offset:49152
    ds_read_b64_tr_b16 v[170:171], v218 offset:51200
    v_mfma_f32_16x16x32_bf16 v[104:107], v[176:179], v[132:135], v[104:107]
    ds_read_b64_tr_b16 a[108:109], v215 offset:40960
    v_fma_f32 v156, v156, s39, -v223
    v_accvgpr_read_b32 v157, a125
    v_exp_f32 v156, v156
    v_fma_f32 v157, v157, s39, -v223
    v_mfma_f32_16x16x32_bf16 v[100:103], v[180:183], v[128:131], v[100:103]
    s_waitcnt lgkmcnt(11)
    ds_read_b64_tr_b16 v[172:173], v219 offset:49152
    ds_read_b64_tr_b16 v[174:175], v219 offset:51200
    v_mfma_f32_16x16x32_bf16 v[108:111], v[180:183], v[132:135], v[108:111]
    buffer_load_dwordx4 v205, s[12:15], s38 offen offset:1024 nt lds
    v_accvgpr_read_b32 v158, a126
    v_cvt_pk_bf16_f32 v141, v154, v155
    v_exp_f32 v157, v157
    v_mfma_f32_16x16x32_bf16 v[112:115], v[184:187], v[128:131], v[112:115]
    s_waitcnt lgkmcnt(10)
    ds_read_b64_tr_b16 v[176:177], v216 offset:53248
    ds_read_b64_tr_b16 v[178:179], v216 offset:55296
    v_mfma_f32_16x16x32_bf16 v[120:123], v[184:187], v[132:135], v[120:123]
    ds_read_b64_tr_b16 a[110:111], v215 offset:43008
    v_fma_f32 v158, v158, s39, -v223
    v_accvgpr_read_b32 v159, a127
    v_exp_f32 v158, v158
    v_mfma_f32_16x16x32_bf16 v[116:119], v[188:191], v[128:131], v[116:119]
    ds_read_b64_tr_b16 v[180:181], v217 offset:53248
    ds_read_b64_tr_b16 v[182:183], v217 offset:55296
    v_mfma_f32_16x16x32_bf16 v[124:127], v[188:191], v[132:135], v[124:127]
    buffer_load_dwordx4 v206, s[12:15], s38 offen offset:2048 nt lds
    v_fma_f32 v159, v159, s39, -v223
    v_cvt_pk_bf16_f32 v142, v156, v157
    v_exp_f32 v159, v159
    s_nop 0
    v_cvt_pk_bf16_f32 v143, v158, v159
    v_mfma_f32_16x16x32_bf16 v[248:251], v[244:247], v[136:139], v[248:251]
    s_waitcnt lgkmcnt(13)
    v_accvgpr_read_b32 v144, a128
    v_fma_f32 v144, v144, s39, -v222
    v_mfma_f32_16x16x32_bf16 v[252:255], v[244:247], v[140:143], v[252:255]
    v_accvgpr_read_b32 v145, a129
    v_mfma_f32_16x16x32_bf16 v[0:3], v[160:163], v[136:139], v[0:3]
    s_waitcnt lgkmcnt(10)
    ds_read_b64_tr_b16 v[184:185], v218 offset:53248
    ds_read_b64_tr_b16 v[186:187], v218 offset:55296
    v_mfma_f32_16x16x32_bf16 v[8:11], v[160:163], v[140:143], v[8:11]
    ds_read_b64_tr_b16 a[112:113], v212 offset:45056
    buffer_load_dwordx4 v207, s[12:15], s38 offen offset:3072 nt lds
    v_exp_f32 v144, v144
    v_fma_f32 v145, v145, s39, -v222
    v_accvgpr_read_b32 v146, a130
    v_mfma_f32_16x16x32_bf16 v[4:7], v[164:167], v[136:139], v[4:7]
    s_waitcnt lgkmcnt(11)
    ds_read_b64_tr_b16 v[188:189], v219 offset:53248
    ds_read_b64_tr_b16 v[190:191], v219 offset:55296
    v_mfma_f32_16x16x32_bf16 v[12:15], v[164:167], v[140:143], v[12:15]
    v_exp_f32 v145, v145
    v_fma_f32 v146, v146, s39, -v222
    v_accvgpr_read_b32 v147, a131
    v_mfma_f32_16x16x32_bf16 v[16:19], v[168:171], v[136:139], v[16:19]
    s_waitcnt lgkmcnt(10)
    ds_read_b64_tr_b16 v[160:161], v216 offset:57344
    ds_read_b64_tr_b16 v[162:163], v216 offset:59392
    v_mfma_f32_16x16x32_bf16 v[24:27], v[168:171], v[140:143], v[24:27]
    ds_read_b64_tr_b16 a[114:115], v212 offset:47104
    v_exp_f32 v146, v146
    v_fma_f32 v147, v147, s39, -v222
    v_accvgpr_read_b32 v148, a132
    v_cvt_pk_bf16_f32 v128, v144, v145
    v_mfma_f32_16x16x32_bf16 v[20:23], v[172:175], v[136:139], v[20:23]
    s_waitcnt lgkmcnt(11)
    ds_read_b64_tr_b16 v[164:165], v217 offset:57344
    ds_read_b64_tr_b16 v[166:167], v217 offset:59392
    v_mfma_f32_16x16x32_bf16 v[28:31], v[172:175], v[140:143], v[28:31]
    v_exp_f32 v147, v147
    v_fma_f32 v148, v148, s39, -v222
    v_accvgpr_read_b32 v149, a133
    v_mfma_f32_16x16x32_bf16 v[32:35], v[176:179], v[136:139], v[32:35]
    s_waitcnt lgkmcnt(10)
    ds_read_b64_tr_b16 v[168:169], v218 offset:57344
    ds_read_b64_tr_b16 v[170:171], v218 offset:59392
    v_mfma_f32_16x16x32_bf16 v[40:43], v[176:179], v[140:143], v[40:43]
    ds_read_b64_tr_b16 a[116:117], v213 offset:45056
    v_exp_f32 v148, v148
    v_fma_f32 v149, v149, s39, -v222
    v_accvgpr_read_b32 v150, a134
    v_mfma_f32_16x16x32_bf16 v[36:39], v[180:183], v[136:139], v[36:39]
    s_waitcnt lgkmcnt(11)
    ds_read_b64_tr_b16 v[172:173], v219 offset:57344
    ds_read_b64_tr_b16 v[174:175], v219 offset:59392
    v_mfma_f32_16x16x32_bf16 v[44:47], v[180:183], v[140:143], v[44:47]
    v_cvt_pk_bf16_f32 v129, v146, v147
    v_exp_f32 v149, v149
    v_fma_f32 v150, v150, s39, -v222
    v_accvgpr_read_b32 v151, a135
    v_mfma_f32_16x16x32_bf16 v[48:51], v[184:187], v[136:139], v[48:51]
    s_waitcnt lgkmcnt(10)
    ds_read_b64_tr_b16 v[176:177], v216 offset:61440
    ds_read_b64_tr_b16 v[178:179], v216 offset:63488
    v_mfma_f32_16x16x32_bf16 v[56:59], v[184:187], v[140:143], v[56:59]
    ds_read_b64_tr_b16 a[118:119], v213 offset:47104
    v_add_u32 v216, 65536, v216
    v_exp_f32 v150, v150
    v_fma_f32 v151, v151, s39, -v222
    v_accvgpr_read_b32 v152, a136
    v_mfma_f32_16x16x32_bf16 v[52:55], v[188:191], v[136:139], v[52:55]
    s_waitcnt lgkmcnt(11)
    ds_read_b64_tr_b16 v[180:181], v217 offset:61440
    ds_read_b64_tr_b16 v[182:183], v217 offset:63488
    v_mfma_f32_16x16x32_bf16 v[60:63], v[188:191], v[140:143], v[60:63]
    v_add_u32 v217, 65536, v217
    v_cvt_pk_bf16_f32 v130, v148, v149
    v_exp_f32 v151, v151
    v_fma_f32 v152, v152, s39, -v223
    v_mfma_f32_16x16x32_bf16 v[64:67], v[160:163], v[136:139], v[64:67]
    s_waitcnt lgkmcnt(10)
    ds_read_b64_tr_b16 v[184:185], v218 offset:61440
    ds_read_b64_tr_b16 v[186:187], v218 offset:63488
    v_mfma_f32_16x16x32_bf16 v[72:75], v[160:163], v[140:143], v[72:75]
    ds_read_b64_tr_b16 a[120:121], v214 offset:45056
    v_add_u32 v218, 65536, v218
    v_accvgpr_read_b32 v153, a137
    v_exp_f32 v152, v152
    v_fma_f32 v153, v153, s39, -v223
    v_mfma_f32_16x16x32_bf16 v[68:71], v[164:167], v[136:139], v[68:71]
    s_waitcnt lgkmcnt(11)
    ds_read_b64_tr_b16 v[188:189], v219 offset:61440
    ds_read_b64_tr_b16 v[190:191], v219 offset:63488
    v_mfma_f32_16x16x32_bf16 v[76:79], v[164:167], v[140:143], v[76:79]
    s_waitcnt vmcnt(5)
    s_barrier
    v_add_u32 v219, 65536, v219
    v_accvgpr_read_b32 v154, a138
    v_cvt_pk_bf16_f32 v131, v150, v151
    v_exp_f32 v153, v153
    v_fma_f32 v154, v154, s39, -v223
    v_mfma_f32_16x16x32_bf16 v[80:83], v[168:171], v[136:139], v[80:83]
    s_waitcnt lgkmcnt(10)
    ds_read_b64_tr_b16 v[160:161], v216 offset:16384
    ds_read_b64_tr_b16 v[162:163], v216 offset:18432
    v_mfma_f32_16x16x32_bf16 v[88:91], v[168:171], v[140:143], v[88:91]
    ds_read_b64_tr_b16 a[122:123], v214 offset:47104
    s_add_u32 m0, s36, 16384
    s_mov_b32 s38, 163840
    v_accvgpr_read_b32 v155, a139
    v_exp_f32 v154, v154
    v_fma_f32 v155, v155, s39, -v223
    v_mfma_f32_16x16x32_bf16 v[84:87], v[172:175], v[136:139], v[84:87]
    s_waitcnt lgkmcnt(11)
    ds_read_b64_tr_b16 v[164:165], v217 offset:16384
    ds_read_b64_tr_b16 v[166:167], v217 offset:18432
    v_mfma_f32_16x16x32_bf16 v[92:95], v[172:175], v[140:143], v[92:95]
    buffer_load_dwordx4 v204, s[12:15], s38 offen offset:0 nt lds
    v_accvgpr_read_b32 v156, a140
    v_cvt_pk_bf16_f32 v132, v152, v153
    v_exp_f32 v155, v155
    v_mfma_f32_16x16x32_bf16 v[96:99], v[176:179], v[136:139], v[96:99]
    s_waitcnt lgkmcnt(10)
    ds_read_b64_tr_b16 v[168:169], v218 offset:16384
    ds_read_b64_tr_b16 v[170:171], v218 offset:18432
    v_mfma_f32_16x16x32_bf16 v[104:107], v[176:179], v[140:143], v[104:107]
    ds_read_b64_tr_b16 a[124:125], v215 offset:45056
    v_fma_f32 v156, v156, s39, -v223
    v_accvgpr_read_b32 v157, a141
    v_exp_f32 v156, v156
    v_fma_f32 v157, v157, s39, -v223
    v_mfma_f32_16x16x32_bf16 v[100:103], v[180:183], v[136:139], v[100:103]
    s_waitcnt lgkmcnt(11)
    ds_read_b64_tr_b16 v[172:173], v219 offset:16384
    ds_read_b64_tr_b16 v[174:175], v219 offset:18432
    v_mfma_f32_16x16x32_bf16 v[108:111], v[180:183], v[140:143], v[108:111]
    buffer_load_dwordx4 v205, s[12:15], s38 offen offset:1024 nt lds
    v_accvgpr_read_b32 v158, a142
    v_cvt_pk_bf16_f32 v133, v154, v155
    v_exp_f32 v157, v157
    v_mfma_f32_16x16x32_bf16 v[112:115], v[184:187], v[136:139], v[112:115]
    s_waitcnt lgkmcnt(10)
    ds_read_b64_tr_b16 v[176:177], v216 offset:20480
    ds_read_b64_tr_b16 v[178:179], v216 offset:22528
    v_mfma_f32_16x16x32_bf16 v[120:123], v[184:187], v[140:143], v[120:123]
    ds_read_b64_tr_b16 a[126:127], v215 offset:47104
    v_fma_f32 v158, v158, s39, -v223
    v_accvgpr_read_b32 v159, a143
    v_exp_f32 v158, v158
    v_mfma_f32_16x16x32_bf16 v[116:119], v[188:191], v[136:139], v[116:119]
    ds_read_b64_tr_b16 v[180:181], v217 offset:20480
    ds_read_b64_tr_b16 v[182:183], v217 offset:22528
    v_mfma_f32_16x16x32_bf16 v[124:127], v[188:191], v[140:143], v[124:127]
    buffer_load_dwordx4 v206, s[12:15], s38 offen offset:2048 nt lds
    v_fma_f32 v159, v159, s39, -v223
    v_cvt_pk_bf16_f32 v134, v156, v157
    v_exp_f32 v159, v159
    s_nop 0
    v_cvt_pk_bf16_f32 v135, v158, v159
    v_mfma_f32_16x16x32_bf16 v[248:251], v[244:247], v[128:131], v[248:251]
    s_waitcnt lgkmcnt(13)
    v_accvgpr_read_b32 v144, a144
    v_fma_f32 v144, v144, s39, -v222
    v_mfma_f32_16x16x32_bf16 v[252:255], v[244:247], v[132:135], v[252:255]
    v_accvgpr_read_b32 v145, a145
    v_mfma_f32_16x16x32_bf16 v[0:3], v[160:163], v[128:131], v[0:3]
    s_waitcnt lgkmcnt(10)
    ds_read_b64_tr_b16 v[184:185], v218 offset:20480
    ds_read_b64_tr_b16 v[186:187], v218 offset:22528
    v_mfma_f32_16x16x32_bf16 v[8:11], v[160:163], v[132:135], v[8:11]
    v_add_u32 v212, 131072, v212
    ds_read_b64_tr_b16 a[128:129], v212 offset:0
    buffer_load_dwordx4 v207, s[12:15], s38 offen offset:3072 nt lds
    v_exp_f32 v144, v144
    v_fma_f32 v145, v145, s39, -v222
    v_accvgpr_read_b32 v146, a146
    v_mfma_f32_16x16x32_bf16 v[4:7], v[164:167], v[128:131], v[4:7]
    s_waitcnt lgkmcnt(11)
    ds_read_b64_tr_b16 v[188:189], v219 offset:20480
    ds_read_b64_tr_b16 v[190:191], v219 offset:22528
    v_mfma_f32_16x16x32_bf16 v[12:15], v[164:167], v[132:135], v[12:15]
    v_exp_f32 v145, v145
    v_fma_f32 v146, v146, s39, -v222
    v_accvgpr_read_b32 v147, a147
    v_mfma_f32_16x16x32_bf16 v[16:19], v[168:171], v[128:131], v[16:19]
    s_waitcnt lgkmcnt(10)
    ds_read_b64_tr_b16 v[160:161], v216 offset:24576
    ds_read_b64_tr_b16 v[162:163], v216 offset:26624
    v_mfma_f32_16x16x32_bf16 v[24:27], v[168:171], v[132:135], v[24:27]
    ds_read_b64_tr_b16 a[130:131], v212 offset:2048
    v_exp_f32 v146, v146
    v_fma_f32 v147, v147, s39, -v222
    v_accvgpr_read_b32 v148, a148
    v_cvt_pk_bf16_f32 v136, v144, v145
    v_mfma_f32_16x16x32_bf16 v[20:23], v[172:175], v[128:131], v[20:23]
    s_waitcnt lgkmcnt(11)
    ds_read_b64_tr_b16 v[164:165], v217 offset:24576
    ds_read_b64_tr_b16 v[166:167], v217 offset:26624
    v_mfma_f32_16x16x32_bf16 v[28:31], v[172:175], v[132:135], v[28:31]
    v_exp_f32 v147, v147
    v_fma_f32 v148, v148, s39, -v222
    v_accvgpr_read_b32 v149, a149
    v_mfma_f32_16x16x32_bf16 v[32:35], v[176:179], v[128:131], v[32:35]
    s_waitcnt lgkmcnt(10)
    ds_read_b64_tr_b16 v[168:169], v218 offset:24576
    ds_read_b64_tr_b16 v[170:171], v218 offset:26624
    v_mfma_f32_16x16x32_bf16 v[40:43], v[176:179], v[132:135], v[40:43]
    v_add_u32 v213, 131072, v213
    ds_read_b64_tr_b16 a[132:133], v213 offset:0
    v_exp_f32 v148, v148
    v_fma_f32 v149, v149, s39, -v222
    v_accvgpr_read_b32 v150, a150
    v_mfma_f32_16x16x32_bf16 v[36:39], v[180:183], v[128:131], v[36:39]
    s_waitcnt lgkmcnt(11)
    ds_read_b64_tr_b16 v[172:173], v219 offset:24576
    ds_read_b64_tr_b16 v[174:175], v219 offset:26624
    v_mfma_f32_16x16x32_bf16 v[44:47], v[180:183], v[132:135], v[44:47]
    v_cvt_pk_bf16_f32 v137, v146, v147
    v_exp_f32 v149, v149
    v_fma_f32 v150, v150, s39, -v222
    v_accvgpr_read_b32 v151, a151
    v_mfma_f32_16x16x32_bf16 v[48:51], v[184:187], v[128:131], v[48:51]
    s_waitcnt lgkmcnt(10)
    ds_read_b64_tr_b16 v[176:177], v216 offset:28672
    ds_read_b64_tr_b16 v[178:179], v216 offset:30720
    v_mfma_f32_16x16x32_bf16 v[56:59], v[184:187], v[132:135], v[56:59]
    ds_read_b64_tr_b16 a[134:135], v213 offset:2048
    v_add_u32 v216, 4294836224, v216
    v_exp_f32 v150, v150
    v_fma_f32 v151, v151, s39, -v222
    v_accvgpr_read_b32 v152, a152
    v_mfma_f32_16x16x32_bf16 v[52:55], v[188:191], v[128:131], v[52:55]
    s_waitcnt lgkmcnt(11)
    ds_read_b64_tr_b16 v[180:181], v217 offset:28672
    ds_read_b64_tr_b16 v[182:183], v217 offset:30720
    v_mfma_f32_16x16x32_bf16 v[60:63], v[188:191], v[132:135], v[60:63]
    v_add_u32 v217, 4294836224, v217
    v_cvt_pk_bf16_f32 v138, v148, v149
    v_exp_f32 v151, v151
    v_fma_f32 v152, v152, s39, -v223
    v_mfma_f32_16x16x32_bf16 v[64:67], v[160:163], v[128:131], v[64:67]
    s_waitcnt lgkmcnt(10)
    ds_read_b64_tr_b16 v[184:185], v218 offset:28672
    ds_read_b64_tr_b16 v[186:187], v218 offset:30720
    v_mfma_f32_16x16x32_bf16 v[72:75], v[160:163], v[132:135], v[72:75]
    v_add_u32 v214, 131072, v214
    ds_read_b64_tr_b16 a[136:137], v214 offset:0
    v_add_u32 v218, 4294836224, v218
    v_accvgpr_read_b32 v153, a153
    v_exp_f32 v152, v152
    v_fma_f32 v153, v153, s39, -v223
    v_mfma_f32_16x16x32_bf16 v[68:71], v[164:167], v[128:131], v[68:71]
    s_waitcnt lgkmcnt(11)
    ds_read_b64_tr_b16 v[188:189], v219 offset:28672
    ds_read_b64_tr_b16 v[190:191], v219 offset:30720
    v_mfma_f32_16x16x32_bf16 v[76:79], v[164:167], v[132:135], v[76:79]
    s_waitcnt vmcnt(4)
    s_barrier
    v_add_u32 v219, 4294836224, v219
    v_accvgpr_read_b32 v154, a154
    v_cvt_pk_bf16_f32 v139, v150, v151
    v_exp_f32 v153, v153
    v_fma_f32 v154, v154, s39, -v223
    v_mfma_f32_16x16x32_bf16 v[80:83], v[168:171], v[128:131], v[80:83]
    s_waitcnt lgkmcnt(10)
    ds_read_b64_tr_b16 v[160:161], v216 offset:0
    ds_read_b64_tr_b16 v[162:163], v216 offset:2048
    v_mfma_f32_16x16x32_bf16 v[88:91], v[168:171], v[132:135], v[88:91]
    ds_read_b64_tr_b16 a[138:139], v214 offset:2048
    s_add_u32 m0, s36, 49152
    s_mov_b32 s38, 180224
    v_accvgpr_read_b32 v155, a155
    v_exp_f32 v154, v154
    v_fma_f32 v155, v155, s39, -v223
    v_mfma_f32_16x16x32_bf16 v[84:87], v[172:175], v[128:131], v[84:87]
    s_waitcnt lgkmcnt(11)
    ds_read_b64_tr_b16 v[164:165], v217 offset:0
    ds_read_b64_tr_b16 v[166:167], v217 offset:2048
    v_mfma_f32_16x16x32_bf16 v[92:95], v[172:175], v[132:135], v[92:95]
    buffer_load_dwordx4 v204, s[12:15], s38 offen offset:0 nt lds
    v_accvgpr_read_b32 v156, a156
    v_cvt_pk_bf16_f32 v140, v152, v153
    v_exp_f32 v155, v155
    v_mfma_f32_16x16x32_bf16 v[96:99], v[176:179], v[128:131], v[96:99]
    s_waitcnt lgkmcnt(10)
    ds_read_b64_tr_b16 v[168:169], v218 offset:0
    ds_read_b64_tr_b16 v[170:171], v218 offset:2048
    v_mfma_f32_16x16x32_bf16 v[104:107], v[176:179], v[132:135], v[104:107]
    v_add_u32 v215, 131072, v215
    ds_read_b64_tr_b16 a[140:141], v215 offset:0
    buffer_load_dwordx4 v205, s[12:15], s38 offen offset:1024 nt lds
    v_fma_f32 v156, v156, s39, -v223
    v_accvgpr_read_b32 v157, a157
    v_exp_f32 v156, v156
    v_fma_f32 v157, v157, s39, -v223
    v_mfma_f32_16x16x32_bf16 v[100:103], v[180:183], v[128:131], v[100:103]
    s_waitcnt lgkmcnt(11)
    ds_read_b64_tr_b16 v[172:173], v219 offset:0
    ds_read_b64_tr_b16 v[174:175], v219 offset:2048
    v_mfma_f32_16x16x32_bf16 v[108:111], v[180:183], v[132:135], v[108:111]
    buffer_load_dwordx4 v206, s[12:15], s38 offen offset:2048 nt lds
    v_accvgpr_read_b32 v158, a158
    v_cvt_pk_bf16_f32 v141, v154, v155
    v_exp_f32 v157, v157
    v_mfma_f32_16x16x32_bf16 v[112:115], v[184:187], v[128:131], v[112:115]
    s_waitcnt lgkmcnt(10)
    ds_read_b64_tr_b16 v[176:177], v216 offset:4096
    ds_read_b64_tr_b16 v[178:179], v216 offset:6144
    v_mfma_f32_16x16x32_bf16 v[120:123], v[184:187], v[132:135], v[120:123]
    ds_read_b64_tr_b16 a[142:143], v215 offset:2048
    buffer_load_dwordx4 v207, s[12:15], s38 offen offset:3072 nt lds
    v_fma_f32 v158, v158, s39, -v223
    v_accvgpr_read_b32 v159, a159
    v_exp_f32 v158, v158
    v_mfma_f32_16x16x32_bf16 v[116:119], v[188:191], v[128:131], v[116:119]
    ds_read_b64_tr_b16 v[180:181], v217 offset:4096
    ds_read_b64_tr_b16 v[182:183], v217 offset:6144
    v_mfma_f32_16x16x32_bf16 v[124:127], v[188:191], v[132:135], v[124:127]
    s_add_u32 m0, s36, 65536
    s_add_u32 s38, s65, 114688
    v_fma_f32 v159, v159, s39, -v223
    v_cvt_pk_bf16_f32 v142, v156, v157
    v_exp_f32 v159, v159
    s_nop 0
    v_cvt_pk_bf16_f32 v143, v158, v159
    v_mfma_f32_16x16x32_bf16 v[248:251], v[244:247], v[136:139], v[248:251]
    s_waitcnt lgkmcnt(13)
    v_accvgpr_read_b32 v144, a160
    v_fma_f32 v144, v144, s39, -v222
    v_mfma_f32_16x16x32_bf16 v[252:255], v[244:247], v[140:143], v[252:255]
    buffer_load_dwordx4 v208, s[20:23], s38 offen offset:0 lds
    v_accvgpr_read_b32 v145, a161
    v_mfma_f32_16x16x32_bf16 v[0:3], v[160:163], v[136:139], v[0:3]
    s_waitcnt lgkmcnt(10)
    ds_read_b64_tr_b16 v[184:185], v218 offset:4096
    ds_read_b64_tr_b16 v[186:187], v218 offset:6144
    v_mfma_f32_16x16x32_bf16 v[8:11], v[160:163], v[140:143], v[8:11]
    ds_read_b64_tr_b16 a[144:145], v212 offset:4096
    v_exp_f32 v144, v144
    v_fma_f32 v145, v145, s39, -v222
    v_accvgpr_read_b32 v146, a162
    v_mfma_f32_16x16x32_bf16 v[4:7], v[164:167], v[136:139], v[4:7]
    s_waitcnt lgkmcnt(11)
    ds_read_b64_tr_b16 v[188:189], v219 offset:4096
    ds_read_b64_tr_b16 v[190:191], v219 offset:6144
    v_mfma_f32_16x16x32_bf16 v[12:15], v[164:167], v[140:143], v[12:15]
    v_mov_b32 v194, 0
    buffer_load_dword v194, v194, s[76:79], 0 offen sc0 sc1
    v_exp_f32 v145, v145
    v_fma_f32 v146, v146, s39, -v222
    v_accvgpr_read_b32 v147, a163
    v_mfma_f32_16x16x32_bf16 v[16:19], v[168:171], v[136:139], v[16:19]
    s_waitcnt lgkmcnt(10)
    ds_read_b64_tr_b16 v[160:161], v216 offset:8192
    ds_read_b64_tr_b16 v[162:163], v216 offset:10240
    v_mfma_f32_16x16x32_bf16 v[24:27], v[168:171], v[140:143], v[24:27]
    ds_read_b64_tr_b16 a[146:147], v212 offset:6144
    buffer_load_dwordx4 v209, s[20:23], s38 offen offset:1024 lds
    v_exp_f32 v146, v146
    v_fma_f32 v147, v147, s39, -v222
    v_accvgpr_read_b32 v148, a164
    v_cvt_pk_bf16_f32 v128, v144, v145
    v_mfma_f32_16x16x32_bf16 v[20:23], v[172:175], v[136:139], v[20:23]
    s_waitcnt lgkmcnt(11)
    ds_read_b64_tr_b16 v[164:165], v217 offset:8192
    ds_read_b64_tr_b16 v[166:167], v217 offset:10240
    v_mfma_f32_16x16x32_bf16 v[28:31], v[172:175], v[140:143], v[28:31]
    v_exp_f32 v147, v147
    v_fma_f32 v148, v148, s39, -v222
    v_accvgpr_read_b32 v149, a165
    v_mfma_f32_16x16x32_bf16 v[32:35], v[176:179], v[136:139], v[32:35]
    s_waitcnt lgkmcnt(10)
    ds_read_b64_tr_b16 v[168:169], v218 offset:8192
    ds_read_b64_tr_b16 v[170:171], v218 offset:10240
    v_mfma_f32_16x16x32_bf16 v[40:43], v[176:179], v[140:143], v[40:43]
    ds_read_b64_tr_b16 a[148:149], v213 offset:4096
    buffer_load_dwordx4 v210, s[20:23], s38 offen offset:2048 lds
    v_exp_f32 v148, v148
    v_fma_f32 v149, v149, s39, -v222
    v_accvgpr_read_b32 v150, a166
    v_mfma_f32_16x16x32_bf16 v[36:39], v[180:183], v[136:139], v[36:39]
    s_waitcnt lgkmcnt(11)
    ds_read_b64_tr_b16 v[172:173], v219 offset:8192
    ds_read_b64_tr_b16 v[174:175], v219 offset:10240
    v_mfma_f32_16x16x32_bf16 v[44:47], v[180:183], v[140:143], v[44:47]
    v_cvt_pk_bf16_f32 v129, v146, v147
    v_exp_f32 v149, v149
    v_fma_f32 v150, v150, s39, -v222
    v_accvgpr_read_b32 v151, a167
    v_mfma_f32_16x16x32_bf16 v[48:51], v[184:187], v[136:139], v[48:51]
    s_waitcnt lgkmcnt(10)
    ds_read_b64_tr_b16 v[176:177], v216 offset:12288
    ds_read_b64_tr_b16 v[178:179], v216 offset:14336
    v_mfma_f32_16x16x32_bf16 v[56:59], v[184:187], v[140:143], v[56:59]
    ds_read_b64_tr_b16 a[150:151], v213 offset:6144
    buffer_load_dwordx4 v211, s[20:23], s38 offen offset:3072 lds
    v_exp_f32 v150, v150
    v_fma_f32 v151, v151, s39, -v222
    v_accvgpr_read_b32 v152, a168
    v_mfma_f32_16x16x32_bf16 v[52:55], v[188:191], v[136:139], v[52:55]
    s_waitcnt lgkmcnt(11)
    ds_read_b64_tr_b16 v[180:181], v217 offset:12288
    ds_read_b64_tr_b16 v[182:183], v217 offset:14336
    v_mfma_f32_16x16x32_bf16 v[60:63], v[188:191], v[140:143], v[60:63]
    v_cvt_pk_bf16_f32 v130, v148, v149
    v_exp_f32 v151, v151
    v_fma_f32 v152, v152, s39, -v223
    v_mfma_f32_16x16x32_bf16 v[64:67], v[160:163], v[136:139], v[64:67]
    s_waitcnt lgkmcnt(10)
    ds_read_b64_tr_b16 v[184:185], v218 offset:12288
    ds_read_b64_tr_b16 v[186:187], v218 offset:14336
    v_mfma_f32_16x16x32_bf16 v[72:75], v[160:163], v[140:143], v[72:75]
    ds_read_b64_tr_b16 a[152:153], v214 offset:4096
    v_accvgpr_read_b32 v153, a169
    v_exp_f32 v152, v152
    v_fma_f32 v153, v153, s39, -v223
    v_mfma_f32_16x16x32_bf16 v[68:71], v[164:167], v[136:139], v[68:71]
    s_waitcnt lgkmcnt(11)
    ds_read_b64_tr_b16 v[188:189], v219 offset:12288
    ds_read_b64_tr_b16 v[190:191], v219 offset:14336
    v_mfma_f32_16x16x32_bf16 v[76:79], v[164:167], v[140:143], v[76:79]
    s_waitcnt vmcnt(9)
    s_barrier
    v_accvgpr_read_b32 v154, a170
    v_cvt_pk_bf16_f32 v131, v150, v151
    v_exp_f32 v153, v153
    v_fma_f32 v154, v154, s39, -v223
    v_mfma_f32_16x16x32_bf16 v[80:83], v[168:171], v[136:139], v[80:83]
    s_waitcnt lgkmcnt(10)
    ds_read_b64_tr_b16 v[160:161], v216 offset:16384
    ds_read_b64_tr_b16 v[162:163], v216 offset:18432
    v_mfma_f32_16x16x32_bf16 v[88:91], v[168:171], v[140:143], v[88:91]
    ds_read_b64_tr_b16 a[154:155], v214 offset:6144
    s_add_u32 m0, s36, 81920
    s_mov_b32 s38, 196608
    v_accvgpr_read_b32 v155, a171
    v_exp_f32 v154, v154
    v_fma_f32 v155, v155, s39, -v223
    v_mfma_f32_16x16x32_bf16 v[84:87], v[172:175], v[136:139], v[84:87]
    s_waitcnt lgkmcnt(11)
    ds_read_b64_tr_b16 v[164:165], v217 offset:16384
    ds_read_b64_tr_b16 v[166:167], v217 offset:18432
    v_mfma_f32_16x16x32_bf16 v[92:95], v[172:175], v[140:143], v[92:95]
    buffer_load_dwordx4 v204, s[12:15], s38 offen offset:0 nt lds
    v_accvgpr_read_b32 v156, a172
    v_cvt_pk_bf16_f32 v132, v152, v153
    v_exp_f32 v155, v155
    v_mfma_f32_16x16x32_bf16 v[96:99], v[176:179], v[136:139], v[96:99]
    s_waitcnt lgkmcnt(10)
    ds_read_b64_tr_b16 v[168:169], v218 offset:16384
    ds_read_b64_tr_b16 v[170:171], v218 offset:18432
    v_mfma_f32_16x16x32_bf16 v[104:107], v[176:179], v[140:143], v[104:107]
    ds_read_b64_tr_b16 a[156:157], v215 offset:4096
    v_fma_f32 v156, v156, s39, -v223
    v_accvgpr_read_b32 v157, a173
    v_exp_f32 v156, v156
    v_fma_f32 v157, v157, s39, -v223
    v_mfma_f32_16x16x32_bf16 v[100:103], v[180:183], v[136:139], v[100:103]
    s_waitcnt lgkmcnt(11)
    ds_read_b64_tr_b16 v[172:173], v219 offset:16384
    ds_read_b64_tr_b16 v[174:175], v219 offset:18432
    v_mfma_f32_16x16x32_bf16 v[108:111], v[180:183], v[140:143], v[108:111]
    buffer_load_dwordx4 v205, s[12:15], s38 offen offset:1024 nt lds
    v_accvgpr_read_b32 v158, a174
    v_cvt_pk_bf16_f32 v133, v154, v155
    v_exp_f32 v157, v157
    v_mfma_f32_16x16x32_bf16 v[112:115], v[184:187], v[136:139], v[112:115]
    s_waitcnt lgkmcnt(10)
    ds_read_b64_tr_b16 v[176:177], v216 offset:20480
    ds_read_b64_tr_b16 v[178:179], v216 offset:22528
    v_mfma_f32_16x16x32_bf16 v[120:123], v[184:187], v[140:143], v[120:123]
    ds_read_b64_tr_b16 a[158:159], v215 offset:6144
    v_fma_f32 v158, v158, s39, -v223
    v_accvgpr_read_b32 v159, a175
    v_exp_f32 v158, v158
    v_mfma_f32_16x16x32_bf16 v[116:119], v[188:191], v[136:139], v[116:119]
    ds_read_b64_tr_b16 v[180:181], v217 offset:20480
    ds_read_b64_tr_b16 v[182:183], v217 offset:22528
    v_mfma_f32_16x16x32_bf16 v[124:127], v[188:191], v[140:143], v[124:127]
    buffer_load_dwordx4 v206, s[12:15], s38 offen offset:2048 nt lds
    v_fma_f32 v159, v159, s39, -v223
    v_cvt_pk_bf16_f32 v134, v156, v157
    v_exp_f32 v159, v159
    s_nop 0
    v_cvt_pk_bf16_f32 v135, v158, v159
    v_mfma_f32_16x16x32_bf16 v[248:251], v[244:247], v[128:131], v[248:251]
    s_waitcnt lgkmcnt(13)
    v_accvgpr_read_b32 v144, a176
    v_fma_f32 v144, v144, s39, -v222
    v_mfma_f32_16x16x32_bf16 v[252:255], v[244:247], v[132:135], v[252:255]
    v_accvgpr_read_b32 v145, a177
    v_mfma_f32_16x16x32_bf16 v[0:3], v[160:163], v[128:131], v[0:3]
    s_waitcnt lgkmcnt(10)
    ds_read_b64_tr_b16 v[184:185], v218 offset:20480
    ds_read_b64_tr_b16 v[186:187], v218 offset:22528
    v_mfma_f32_16x16x32_bf16 v[8:11], v[160:163], v[132:135], v[8:11]
    ds_read_b64_tr_b16 a[160:161], v212 offset:8192
    buffer_load_dwordx4 v207, s[12:15], s38 offen offset:3072 nt lds
    v_exp_f32 v144, v144
    v_fma_f32 v145, v145, s39, -v222
    v_accvgpr_read_b32 v146, a178
    v_mfma_f32_16x16x32_bf16 v[4:7], v[164:167], v[128:131], v[4:7]
    s_waitcnt lgkmcnt(11)
    ds_read_b64_tr_b16 v[188:189], v219 offset:20480
    ds_read_b64_tr_b16 v[190:191], v219 offset:22528
    v_mfma_f32_16x16x32_bf16 v[12:15], v[164:167], v[132:135], v[12:15]
    v_exp_f32 v145, v145
    v_fma_f32 v146, v146, s39, -v222
    v_accvgpr_read_b32 v147, a179
    v_mfma_f32_16x16x32_bf16 v[16:19], v[168:171], v[128:131], v[16:19]
    s_waitcnt lgkmcnt(10)
    ds_read_b64_tr_b16 v[160:161], v216 offset:24576
    ds_read_b64_tr_b16 v[162:163], v216 offset:26624
    v_mfma_f32_16x16x32_bf16 v[24:27], v[168:171], v[132:135], v[24:27]
    ds_read_b64_tr_b16 a[162:163], v212 offset:10240
    v_exp_f32 v146, v146
    v_fma_f32 v147, v147, s39, -v222
    v_accvgpr_read_b32 v148, a180
    v_cvt_pk_bf16_f32 v136, v144, v145
    v_mfma_f32_16x16x32_bf16 v[20:23], v[172:175], v[128:131], v[20:23]
    s_waitcnt lgkmcnt(11)
    ds_read_b64_tr_b16 v[164:165], v217 offset:24576
    ds_read_b64_tr_b16 v[166:167], v217 offset:26624
    v_mfma_f32_16x16x32_bf16 v[28:31], v[172:175], v[132:135], v[28:31]
    v_exp_f32 v147, v147
    v_fma_f32 v148, v148, s39, -v222
    v_accvgpr_read_b32 v149, a181
    v_mfma_f32_16x16x32_bf16 v[32:35], v[176:179], v[128:131], v[32:35]
    s_waitcnt lgkmcnt(10)
    ds_read_b64_tr_b16 v[168:169], v218 offset:24576
    ds_read_b64_tr_b16 v[170:171], v218 offset:26624
    v_mfma_f32_16x16x32_bf16 v[40:43], v[176:179], v[132:135], v[40:43]
    ds_read_b64_tr_b16 a[164:165], v213 offset:8192
    v_exp_f32 v148, v148
    v_fma_f32 v149, v149, s39, -v222
    v_accvgpr_read_b32 v150, a182
    v_mfma_f32_16x16x32_bf16 v[36:39], v[180:183], v[128:131], v[36:39]
    s_waitcnt lgkmcnt(11)
    ds_read_b64_tr_b16 v[172:173], v219 offset:24576
    ds_read_b64_tr_b16 v[174:175], v219 offset:26624
    v_mfma_f32_16x16x32_bf16 v[44:47], v[180:183], v[132:135], v[44:47]
    v_cvt_pk_bf16_f32 v137, v146, v147
    v_exp_f32 v149, v149
    v_fma_f32 v150, v150, s39, -v222
    v_accvgpr_read_b32 v151, a183
    v_mfma_f32_16x16x32_bf16 v[48:51], v[184:187], v[128:131], v[48:51]
    s_waitcnt lgkmcnt(10)
    ds_read_b64_tr_b16 v[176:177], v216 offset:28672
    ds_read_b64_tr_b16 v[178:179], v216 offset:30720
    v_mfma_f32_16x16x32_bf16 v[56:59], v[184:187], v[132:135], v[56:59]
    ds_read_b64_tr_b16 a[166:167], v213 offset:10240
    v_exp_f32 v150, v150
    v_fma_f32 v151, v151, s39, -v222
    v_accvgpr_read_b32 v152, a184
    v_mfma_f32_16x16x32_bf16 v[52:55], v[188:191], v[128:131], v[52:55]
    s_waitcnt lgkmcnt(11)
    ds_read_b64_tr_b16 v[180:181], v217 offset:28672
    ds_read_b64_tr_b16 v[182:183], v217 offset:30720
    v_mfma_f32_16x16x32_bf16 v[60:63], v[188:191], v[132:135], v[60:63]
    v_cvt_pk_bf16_f32 v138, v148, v149
    v_exp_f32 v151, v151
    v_fma_f32 v152, v152, s39, -v223
    v_mfma_f32_16x16x32_bf16 v[64:67], v[160:163], v[128:131], v[64:67]
    s_waitcnt lgkmcnt(10)
    ds_read_b64_tr_b16 v[184:185], v218 offset:28672
    ds_read_b64_tr_b16 v[186:187], v218 offset:30720
    v_mfma_f32_16x16x32_bf16 v[72:75], v[160:163], v[132:135], v[72:75]
    ds_read_b64_tr_b16 a[168:169], v214 offset:8192
    v_accvgpr_read_b32 v153, a185
    v_exp_f32 v152, v152
    v_fma_f32 v153, v153, s39, -v223
    v_mfma_f32_16x16x32_bf16 v[68:71], v[164:167], v[128:131], v[68:71]
    s_waitcnt lgkmcnt(11)
    ds_read_b64_tr_b16 v[188:189], v219 offset:28672
    ds_read_b64_tr_b16 v[190:191], v219 offset:30720
    v_mfma_f32_16x16x32_bf16 v[76:79], v[164:167], v[132:135], v[76:79]
    s_waitcnt vmcnt(9)
    s_barrier
    v_accvgpr_read_b32 v154, a186
    v_cvt_pk_bf16_f32 v139, v150, v151
    v_exp_f32 v153, v153
    v_fma_f32 v154, v154, s39, -v223
    v_mfma_f32_16x16x32_bf16 v[80:83], v[168:171], v[128:131], v[80:83]
    s_waitcnt lgkmcnt(10)
    ds_read_b64_tr_b16 v[160:161], v216 offset:49152
    ds_read_b64_tr_b16 v[162:163], v216 offset:51200
    v_mfma_f32_16x16x32_bf16 v[88:91], v[168:171], v[132:135], v[88:91]
    ds_read_b64_tr_b16 a[170:171], v214 offset:10240
    s_add_u32 m0, s36, 98304
    s_mov_b32 s38, 212992
    v_accvgpr_read_b32 v155, a187
    v_exp_f32 v154, v154
    v_fma_f32 v155, v155, s39, -v223
    v_mfma_f32_16x16x32_bf16 v[84:87], v[172:175], v[128:131], v[84:87]
    s_waitcnt lgkmcnt(11)
    ds_read_b64_tr_b16 v[164:165], v217 offset:49152
    ds_read_b64_tr_b16 v[166:167], v217 offset:51200
    v_mfma_f32_16x16x32_bf16 v[92:95], v[172:175], v[132:135], v[92:95]
    buffer_load_dwordx4 v204, s[12:15], s38 offen offset:0 nt lds
    v_accvgpr_read_b32 v156, a188
    v_cvt_pk_bf16_f32 v140, v152, v153
    v_exp_f32 v155, v155
    v_mfma_f32_16x16x32_bf16 v[96:99], v[176:179], v[128:131], v[96:99]
    s_waitcnt lgkmcnt(10)
    ds_read_b64_tr_b16 v[168:169], v218 offset:49152
    ds_read_b64_tr_b16 v[170:171], v218 offset:51200
    v_mfma_f32_16x16x32_bf16 v[104:107], v[176:179], v[132:135], v[104:107]
    ds_read_b64_tr_b16 a[172:173], v215 offset:8192
    v_fma_f32 v156, v156, s39, -v223
    v_accvgpr_read_b32 v157, a189
    v_exp_f32 v156, v156
    v_fma_f32 v157, v157, s39, -v223
    v_mfma_f32_16x16x32_bf16 v[100:103], v[180:183], v[128:131], v[100:103]
    s_waitcnt lgkmcnt(11)
    ds_read_b64_tr_b16 v[172:173], v219 offset:49152
    ds_read_b64_tr_b16 v[174:175], v219 offset:51200
    v_mfma_f32_16x16x32_bf16 v[108:111], v[180:183], v[132:135], v[108:111]
    buffer_load_dwordx4 v205, s[12:15], s38 offen offset:1024 nt lds
    v_accvgpr_read_b32 v158, a190
    v_cvt_pk_bf16_f32 v141, v154, v155
    v_exp_f32 v157, v157
    v_mfma_f32_16x16x32_bf16 v[112:115], v[184:187], v[128:131], v[112:115]
    s_waitcnt lgkmcnt(10)
    ds_read_b64_tr_b16 v[176:177], v216 offset:53248
    ds_read_b64_tr_b16 v[178:179], v216 offset:55296
    v_mfma_f32_16x16x32_bf16 v[120:123], v[184:187], v[132:135], v[120:123]
    ds_read_b64_tr_b16 a[174:175], v215 offset:10240
    v_fma_f32 v158, v158, s39, -v223
    v_accvgpr_read_b32 v159, a191
    v_exp_f32 v158, v158
    v_mfma_f32_16x16x32_bf16 v[116:119], v[188:191], v[128:131], v[116:119]
    ds_read_b64_tr_b16 v[180:181], v217 offset:53248
    ds_read_b64_tr_b16 v[182:183], v217 offset:55296
    v_mfma_f32_16x16x32_bf16 v[124:127], v[188:191], v[132:135], v[124:127]
    buffer_load_dwordx4 v206, s[12:15], s38 offen offset:2048 nt lds
    v_fma_f32 v159, v159, s39, -v223
    v_cvt_pk_bf16_f32 v142, v156, v157
    v_exp_f32 v159, v159
    s_nop 0
    v_cvt_pk_bf16_f32 v143, v158, v159
    v_mfma_f32_16x16x32_bf16 v[248:251], v[244:247], v[136:139], v[248:251]
    s_waitcnt lgkmcnt(13)
    v_accvgpr_read_b32 v144, a192
    v_fma_f32 v144, v144, s39, -v222
    v_mfma_f32_16x16x32_bf16 v[252:255], v[244:247], v[140:143], v[252:255]
    v_accvgpr_read_b32 v145, a193
    v_mfma_f32_16x16x32_bf16 v[0:3], v[160:163], v[136:139], v[0:3]
    s_waitcnt lgkmcnt(10)
    ds_read_b64_tr_b16 v[184:185], v218 offset:53248
    ds_read_b64_tr_b16 v[186:187], v218 offset:55296
    v_mfma_f32_16x16x32_bf16 v[8:11], v[160:163], v[140:143], v[8:11]
    ds_read_b64_tr_b16 a[176:177], v212 offset:12288
    buffer_load_dwordx4 v207, s[12:15], s38 offen offset:3072 nt lds
    v_exp_f32 v144, v144
    v_fma_f32 v145, v145, s39, -v222
    v_accvgpr_read_b32 v146, a194
    v_mfma_f32_16x16x32_bf16 v[4:7], v[164:167], v[136:139], v[4:7]
    s_waitcnt lgkmcnt(11)
    ds_read_b64_tr_b16 v[188:189], v219 offset:53248
    ds_read_b64_tr_b16 v[190:191], v219 offset:55296
    v_mfma_f32_16x16x32_bf16 v[12:15], v[164:167], v[140:143], v[12:15]
    v_exp_f32 v145, v145
    v_fma_f32 v146, v146, s39, -v222
    v_accvgpr_read_b32 v147, a195
    v_mfma_f32_16x16x32_bf16 v[16:19], v[168:171], v[136:139], v[16:19]
    s_waitcnt lgkmcnt(10)
    ds_read_b64_tr_b16 v[160:161], v216 offset:57344
    ds_read_b64_tr_b16 v[162:163], v216 offset:59392
    v_mfma_f32_16x16x32_bf16 v[24:27], v[168:171], v[140:143], v[24:27]
    ds_read_b64_tr_b16 a[178:179], v212 offset:14336
    v_exp_f32 v146, v146
    v_fma_f32 v147, v147, s39, -v222
    v_accvgpr_read_b32 v148, a196
    v_cvt_pk_bf16_f32 v128, v144, v145
    v_mfma_f32_16x16x32_bf16 v[20:23], v[172:175], v[136:139], v[20:23]
    s_waitcnt lgkmcnt(11)
    ds_read_b64_tr_b16 v[164:165], v217 offset:57344
    ds_read_b64_tr_b16 v[166:167], v217 offset:59392
    v_mfma_f32_16x16x32_bf16 v[28:31], v[172:175], v[140:143], v[28:31]
    v_exp_f32 v147, v147
    v_fma_f32 v148, v148, s39, -v222
    v_accvgpr_read_b32 v149, a197
    v_mfma_f32_16x16x32_bf16 v[32:35], v[176:179], v[136:139], v[32:35]
    s_waitcnt lgkmcnt(10)
    ds_read_b64_tr_b16 v[168:169], v218 offset:57344
    ds_read_b64_tr_b16 v[170:171], v218 offset:59392
    v_mfma_f32_16x16x32_bf16 v[40:43], v[176:179], v[140:143], v[40:43]
    ds_read_b64_tr_b16 a[180:181], v213 offset:12288
    v_exp_f32 v148, v148
    v_fma_f32 v149, v149, s39, -v222
    v_accvgpr_read_b32 v150, a198
    v_mfma_f32_16x16x32_bf16 v[36:39], v[180:183], v[136:139], v[36:39]
    s_waitcnt lgkmcnt(11)
    ds_read_b64_tr_b16 v[172:173], v219 offset:57344
    ds_read_b64_tr_b16 v[174:175], v219 offset:59392
    v_mfma_f32_16x16x32_bf16 v[44:47], v[180:183], v[140:143], v[44:47]
    v_cvt_pk_bf16_f32 v129, v146, v147
    v_exp_f32 v149, v149
    v_fma_f32 v150, v150, s39, -v222
    v_accvgpr_read_b32 v151, a199
    v_mfma_f32_16x16x32_bf16 v[48:51], v[184:187], v[136:139], v[48:51]
    s_waitcnt lgkmcnt(10)
    ds_read_b64_tr_b16 v[176:177], v216 offset:61440
    ds_read_b64_tr_b16 v[178:179], v216 offset:63488
    v_mfma_f32_16x16x32_bf16 v[56:59], v[184:187], v[140:143], v[56:59]
    ds_read_b64_tr_b16 a[182:183], v213 offset:14336
    v_add_u32 v216, 65536, v216
    v_exp_f32 v150, v150
    v_fma_f32 v151, v151, s39, -v222
    v_accvgpr_read_b32 v152, a200
    v_mfma_f32_16x16x32_bf16 v[52:55], v[188:191], v[136:139], v[52:55]
    s_waitcnt lgkmcnt(11)
    ds_read_b64_tr_b16 v[180:181], v217 offset:61440
    ds_read_b64_tr_b16 v[182:183], v217 offset:63488
    v_mfma_f32_16x16x32_bf16 v[60:63], v[188:191], v[140:143], v[60:63]
    v_add_u32 v217, 65536, v217
    v_cvt_pk_bf16_f32 v130, v148, v149
    v_exp_f32 v151, v151
    v_fma_f32 v152, v152, s39, -v223
    v_mfma_f32_16x16x32_bf16 v[64:67], v[160:163], v[136:139], v[64:67]
    s_waitcnt lgkmcnt(10)
    ds_read_b64_tr_b16 v[184:185], v218 offset:61440
    ds_read_b64_tr_b16 v[186:187], v218 offset:63488
    v_mfma_f32_16x16x32_bf16 v[72:75], v[160:163], v[140:143], v[72:75]
    ds_read_b64_tr_b16 a[184:185], v214 offset:12288
    v_add_u32 v218, 65536, v218
    v_accvgpr_read_b32 v153, a201
    v_exp_f32 v152, v152
    v_fma_f32 v153, v153, s39, -v223
    v_mfma_f32_16x16x32_bf16 v[68:71], v[164:167], v[136:139], v[68:71]
    s_waitcnt lgkmcnt(11)
    ds_read_b64_tr_b16 v[188:189], v219 offset:61440
    ds_read_b64_tr_b16 v[190:191], v219 offset:63488
    v_mfma_f32_16x16x32_bf16 v[76:79], v[164:167], v[140:143], v[76:79]
    s_waitcnt vmcnt(4)
    s_barrier
    v_add_u32 v219, 65536, v219
    v_accvgpr_read_b32 v154, a202
    v_cvt_pk_bf16_f32 v131, v150, v151
    v_exp_f32 v153, v153
    v_fma_f32 v154, v154, s39, -v223
    v_mfma_f32_16x16x32_bf16 v[80:83], v[168:171], v[136:139], v[80:83]
    s_waitcnt lgkmcnt(10)
    ds_read_b64_tr_b16 v[160:161], v216 offset:16384
    ds_read_b64_tr_b16 v[162:163], v216 offset:18432
    v_mfma_f32_16x16x32_bf16 v[88:91], v[168:171], v[140:143], v[88:91]
    ds_read_b64_tr_b16 a[186:187], v214 offset:14336
    s_add_u32 m0, s36, 114688
    s_mov_b32 s38, 229376
    v_accvgpr_read_b32 v155, a203
    v_exp_f32 v154, v154
    v_fma_f32 v155, v155, s39, -v223
    v_mfma_f32_16x16x32_bf16 v[84:87], v[172:175], v[136:139], v[84:87]
    s_waitcnt lgkmcnt(11)
    ds_read_b64_tr_b16 v[164:165], v217 offset:16384
    ds_read_b64_tr_b16 v[166:167], v217 offset:18432
    v_mfma_f32_16x16x32_bf16 v[92:95], v[172:175], v[140:143], v[92:95]
    buffer_load_dwordx4 v204, s[12:15], s38 offen offset:0 nt lds
    v_accvgpr_read_b32 v156, a204
    v_cvt_pk_bf16_f32 v132, v152, v153
    v_exp_f32 v155, v155
    v_mfma_f32_16x16x32_bf16 v[96:99], v[176:179], v[136:139], v[96:99]
    s_waitcnt lgkmcnt(10)
    ds_read_b64_tr_b16 v[168:169], v218 offset:16384
    ds_read_b64_tr_b16 v[170:171], v218 offset:18432
    v_mfma_f32_16x16x32_bf16 v[104:107], v[176:179], v[140:143], v[104:107]
    ds_read_b64_tr_b16 a[188:189], v215 offset:12288
    v_fma_f32 v156, v156, s39, -v223
    v_accvgpr_read_b32 v157, a205
    v_exp_f32 v156, v156
    v_fma_f32 v157, v157, s39, -v223
    v_mfma_f32_16x16x32_bf16 v[100:103], v[180:183], v[136:139], v[100:103]
    s_waitcnt lgkmcnt(11)
    ds_read_b64_tr_b16 v[172:173], v219 offset:16384
    ds_read_b64_tr_b16 v[174:175], v219 offset:18432
    v_mfma_f32_16x16x32_bf16 v[108:111], v[180:183], v[140:143], v[108:111]
    buffer_load_dwordx4 v205, s[12:15], s38 offen offset:1024 nt lds
    v_accvgpr_read_b32 v158, a206
    v_cvt_pk_bf16_f32 v133, v154, v155
    v_exp_f32 v157, v157
    v_mfma_f32_16x16x32_bf16 v[112:115], v[184:187], v[136:139], v[112:115]
    s_waitcnt lgkmcnt(10)
    ds_read_b64_tr_b16 v[176:177], v216 offset:20480
    ds_read_b64_tr_b16 v[178:179], v216 offset:22528
    v_mfma_f32_16x16x32_bf16 v[120:123], v[184:187], v[140:143], v[120:123]
    ds_read_b64_tr_b16 a[190:191], v215 offset:14336
    v_fma_f32 v158, v158, s39, -v223
    v_accvgpr_read_b32 v159, a207
    v_exp_f32 v158, v158
    v_mfma_f32_16x16x32_bf16 v[116:119], v[188:191], v[136:139], v[116:119]
    ds_read_b64_tr_b16 v[180:181], v217 offset:20480
    ds_read_b64_tr_b16 v[182:183], v217 offset:22528
    v_mfma_f32_16x16x32_bf16 v[124:127], v[188:191], v[140:143], v[124:127]
    buffer_load_dwordx4 v206, s[12:15], s38 offen offset:2048 nt lds
    v_fma_f32 v159, v159, s39, -v223
    v_cvt_pk_bf16_f32 v134, v156, v157
    v_exp_f32 v159, v159
    s_nop 0
    v_cvt_pk_bf16_f32 v135, v158, v159
    s_branch ANCHOR
.p2align 12
ANCHOR:
    v_mfma_f32_16x16x32_bf16 v[248:251], v[244:247], v[128:131], v[248:251]
    s_waitcnt lgkmcnt(13)
    v_accvgpr_read_b32 v144, a208
    v_fma_f32 v144, v144, s39, -v222
    v_mfma_f32_16x16x32_bf16 v[252:255], v[244:247], v[132:135], v[252:255]
    v_accvgpr_read_b32 v145, a209
    v_mfma_f32_16x16x32_bf16 v[0:3], v[160:163], v[128:131], v[0:3]
    s_waitcnt lgkmcnt(10)
    ds_read_b64_tr_b16 v[184:185], v218 offset:20480
    ds_read_b64_tr_b16 v[186:187], v218 offset:22528
    v_mfma_f32_16x16x32_bf16 v[8:11], v[160:163], v[132:135], v[8:11]
    v_add_u32 v212, 4294901760, v212
    ds_read_b64_tr_b16 a[192:193], v212 offset:0
    buffer_load_dwordx4 v207, s[12:15], s38 offen offset:3072 nt lds
    v_exp_f32 v144, v144
    v_fma_f32 v145, v145, s39, -v222
    v_accvgpr_read_b32 v146, a210
    v_mfma_f32_16x16x32_bf16 v[4:7], v[164:167], v[128:131], v[4:7]
    s_waitcnt lgkmcnt(11)
    ds_read_b64_tr_b16 v[188:189], v219 offset:20480
    ds_read_b64_tr_b16 v[190:191], v219 offset:22528
    v_mfma_f32_16x16x32_bf16 v[12:15], v[164:167], v[132:135], v[12:15]
    v_exp_f32 v145, v145
    v_fma_f32 v146, v146, s39, -v222
    v_accvgpr_read_b32 v147, a211
    v_mfma_f32_16x16x32_bf16 v[16:19], v[168:171], v[128:131], v[16:19]
    s_waitcnt lgkmcnt(10)
    ds_read_b64_tr_b16 v[160:161], v216 offset:24576
    ds_read_b64_tr_b16 v[162:163], v216 offset:26624
    v_mfma_f32_16x16x32_bf16 v[24:27], v[168:171], v[132:135], v[24:27]
    ds_read_b64_tr_b16 a[194:195], v212 offset:2048
    v_exp_f32 v146, v146
    v_fma_f32 v147, v147, s39, -v222
    v_accvgpr_read_b32 v148, a212
    v_cvt_pk_bf16_f32 v136, v144, v145
    v_mfma_f32_16x16x32_bf16 v[20:23], v[172:175], v[128:131], v[20:23]
    s_waitcnt lgkmcnt(11)
    ds_read_b64_tr_b16 v[164:165], v217 offset:24576
    ds_read_b64_tr_b16 v[166:167], v217 offset:26624
    v_mfma_f32_16x16x32_bf16 v[28:31], v[172:175], v[132:135], v[28:31]
    v_exp_f32 v147, v147
    v_fma_f32 v148, v148, s39, -v222
    v_accvgpr_read_b32 v149, a213
    v_mfma_f32_16x16x32_bf16 v[32:35], v[176:179], v[128:131], v[32:35]
    s_waitcnt lgkmcnt(10)
    ds_read_b64_tr_b16 v[168:169], v218 offset:24576
    ds_read_b64_tr_b16 v[170:171], v218 offset:26624
    v_mfma_f32_16x16x32_bf16 v[40:43], v[176:179], v[132:135], v[40:43]
    v_add_u32 v213, 4294901760, v213
    ds_read_b64_tr_b16 a[196:197], v213 offset:0
    v_exp_f32 v148, v148
    v_fma_f32 v149, v149, s39, -v222
    v_accvgpr_read_b32 v150, a214
    v_mfma_f32_16x16x32_bf16 v[36:39], v[180:183], v[128:131], v[36:39]
    s_waitcnt lgkmcnt(11)
    ds_read_b64_tr_b16 v[172:173], v219 offset:24576
    ds_read_b64_tr_b16 v[174:175], v219 offset:26624
    v_mfma_f32_16x16x32_bf16 v[44:47], v[180:183], v[132:135], v[44:47]
L_pf3:
    s_bfe_u32 s7, s2, 0x20003
    s_lshl_b32 s7, s7, 2
    s_add_u32 s7, s7, s35
    s_lshl_b32 s7, s7, 10
    s_add_u32 s7, s7, L_pf3 - concat_heads__mha_block_cached__mha_block_cached__near_ridge_kernel + 3072
    v_lshlrev_b32 v226, 6, v243
    v_add_u32 v226, s7, v226
    v_min_u32 v226, CODE_END_OFF - 64, v226
    s_mov_b64 exec, 0xffff
    global_load_dword v226, v226, s[92:93]
    s_mov_b64 exec, -1
    v_cvt_pk_bf16_f32 v137, v146, v147
    v_exp_f32 v149, v149
    v_fma_f32 v150, v150, s39, -v222
    v_accvgpr_read_b32 v151, a215
    v_mfma_f32_16x16x32_bf16 v[48:51], v[184:187], v[128:131], v[48:51]
    s_waitcnt lgkmcnt(10)
    ds_read_b64_tr_b16 v[176:177], v216 offset:28672
    ds_read_b64_tr_b16 v[178:179], v216 offset:30720
    v_mfma_f32_16x16x32_bf16 v[56:59], v[184:187], v[132:135], v[56:59]
    ds_read_b64_tr_b16 a[198:199], v213 offset:2048
    v_exp_f32 v150, v150
    v_fma_f32 v151, v151, s39, -v222
    v_accvgpr_read_b32 v152, a216
WARM12:
    s_mov_b64 vcc, -1
    s_branch HK0
HR0:
    s_mov_b64 vcc, 0
    v_mfma_f32_16x16x32_bf16 v[52:55], v[188:191], v[128:131], v[52:55]
    s_waitcnt lgkmcnt(11)
    ds_read_b64_tr_b16 v[180:181], v217 offset:28672
    ds_read_b64_tr_b16 v[182:183], v217 offset:30720
    v_mfma_f32_16x16x32_bf16 v[60:63], v[188:191], v[132:135], v[60:63]
    v_cvt_pk_bf16_f32 v138, v148, v149
    v_exp_f32 v151, v151
    v_fma_f32 v152, v152, s39, -v223
    v_mfma_f32_16x16x32_bf16 v[64:67], v[160:163], v[128:131], v[64:67]
    s_waitcnt lgkmcnt(10)
    ds_read_b64_tr_b16 v[184:185], v218 offset:28672
    ds_read_b64_tr_b16 v[186:187], v218 offset:30720
    v_mfma_f32_16x16x32_bf16 v[72:75], v[160:163], v[132:135], v[72:75]
    v_add_u32 v214, 4294901760, v214
    ds_read_b64_tr_b16 a[200:201], v214 offset:0
    v_accvgpr_read_b32 v153, a217
    v_exp_f32 v152, v152
    v_fma_f32 v153, v153, s39, -v223
    v_mfma_f32_16x16x32_bf16 v[68:71], v[164:167], v[128:131], v[68:71]
    s_waitcnt lgkmcnt(11)
    ds_read_b64_tr_b16 v[188:189], v219 offset:28672
    ds_read_b64_tr_b16 v[190:191], v219 offset:30720
    v_mfma_f32_16x16x32_bf16 v[76:79], v[164:167], v[132:135], v[76:79]
    s_waitcnt vmcnt(5)
    s_barrier
    v_accvgpr_read_b32 v154, a218
    v_cvt_pk_bf16_f32 v139, v150, v151
    v_exp_f32 v153, v153
    v_fma_f32 v154, v154, s39, -v223
    v_mfma_f32_16x16x32_bf16 v[80:83], v[168:171], v[128:131], v[80:83]
    s_waitcnt lgkmcnt(10)
    ds_read_b64_tr_b16 v[160:161], v216 offset:32768
    ds_read_b64_tr_b16 v[162:163], v216 offset:34816
    v_mfma_f32_16x16x32_bf16 v[88:91], v[168:171], v[132:135], v[88:91]
    ds_read_b64_tr_b16 a[202:203], v214 offset:2048
    s_add_u32 m0, s36, 32768
    s_mov_b32 s38, 245760
    v_accvgpr_read_b32 v155, a219
    v_exp_f32 v154, v154
    v_fma_f32 v155, v155, s39, -v223
    v_mfma_f32_16x16x32_bf16 v[84:87], v[172:175], v[128:131], v[84:87]
    s_waitcnt lgkmcnt(11)
    ds_read_b64_tr_b16 v[164:165], v217 offset:32768
    ds_read_b64_tr_b16 v[166:167], v217 offset:34816
    v_mfma_f32_16x16x32_bf16 v[92:95], v[172:175], v[132:135], v[92:95]
    buffer_load_dwordx4 v204, s[12:15], s38 offen offset:0 nt lds
    v_accvgpr_read_b32 v156, a220
    v_cvt_pk_bf16_f32 v140, v152, v153
    v_exp_f32 v155, v155
    v_mfma_f32_16x16x32_bf16 v[96:99], v[176:179], v[128:131], v[96:99]
    s_waitcnt lgkmcnt(10)
    ds_read_b64_tr_b16 v[168:169], v218 offset:32768
    ds_read_b64_tr_b16 v[170:171], v218 offset:34816
    v_mfma_f32_16x16x32_bf16 v[104:107], v[176:179], v[132:135], v[104:107]
    v_add_u32 v215, 4294901760, v215
    ds_read_b64_tr_b16 a[204:205], v215 offset:0
    buffer_load_dwordx4 v205, s[12:15], s38 offen offset:1024 nt lds
    v_fma_f32 v156, v156, s39, -v223
    v_accvgpr_read_b32 v157, a221
    v_exp_f32 v156, v156
    v_fma_f32 v157, v157, s39, -v223
    v_mfma_f32_16x16x32_bf16 v[100:103], v[180:183], v[128:131], v[100:103]
    s_waitcnt lgkmcnt(11)
    ds_read_b64_tr_b16 v[172:173], v219 offset:32768
    ds_read_b64_tr_b16 v[174:175], v219 offset:34816
    v_mfma_f32_16x16x32_bf16 v[108:111], v[180:183], v[132:135], v[108:111]
    buffer_load_dwordx4 v206, s[12:15], s38 offen offset:2048 nt lds
    v_accvgpr_read_b32 v158, a222
    v_cvt_pk_bf16_f32 v141, v154, v155
    v_exp_f32 v157, v157
    v_mfma_f32_16x16x32_bf16 v[112:115], v[184:187], v[128:131], v[112:115]
    s_waitcnt lgkmcnt(10)
    ds_read_b64_tr_b16 v[176:177], v216 offset:36864
    ds_read_b64_tr_b16 v[178:179], v216 offset:38912
    v_mfma_f32_16x16x32_bf16 v[120:123], v[184:187], v[132:135], v[120:123]
    ds_read_b64_tr_b16 a[206:207], v215 offset:2048
    buffer_load_dwordx4 v207, s[12:15], s38 offen offset:3072 nt lds
    v_fma_f32 v158, v158, s39, -v223
    v_accvgpr_read_b32 v159, a223
    v_exp_f32 v158, v158
    v_mfma_f32_16x16x32_bf16 v[116:119], v[188:191], v[128:131], v[116:119]
    ds_read_b64_tr_b16 v[180:181], v217 offset:36864
    ds_read_b64_tr_b16 v[182:183], v217 offset:38912
    v_mfma_f32_16x16x32_bf16 v[124:127], v[188:191], v[132:135], v[124:127]
    s_add_u32 m0, s36, 147456
    v_fma_f32 v159, v159, s39, -v223
    v_cvt_pk_bf16_f32 v142, v156, v157
    v_exp_f32 v159, v159
    s_nop 0
    v_cvt_pk_bf16_f32 v143, v158, v159
    v_mfma_f32_16x16x32_bf16 v[248:251], v[244:247], v[136:139], v[248:251]
    s_waitcnt lgkmcnt(13)
    v_accvgpr_read_b32 v144, a224
    v_fma_f32 v144, v144, s39, -v222
    v_mfma_f32_16x16x32_bf16 v[252:255], v[244:247], v[140:143], v[252:255]
    buffer_load_dwordx4 v208, s[20:23], s66 offen offset:0 lds
    v_accvgpr_read_b32 v145, a225
    v_mfma_f32_16x16x32_bf16 v[0:3], v[160:163], v[136:139], v[0:3]
    s_waitcnt lgkmcnt(10)
    ds_read_b64_tr_b16 v[184:185], v218 offset:36864
    ds_read_b64_tr_b16 v[186:187], v218 offset:38912
    v_mfma_f32_16x16x32_bf16 v[8:11], v[160:163], v[140:143], v[8:11]
    ds_read_b64_tr_b16 a[208:209], v212 offset:4096
    buffer_load_dwordx4 v209, s[20:23], s66 offen offset:1024 lds
    v_exp_f32 v144, v144
    v_fma_f32 v145, v145, s39, -v222
    v_accvgpr_read_b32 v146, a226
    v_mfma_f32_16x16x32_bf16 v[4:7], v[164:167], v[136:139], v[4:7]
    s_waitcnt lgkmcnt(11)
    ds_read_b64_tr_b16 v[188:189], v219 offset:36864
    ds_read_b64_tr_b16 v[190:191], v219 offset:38912
    v_mfma_f32_16x16x32_bf16 v[12:15], v[164:167], v[140:143], v[12:15]
    buffer_load_dwordx4 v210, s[20:23], s66 offen offset:2048 lds
    v_exp_f32 v145, v145
    v_fma_f32 v146, v146, s39, -v222
    v_accvgpr_read_b32 v147, a227
    v_mfma_f32_16x16x32_bf16 v[16:19], v[168:171], v[136:139], v[16:19]
    s_waitcnt lgkmcnt(10)
    ds_read_b64_tr_b16 v[160:161], v216 offset:40960
    ds_read_b64_tr_b16 v[162:163], v216 offset:43008
    v_mfma_f32_16x16x32_bf16 v[24:27], v[168:171], v[140:143], v[24:27]
    ds_read_b64_tr_b16 a[210:211], v212 offset:6144
    buffer_load_dwordx4 v211, s[20:23], s66 offen offset:3072 lds
    v_exp_f32 v146, v146
    v_fma_f32 v147, v147, s39, -v222
    v_accvgpr_read_b32 v148, a228
    v_cvt_pk_bf16_f32 v128, v144, v145
    v_mfma_f32_16x16x32_bf16 v[20:23], v[172:175], v[136:139], v[20:23]
    s_waitcnt lgkmcnt(11)
    ds_read_b64_tr_b16 v[164:165], v217 offset:40960
    ds_read_b64_tr_b16 v[166:167], v217 offset:43008
    v_mfma_f32_16x16x32_bf16 v[28:31], v[172:175], v[140:143], v[28:31]
    s_add_u32 m0, s36, 0
    s_add_u32 s38, s66, 114688
    v_exp_f32 v147, v147
    v_fma_f32 v148, v148, s39, -v222
    v_accvgpr_read_b32 v149, a229
    v_mfma_f32_16x16x32_bf16 v[32:35], v[176:179], v[136:139], v[32:35]
    s_waitcnt lgkmcnt(10)
    ds_read_b64_tr_b16 v[168:169], v218 offset:40960
    ds_read_b64_tr_b16 v[170:171], v218 offset:43008
    v_mfma_f32_16x16x32_bf16 v[40:43], v[176:179], v[140:143], v[40:43]
    ds_read_b64_tr_b16 a[212:213], v213 offset:4096
    buffer_load_dwordx4 v208, s[20:23], s38 offen offset:0 lds
    v_exp_f32 v148, v148
    v_fma_f32 v149, v149, s39, -v222
    v_accvgpr_read_b32 v150, a230
    v_mfma_f32_16x16x32_bf16 v[36:39], v[180:183], v[136:139], v[36:39]
    s_waitcnt lgkmcnt(11)
    ds_read_b64_tr_b16 v[172:173], v219 offset:40960
    ds_read_b64_tr_b16 v[174:175], v219 offset:43008
    v_mfma_f32_16x16x32_bf16 v[44:47], v[180:183], v[140:143], v[44:47]
    buffer_load_dwordx4 v209, s[20:23], s38 offen offset:1024 lds
    v_cvt_pk_bf16_f32 v129, v146, v147
    v_exp_f32 v149, v149
    v_fma_f32 v150, v150, s39, -v222
    v_accvgpr_read_b32 v151, a231
    v_mfma_f32_16x16x32_bf16 v[48:51], v[184:187], v[136:139], v[48:51]
    s_waitcnt lgkmcnt(10)
    ds_read_b64_tr_b16 v[176:177], v216 offset:45056
    ds_read_b64_tr_b16 v[178:179], v216 offset:47104
    v_mfma_f32_16x16x32_bf16 v[56:59], v[184:187], v[140:143], v[56:59]
    ds_read_b64_tr_b16 a[214:215], v213 offset:6144
    buffer_load_dwordx4 v210, s[20:23], s38 offen offset:2048 lds
    v_exp_f32 v150, v150
    v_fma_f32 v151, v151, s39, -v222
    v_accvgpr_read_b32 v152, a232
WARM13:
    s_mov_b64 vcc, -1
    s_branch HK1
HR1:
    s_mov_b64 vcc, 0
    v_mfma_f32_16x16x32_bf16 v[52:55], v[188:191], v[136:139], v[52:55]
    s_waitcnt lgkmcnt(11)
    ds_read_b64_tr_b16 v[180:181], v217 offset:45056
    ds_read_b64_tr_b16 v[182:183], v217 offset:47104
    v_mfma_f32_16x16x32_bf16 v[60:63], v[188:191], v[140:143], v[60:63]
    v_cvt_pk_bf16_f32 v130, v148, v149
    v_exp_f32 v151, v151
    v_fma_f32 v152, v152, s39, -v223
    v_mfma_f32_16x16x32_bf16 v[64:67], v[160:163], v[136:139], v[64:67]
    s_waitcnt lgkmcnt(10)
    ds_read_b64_tr_b16 v[184:185], v218 offset:45056
    ds_read_b64_tr_b16 v[186:187], v218 offset:47104
    v_mfma_f32_16x16x32_bf16 v[72:75], v[160:163], v[140:143], v[72:75]
    ds_read_b64_tr_b16 a[216:217], v214 offset:4096
    buffer_load_dwordx4 v211, s[20:23], s38 offen offset:3072 lds
    v_accvgpr_read_b32 v153, a233
    v_exp_f32 v152, v152
    v_fma_f32 v153, v153, s39, -v223
    v_mfma_f32_16x16x32_bf16 v[68:71], v[164:167], v[136:139], v[68:71]
    s_waitcnt lgkmcnt(11)
    ds_read_b64_tr_b16 v[188:189], v219 offset:45056
    ds_read_b64_tr_b16 v[190:191], v219 offset:47104
    v_mfma_f32_16x16x32_bf16 v[76:79], v[164:167], v[140:143], v[76:79]
    s_waitcnt vmcnt(13)
    s_barrier
    v_accvgpr_read_b32 v154, a234
    v_cvt_pk_bf16_f32 v131, v150, v151
    v_exp_f32 v153, v153
    v_fma_f32 v154, v154, s39, -v223
    v_mfma_f32_16x16x32_bf16 v[80:83], v[168:171], v[136:139], v[80:83]
    s_waitcnt lgkmcnt(10)
    ds_read_b64_tr_b16 v[160:161], v216 offset:49152
    ds_read_b64_tr_b16 v[162:163], v216 offset:51200
    v_mfma_f32_16x16x32_bf16 v[88:91], v[168:171], v[140:143], v[88:91]
    ds_read_b64_tr_b16 a[218:219], v214 offset:6144
    s_add_u32 m0, s36, 16384
    v_accvgpr_read_b32 v155, a235
    v_exp_f32 v154, v154
    v_fma_f32 v155, v155, s39, -v223
    v_mfma_f32_16x16x32_bf16 v[84:87], v[172:175], v[136:139], v[84:87]
    s_waitcnt lgkmcnt(11)
    ds_read_b64_tr_b16 v[164:165], v217 offset:49152
    ds_read_b64_tr_b16 v[166:167], v217 offset:51200
    v_mfma_f32_16x16x32_bf16 v[92:95], v[172:175], v[140:143], v[92:95]
    buffer_load_dwordx4 v208, s[20:23], s67 offen offset:0 lds
    v_accvgpr_read_b32 v156, a236
    v_cvt_pk_bf16_f32 v132, v152, v153
    v_exp_f32 v155, v155
    v_mfma_f32_16x16x32_bf16 v[96:99], v[176:179], v[136:139], v[96:99]
    s_waitcnt lgkmcnt(10)
    ds_read_b64_tr_b16 v[168:169], v218 offset:49152
    ds_read_b64_tr_b16 v[170:171], v218 offset:51200
    v_mfma_f32_16x16x32_bf16 v[104:107], v[176:179], v[140:143], v[104:107]
    ds_read_b64_tr_b16 a[220:221], v215 offset:4096
    buffer_load_dwordx4 v209, s[20:23], s67 offen offset:1024 lds
    v_fma_f32 v156, v156, s39, -v223
    v_accvgpr_read_b32 v157, a237
    v_exp_f32 v156, v156
    v_fma_f32 v157, v157, s39, -v223
    v_mfma_f32_16x16x32_bf16 v[100:103], v[180:183], v[136:139], v[100:103]
    s_waitcnt lgkmcnt(11)
    ds_read_b64_tr_b16 v[172:173], v219 offset:49152
    ds_read_b64_tr_b16 v[174:175], v219 offset:51200
    v_mfma_f32_16x16x32_bf16 v[108:111], v[180:183], v[140:143], v[108:111]
    buffer_load_dwordx4 v210, s[20:23], s67 offen offset:2048 lds
    v_accvgpr_read_b32 v158, a238
    v_cvt_pk_bf16_f32 v133, v154, v155
    v_exp_f32 v157, v157
    v_mfma_f32_16x16x32_bf16 v[112:115], v[184:187], v[136:139], v[112:115]
    s_waitcnt lgkmcnt(10)
    ds_read_b64_tr_b16 v[176:177], v216 offset:53248
    ds_read_b64_tr_b16 v[178:179], v216 offset:55296
    v_mfma_f32_16x16x32_bf16 v[120:123], v[184:187], v[140:143], v[120:123]
    ds_read_b64_tr_b16 a[222:223], v215 offset:6144
    buffer_load_dwordx4 v211, s[20:23], s67 offen offset:3072 lds
    v_fma_f32 v158, v158, s39, -v223
    v_accvgpr_read_b32 v159, a239
    v_exp_f32 v158, v158
    v_mfma_f32_16x16x32_bf16 v[116:119], v[188:191], v[136:139], v[116:119]
    ds_read_b64_tr_b16 v[180:181], v217 offset:53248
    ds_read_b64_tr_b16 v[182:183], v217 offset:55296
    v_mfma_f32_16x16x32_bf16 v[124:127], v[188:191], v[140:143], v[124:127]
    s_add_u32 m0, s36, 49152
    s_add_u32 s38, s67, 114688
    v_fma_f32 v159, v159, s39, -v223
    v_cvt_pk_bf16_f32 v134, v156, v157
    v_exp_f32 v159, v159
    s_nop 0
    v_cvt_pk_bf16_f32 v135, v158, v159
    v_mfma_f32_16x16x32_bf16 v[248:251], v[244:247], v[128:131], v[248:251]
    s_waitcnt lgkmcnt(13)
    v_accvgpr_read_b32 v144, a240
    v_fma_f32 v144, v144, s39, -v222
    v_mfma_f32_16x16x32_bf16 v[252:255], v[244:247], v[132:135], v[252:255]
    buffer_load_dwordx4 v208, s[20:23], s38 offen offset:0 lds
    v_accvgpr_read_b32 v145, a241
    v_mfma_f32_16x16x32_bf16 v[0:3], v[160:163], v[128:131], v[0:3]
    s_waitcnt lgkmcnt(10)
    ds_read_b64_tr_b16 v[184:185], v218 offset:53248
    ds_read_b64_tr_b16 v[186:187], v218 offset:55296
    v_mfma_f32_16x16x32_bf16 v[8:11], v[160:163], v[132:135], v[8:11]
    ds_read_b64_tr_b16 a[224:225], v212 offset:8192
    buffer_load_dwordx4 v209, s[20:23], s38 offen offset:1024 lds
    v_exp_f32 v144, v144
    v_fma_f32 v145, v145, s39, -v222
    v_accvgpr_read_b32 v146, a242
    v_mfma_f32_16x16x32_bf16 v[4:7], v[164:167], v[128:131], v[4:7]
    s_waitcnt lgkmcnt(11)
    ds_read_b64_tr_b16 v[188:189], v219 offset:53248
    ds_read_b64_tr_b16 v[190:191], v219 offset:55296
    v_mfma_f32_16x16x32_bf16 v[12:15], v[164:167], v[132:135], v[12:15]
    buffer_load_dwordx4 v210, s[20:23], s38 offen offset:2048 lds
    v_exp_f32 v145, v145
    v_fma_f32 v146, v146, s39, -v222
    v_accvgpr_read_b32 v147, a243
    v_mfma_f32_16x16x32_bf16 v[16:19], v[168:171], v[128:131], v[16:19]
    s_waitcnt lgkmcnt(10)
    ds_read_b64_tr_b16 v[160:161], v216 offset:57344
    ds_read_b64_tr_b16 v[162:163], v216 offset:59392
    v_mfma_f32_16x16x32_bf16 v[24:27], v[168:171], v[132:135], v[24:27]
    ds_read_b64_tr_b16 a[226:227], v212 offset:10240
    buffer_load_dwordx4 v211, s[20:23], s38 offen offset:3072 lds
    v_exp_f32 v146, v146
    v_fma_f32 v147, v147, s39, -v222
    v_accvgpr_read_b32 v148, a244
    v_cvt_pk_bf16_f32 v136, v144, v145
    v_mfma_f32_16x16x32_bf16 v[20:23], v[172:175], v[128:131], v[20:23]
    s_waitcnt lgkmcnt(11)
    ds_read_b64_tr_b16 v[164:165], v217 offset:57344
    ds_read_b64_tr_b16 v[166:167], v217 offset:59392
    v_mfma_f32_16x16x32_bf16 v[28:31], v[172:175], v[132:135], v[28:31]
    s_add_u32 m0, s36, 131072
    v_exp_f32 v147, v147
    v_fma_f32 v148, v148, s39, -v222
    v_accvgpr_read_b32 v149, a245
    v_mfma_f32_16x16x32_bf16 v[32:35], v[176:179], v[128:131], v[32:35]
    s_waitcnt lgkmcnt(10)
    ds_read_b64_tr_b16 v[168:169], v218 offset:57344
    ds_read_b64_tr_b16 v[170:171], v218 offset:59392
    v_mfma_f32_16x16x32_bf16 v[40:43], v[176:179], v[132:135], v[40:43]
    ds_read_b64_tr_b16 a[228:229], v213 offset:8192
    buffer_load_dwordx4 v208, s[20:23], s68 offen offset:0 lds
    v_exp_f32 v148, v148
    v_fma_f32 v149, v149, s39, -v222
    v_accvgpr_read_b32 v150, a246
    v_mfma_f32_16x16x32_bf16 v[36:39], v[180:183], v[128:131], v[36:39]
    s_waitcnt lgkmcnt(11)
    ds_read_b64_tr_b16 v[172:173], v219 offset:57344
    ds_read_b64_tr_b16 v[174:175], v219 offset:59392
    v_mfma_f32_16x16x32_bf16 v[44:47], v[180:183], v[132:135], v[44:47]
    buffer_load_dwordx4 v209, s[20:23], s68 offen offset:1024 lds
    v_cvt_pk_bf16_f32 v137, v146, v147
    v_exp_f32 v149, v149
    v_fma_f32 v150, v150, s39, -v222
    v_accvgpr_read_b32 v151, a247
    v_mfma_f32_16x16x32_bf16 v[48:51], v[184:187], v[128:131], v[48:51]
    s_waitcnt lgkmcnt(10)
    ds_read_b64_tr_b16 v[176:177], v216 offset:61440
    ds_read_b64_tr_b16 v[178:179], v216 offset:63488
    v_mfma_f32_16x16x32_bf16 v[56:59], v[184:187], v[132:135], v[56:59]
    ds_read_b64_tr_b16 a[230:231], v213 offset:10240
    v_add_u32 v216, 4294901760, v216
    v_exp_f32 v150, v150
    v_fma_f32 v151, v151, s39, -v222
    v_accvgpr_read_b32 v152, a248
WARM14:
    s_mov_b64 vcc, -1
    s_branch HK2
HR2:
    s_mov_b64 vcc, 0
    v_mfma_f32_16x16x32_bf16 v[52:55], v[188:191], v[128:131], v[52:55]
    s_waitcnt lgkmcnt(11)
    ds_read_b64_tr_b16 v[180:181], v217 offset:61440
    ds_read_b64_tr_b16 v[182:183], v217 offset:63488
    v_mfma_f32_16x16x32_bf16 v[60:63], v[188:191], v[132:135], v[60:63]
    buffer_load_dwordx4 v210, s[20:23], s68 offen offset:2048 lds
    v_add_u32 v217, 4294901760, v217
    v_cvt_pk_bf16_f32 v138, v148, v149
    v_exp_f32 v151, v151
    v_fma_f32 v152, v152, s39, -v223
    v_mfma_f32_16x16x32_bf16 v[64:67], v[160:163], v[128:131], v[64:67]
    s_waitcnt lgkmcnt(10)
    ds_read_b64_tr_b16 v[184:185], v218 offset:61440
    ds_read_b64_tr_b16 v[186:187], v218 offset:63488
    v_mfma_f32_16x16x32_bf16 v[72:75], v[160:163], v[132:135], v[72:75]
    ds_read_b64_tr_b16 a[232:233], v214 offset:8192
    buffer_load_dwordx4 v211, s[20:23], s68 offen offset:3072 lds
    v_add_u32 v218, 4294901760, v218
    v_accvgpr_read_b32 v153, a249
    v_exp_f32 v152, v152
    v_fma_f32 v153, v153, s39, -v223
    v_mfma_f32_16x16x32_bf16 v[68:71], v[164:167], v[128:131], v[68:71]
    s_waitcnt lgkmcnt(11)
    ds_read_b64_tr_b16 v[188:189], v219 offset:61440
    ds_read_b64_tr_b16 v[190:191], v219 offset:63488
    v_mfma_f32_16x16x32_bf16 v[76:79], v[164:167], v[132:135], v[76:79]
    s_waitcnt vmcnt(20)
    s_barrier
    v_add_u32 v219, 4294901760, v219
    v_accvgpr_read_b32 v154, a250
    v_cvt_pk_bf16_f32 v139, v150, v151
    v_exp_f32 v153, v153
    v_fma_f32 v154, v154, s39, -v223
    v_mfma_f32_16x16x32_bf16 v[80:83], v[168:171], v[128:131], v[80:83]
    s_waitcnt lgkmcnt(10)
    ds_read_b64_tr_b16 v[160:161], v216 offset:32768
    ds_read_b64_tr_b16 v[162:163], v216 offset:34816
    v_mfma_f32_16x16x32_bf16 v[88:91], v[168:171], v[132:135], v[88:91]
    ds_read_b64_tr_b16 a[234:235], v214 offset:10240
    s_add_u32 m0, s36, 81920
    s_add_u32 s38, s68, 114688
    v_accvgpr_read_b32 v155, a251
    v_exp_f32 v154, v154
    v_fma_f32 v155, v155, s39, -v223
    v_mfma_f32_16x16x32_bf16 v[84:87], v[172:175], v[128:131], v[84:87]
    s_waitcnt lgkmcnt(11)
    ds_read_b64_tr_b16 v[164:165], v217 offset:32768
    ds_read_b64_tr_b16 v[166:167], v217 offset:34816
    v_mfma_f32_16x16x32_bf16 v[92:95], v[172:175], v[132:135], v[92:95]
    buffer_load_dwordx4 v208, s[20:23], s38 offen offset:0 lds
    v_accvgpr_read_b32 v156, a252
    v_cvt_pk_bf16_f32 v140, v152, v153
    v_exp_f32 v155, v155
    v_mfma_f32_16x16x32_bf16 v[96:99], v[176:179], v[128:131], v[96:99]
    s_waitcnt lgkmcnt(10)
    ds_read_b64_tr_b16 v[168:169], v218 offset:32768
    ds_read_b64_tr_b16 v[170:171], v218 offset:34816
    v_mfma_f32_16x16x32_bf16 v[104:107], v[176:179], v[132:135], v[104:107]
    ds_read_b64_tr_b16 a[236:237], v215 offset:8192
    buffer_load_dwordx4 v209, s[20:23], s38 offen offset:1024 lds
    v_fma_f32 v156, v156, s39, -v223
    v_accvgpr_read_b32 v157, a253
    v_exp_f32 v156, v156
    v_fma_f32 v157, v157, s39, -v223
    v_mfma_f32_16x16x32_bf16 v[100:103], v[180:183], v[128:131], v[100:103]
    s_waitcnt lgkmcnt(11)
    ds_read_b64_tr_b16 v[172:173], v219 offset:32768
    ds_read_b64_tr_b16 v[174:175], v219 offset:34816
    v_mfma_f32_16x16x32_bf16 v[108:111], v[180:183], v[132:135], v[108:111]
    buffer_load_dwordx4 v210, s[20:23], s38 offen offset:2048 lds
    v_accvgpr_read_b32 v158, a254
    v_cvt_pk_bf16_f32 v141, v154, v155
    v_exp_f32 v157, v157
    v_mfma_f32_16x16x32_bf16 v[112:115], v[184:187], v[128:131], v[112:115]
    s_waitcnt lgkmcnt(10)
    ds_read_b64_tr_b16 v[176:177], v216 offset:36864
    ds_read_b64_tr_b16 v[178:179], v216 offset:38912
    v_mfma_f32_16x16x32_bf16 v[120:123], v[184:187], v[132:135], v[120:123]
    ds_read_b64_tr_b16 a[238:239], v215 offset:10240
    v_fma_f32 v158, v158, s39, -v223
    v_accvgpr_read_b32 v159, a255
    v_exp_f32 v158, v158
    v_mfma_f32_16x16x32_bf16 v[116:119], v[188:191], v[128:131], v[116:119]
    ds_read_b64_tr_b16 v[180:181], v217 offset:36864
    ds_read_b64_tr_b16 v[182:183], v217 offset:38912
    v_mfma_f32_16x16x32_bf16 v[124:127], v[188:191], v[132:135], v[124:127]
    buffer_load_dwordx4 v211, s[20:23], s38 offen offset:3072 lds
    v_fma_f32 v159, v159, s39, -v223
    v_cvt_pk_bf16_f32 v142, v156, v157
    v_exp_f32 v159, v159
    s_nop 0
    v_cvt_pk_bf16_f32 v143, v158, v159
    v_mfma_f32_16x16x32_bf16 v[248:251], v[244:247], v[136:139], v[248:251]
    s_waitcnt lgkmcnt(13)
    v_mfma_f32_16x16x32_bf16 v[252:255], v[244:247], v[140:143], v[252:255]
    s_add_u32 m0, s36, 98304
    v_mfma_f32_16x16x32_bf16 v[0:3], v[160:163], v[136:139], v[0:3]
    s_waitcnt lgkmcnt(10)
    ds_read_b64_tr_b16 v[184:185], v218 offset:36864
    ds_read_b64_tr_b16 v[186:187], v218 offset:38912
    v_mfma_f32_16x16x32_bf16 v[8:11], v[160:163], v[140:143], v[8:11]
    ds_read_b64_tr_b16 a[240:241], v212 offset:12288
    buffer_load_dwordx4 v208, s[20:23], s69 offen offset:0 lds
    v_mfma_f32_16x16x32_bf16 v[4:7], v[164:167], v[136:139], v[4:7]
    s_waitcnt lgkmcnt(11)
    ds_read_b64_tr_b16 v[188:189], v219 offset:36864
    ds_read_b64_tr_b16 v[190:191], v219 offset:38912
    v_mfma_f32_16x16x32_bf16 v[12:15], v[164:167], v[140:143], v[12:15]
    v_rcp_f32 v197, v248
    v_mfma_f32_16x16x32_bf16 v[16:19], v[168:171], v[136:139], v[16:19]
    s_waitcnt lgkmcnt(10)
    ds_read_b64_tr_b16 v[160:161], v216 offset:40960
    ds_read_b64_tr_b16 v[162:163], v216 offset:43008
    v_mfma_f32_16x16x32_bf16 v[24:27], v[168:171], v[140:143], v[24:27]
    ds_read_b64_tr_b16 a[242:243], v212 offset:14336
    buffer_load_dwordx4 v209, s[20:23], s69 offen offset:1024 lds
    v_mfma_f32_16x16x32_bf16 v[20:23], v[172:175], v[136:139], v[20:23]
    s_waitcnt lgkmcnt(11)
    ds_read_b64_tr_b16 v[164:165], v217 offset:40960
    ds_read_b64_tr_b16 v[166:167], v217 offset:43008
    v_mfma_f32_16x16x32_bf16 v[28:31], v[172:175], v[140:143], v[28:31]
    v_rcp_f32 v199, v252
    v_mul_f32 v0, v0, v197
    v_mul_f32 v1, v1, v197
    v_cvt_pk_bf16_f32 v0, v0, v1
    v_mul_f32 v2, v2, v197
    v_mul_f32 v3, v3, v197
    v_cvt_pk_bf16_f32 v1, v2, v3
    v_mfma_f32_16x16x32_bf16 v[32:35], v[176:179], v[136:139], v[32:35]
    s_waitcnt lgkmcnt(10)
    ds_read_b64_tr_b16 v[168:169], v218 offset:40960
    ds_read_b64_tr_b16 v[170:171], v218 offset:43008
    v_mfma_f32_16x16x32_bf16 v[40:43], v[176:179], v[140:143], v[40:43]
    ds_read_b64_tr_b16 a[244:245], v213 offset:12288
    buffer_load_dwordx4 v210, s[20:23], s69 offen offset:2048 lds
    v_mul_f32 v4, v4, v197
    v_mul_f32 v5, v5, v197
    v_mfma_f32_16x16x32_bf16 v[36:39], v[180:183], v[136:139], v[36:39]
    s_waitcnt lgkmcnt(11)
    ds_read_b64_tr_b16 v[172:173], v219 offset:40960
    ds_read_b64_tr_b16 v[174:175], v219 offset:43008
    v_mfma_f32_16x16x32_bf16 v[44:47], v[180:183], v[140:143], v[44:47]
    v_cvt_pk_bf16_f32 v2, v4, v5
    v_mul_f32 v6, v6, v197
    v_mul_f32 v7, v7, v197
    v_cvt_pk_bf16_f32 v3, v6, v7
    v_mul_f32 v8, v8, v199
    v_mul_f32 v9, v9, v199
    v_cvt_pk_bf16_f32 v8, v8, v9
    v_mul_f32 v10, v10, v199
    v_mul_f32 v11, v11, v199
    v_cvt_pk_bf16_f32 v9, v10, v11
    v_mul_f32 v12, v12, v199
    v_mul_f32 v13, v13, v199
    v_cvt_pk_bf16_f32 v10, v12, v13
    v_mul_f32 v14, v14, v199
    v_mfma_f32_16x16x32_bf16 v[48:51], v[184:187], v[136:139], v[48:51]
    s_waitcnt lgkmcnt(10)
    ds_read_b64_tr_b16 v[176:177], v216 offset:45056
    ds_read_b64_tr_b16 v[178:179], v216 offset:47104
    v_mfma_f32_16x16x32_bf16 v[56:59], v[184:187], v[140:143], v[56:59]
    ds_read_b64_tr_b16 a[246:247], v213 offset:14336
    buffer_load_dwordx4 v211, s[20:23], s69 offen offset:3072 lds
    v_mul_f32 v15, v15, v199
    v_cvt_pk_bf16_f32 v11, v14, v15
    v_mfma_f32_16x16x32_bf16 v[52:55], v[188:191], v[136:139], v[52:55]
    s_waitcnt lgkmcnt(11)
    ds_read_b64_tr_b16 v[180:181], v217 offset:45056
    ds_read_b64_tr_b16 v[182:183], v217 offset:47104
    v_mfma_f32_16x16x32_bf16 v[60:63], v[188:191], v[140:143], v[60:63]
HK0:
    s_cbranch_vccnz HR0
    v_mul_f32 v16, v16, v197
    v_mul_f32 v17, v17, v197
    v_cvt_pk_bf16_f32 v16, v16, v17
    v_mul_f32 v18, v18, v197
    v_mul_f32 v19, v19, v197
    v_cvt_pk_bf16_f32 v17, v18, v19
    v_mul_f32 v20, v20, v197
    v_mul_f32 v21, v21, v197
    v_cvt_pk_bf16_f32 v18, v20, v21
    v_mul_f32 v22, v22, v197
    v_mul_f32 v23, v23, v197
    v_cvt_pk_bf16_f32 v19, v22, v23
    v_mul_f32 v24, v24, v199
    v_mul_f32 v25, v25, v199
    v_mfma_f32_16x16x32_bf16 v[64:67], v[160:163], v[136:139], v[64:67]
    s_waitcnt lgkmcnt(10)
    ds_read_b64_tr_b16 v[184:185], v218 offset:45056
    ds_read_b64_tr_b16 v[186:187], v218 offset:47104
    v_mfma_f32_16x16x32_bf16 v[72:75], v[160:163], v[140:143], v[72:75]
    ds_read_b64_tr_b16 a[248:249], v214 offset:12288
    v_cvt_pk_bf16_f32 v24, v24, v25
    v_mul_f32 v26, v26, v199
    v_mul_f32 v27, v27, v199
    v_mfma_f32_16x16x32_bf16 v[68:71], v[164:167], v[136:139], v[68:71]
    s_waitcnt lgkmcnt(11)
    ds_read_b64_tr_b16 v[188:189], v219 offset:45056
    ds_read_b64_tr_b16 v[190:191], v219 offset:47104
    v_mfma_f32_16x16x32_bf16 v[76:79], v[164:167], v[140:143], v[76:79]
    s_barrier
    v_cvt_pk_bf16_f32 v25, v26, v27
    v_mul_f32 v28, v28, v199
    v_mul_f32 v29, v29, v199
    v_cvt_pk_bf16_f32 v26, v28, v29
    v_mul_f32 v30, v30, v199
    v_mul_f32 v31, v31, v199
    v_cvt_pk_bf16_f32 v27, v30, v31
    v_mul_f32 v32, v32, v197
    v_mul_f32 v33, v33, v197
    v_cvt_pk_bf16_f32 v32, v32, v33
    v_mul_f32 v34, v34, v197
    v_mul_f32 v35, v35, v197
    v_cvt_pk_bf16_f32 v33, v34, v35
    v_mfma_f32_16x16x32_bf16 v[80:83], v[168:171], v[136:139], v[80:83]
    s_waitcnt lgkmcnt(10)
    v_mul_f32 v36, v36, v197
    v_mul_f32 v37, v37, v197
    v_mfma_f32_16x16x32_bf16 v[88:91], v[168:171], v[140:143], v[88:91]
    ds_read_b64_tr_b16 a[250:251], v214 offset:14336
    s_add_u32 m0, s36, 114688
    s_add_u32 s38, s69, 114688
    v_cvt_pk_bf16_f32 v34, v36, v37
    v_mul_f32 v38, v38, v197
    v_mfma_f32_16x16x32_bf16 v[84:87], v[172:175], v[136:139], v[84:87]
    s_waitcnt lgkmcnt(9)
    v_mul_f32 v39, v39, v197
    v_cvt_pk_bf16_f32 v35, v38, v39
    v_mfma_f32_16x16x32_bf16 v[92:95], v[172:175], v[140:143], v[92:95]
    buffer_load_dwordx4 v208, s[20:23], s38 offen offset:0 lds
    v_mul_f32 v40, v40, v199
    v_mul_f32 v41, v41, v199
    v_cvt_pk_bf16_f32 v40, v40, v41
    v_mul_f32 v42, v42, v199
    v_mul_f32 v43, v43, v199
    v_cvt_pk_bf16_f32 v41, v42, v43
    v_mul_f32 v44, v44, v199
    v_mul_f32 v45, v45, v199
    v_cvt_pk_bf16_f32 v42, v44, v45
    v_mul_f32 v46, v46, v199
    v_mul_f32 v47, v47, v199
    v_cvt_pk_bf16_f32 v43, v46, v47
    v_mfma_f32_16x16x32_bf16 v[96:99], v[176:179], v[136:139], v[96:99]
    s_waitcnt lgkmcnt(6)
    v_mul_f32 v48, v48, v197
    v_mul_f32 v49, v49, v197
    v_mfma_f32_16x16x32_bf16 v[104:107], v[176:179], v[140:143], v[104:107]
    ds_read_b64_tr_b16 a[252:253], v215 offset:12288
    v_cvt_pk_bf16_f32 v48, v48, v49
    v_mul_f32 v50, v50, v197
    v_mul_f32 v51, v51, v197
    v_mfma_f32_16x16x32_bf16 v[100:103], v[180:183], v[136:139], v[100:103]
    s_waitcnt lgkmcnt(5)
    v_cvt_pk_bf16_f32 v49, v50, v51
    v_mul_f32 v52, v52, v197
    v_mfma_f32_16x16x32_bf16 v[108:111], v[180:183], v[140:143], v[108:111]
    buffer_load_dwordx4 v209, s[20:23], s38 offen offset:1024 lds
    v_mul_f32 v53, v53, v197
    v_cvt_pk_bf16_f32 v50, v52, v53
    v_mul_f32 v54, v54, v197
    v_mul_f32 v55, v55, v197
    v_cvt_pk_bf16_f32 v51, v54, v55
    v_mul_f32 v56, v56, v199
    v_mul_f32 v57, v57, v199
    v_cvt_pk_bf16_f32 v56, v56, v57
    v_mul_f32 v58, v58, v199
    v_mul_f32 v59, v59, v199
    v_cvt_pk_bf16_f32 v57, v58, v59
    v_mfma_f32_16x16x32_bf16 v[112:115], v[184:187], v[136:139], v[112:115]
    s_waitcnt lgkmcnt(2)
    v_mul_f32 v60, v60, v199
    v_mul_f32 v61, v61, v199
    v_mfma_f32_16x16x32_bf16 v[120:123], v[184:187], v[140:143], v[120:123]
    ds_read_b64_tr_b16 a[254:255], v215 offset:14336
    v_cvt_pk_bf16_f32 v58, v60, v61
    v_mul_f32 v62, v62, v199
    v_mul_f32 v63, v63, v199
    v_mfma_f32_16x16x32_bf16 v[116:119], v[188:191], v[136:139], v[116:119]
    v_cvt_pk_bf16_f32 v59, v62, v63
    v_mul_f32 v64, v64, v197
    v_mfma_f32_16x16x32_bf16 v[124:127], v[188:191], v[140:143], v[124:127]
    buffer_load_dwordx4 v210, s[20:23], s38 offen offset:2048 lds
    v_mul_f32 v65, v65, v197
    v_mfma_f32_16x16x32_bf16 v[128:131], a[0:3], v[0:3], 0
    s_waitcnt lgkmcnt(0)
    v_cvt_pk_bf16_f32 v64, v64, v65
    v_mul_f32 v66, v66, v197
    v_mfma_f32_16x16x32_bf16 v[136:139], a[0:3], v[8:11], 0
    buffer_load_dwordx4 v211, s[20:23], s38 offen offset:3072 lds
    v_mfma_f32_16x16x32_bf16 v[132:135], a[4:7], v[0:3], 0
    v_mul_f32 v67, v67, v197
    v_cvt_pk_bf16_f32 v65, v66, v67
    v_mfma_f32_16x16x32_bf16 v[140:143], a[4:7], v[8:11], 0
    v_mul_f32 v68, v68, v197
    v_mul_f32 v69, v69, v197
    v_mfma_f32_16x16x32_bf16 v[144:147], a[8:11], v[0:3], 0
    v_cvt_pk_bf16_f32 v66, v68, v69
    v_mul_f32 v70, v70, v197
    v_mfma_f32_16x16x32_bf16 v[152:155], a[8:11], v[8:11], 0
    s_barrier
    v_mul_f32 v71, v71, v197
    v_mfma_f32_16x16x32_bf16 v[148:151], a[12:15], v[0:3], 0
    v_cvt_pk_bf16_f32 v67, v70, v71
    v_mul_f32 v72, v72, v199
    v_mfma_f32_16x16x32_bf16 v[156:159], a[12:15], v[8:11], 0
    s_add_u32 m0, s36, 32768
    v_mul_f32 v73, v73, v199
    v_cvt_pk_bf16_f32 v72, v72, v73
    v_mfma_f32_16x16x32_bf16 v[224:227], a[128:131], v[0:3], 0
    v_mul_f32 v74, v74, v199
    v_mul_f32 v75, v75, v199
    v_mfma_f32_16x16x32_bf16 v[232:235], a[128:131], v[8:11], 0
    buffer_load_dwordx4 v208, s[20:23], s70 offen offset:0 lds
    v_mfma_f32_16x16x32_bf16 v[228:231], a[132:135], v[0:3], 0
    v_cvt_pk_bf16_f32 v73, v74, v75
    v_mul_f32 v76, v76, v199
    v_mfma_f32_16x16x32_bf16 v[236:239], a[132:135], v[8:11], 0
    buffer_load_dwordx4 v209, s[20:23], s70 offen offset:1024 lds
    v_mfma_f32_16x16x32_bf16 v[240:243], a[136:139], v[0:3], 0
    v_mul_f32 v77, v77, v199
    v_cvt_pk_bf16_f32 v74, v76, v77
    v_mfma_f32_16x16x32_bf16 v[248:251], a[136:139], v[8:11], 0
    buffer_load_dwordx4 v210, s[20:23], s70 offen offset:2048 lds
    v_mfma_f32_16x16x32_bf16 v[244:247], a[140:143], v[0:3], 0
    v_mul_f32 v78, v78, v199
    v_mul_f32 v79, v79, v199
    v_mfma_f32_16x16x32_bf16 v[252:255], a[140:143], v[8:11], 0
    buffer_load_dwordx4 v211, s[20:23], s70 offen offset:3072 lds
    v_cvt_pk_bf16_f32 v75, v78, v79
    v_mfma_f32_16x16x32_bf16 v[128:131], a[16:19], v[16:19], v[128:131]
    v_mul_f32 v80, v80, v197
    v_mul_f32 v81, v81, v197
    v_mfma_f32_16x16x32_bf16 v[136:139], a[16:19], v[24:27], v[136:139]
    s_add_u32 m0, s36, 65536
    v_cvt_pk_bf16_f32 v80, v80, v81
    v_mul_f32 v82, v82, v197
    v_mfma_f32_16x16x32_bf16 v[132:135], a[20:23], v[16:19], v[132:135]
    v_mul_f32 v83, v83, v197
    v_cvt_pk_bf16_f32 v81, v82, v83
    v_mfma_f32_16x16x32_bf16 v[140:143], a[20:23], v[24:27], v[140:143]
    s_add_u32 s38, s70, 114688
    v_mul_f32 v84, v84, v197
    v_mul_f32 v85, v85, v197
    v_mfma_f32_16x16x32_bf16 v[144:147], a[24:27], v[16:19], v[144:147]
    v_cvt_pk_bf16_f32 v82, v84, v85
    v_mul_f32 v86, v86, v197
    v_mfma_f32_16x16x32_bf16 v[152:155], a[24:27], v[24:27], v[152:155]
    buffer_load_dwordx4 v208, s[20:23], s38 offen offset:0 lds
    v_mfma_f32_16x16x32_bf16 v[148:151], a[28:31], v[16:19], v[148:151]
    v_mul_f32 v87, v87, v197
    v_cvt_pk_bf16_f32 v83, v86, v87
    v_mfma_f32_16x16x32_bf16 v[156:159], a[28:31], v[24:27], v[156:159]
    buffer_load_dwordx4 v209, s[20:23], s38 offen offset:1024 lds
    v_mfma_f32_16x16x32_bf16 v[128:131], a[32:35], v[32:35], v[128:131]
    v_mul_f32 v88, v88, v199
    v_mul_f32 v89, v89, v199
    v_mfma_f32_16x16x32_bf16 v[136:139], a[32:35], v[40:43], v[136:139]
    buffer_load_dwordx4 v210, s[20:23], s38 offen offset:2048 lds
    v_cvt_pk_bf16_f32 v88, v88, v89
    v_mfma_f32_16x16x32_bf16 v[132:135], a[36:39], v[32:35], v[132:135]
    v_mul_f32 v90, v90, v199
    v_mul_f32 v91, v91, v199
    v_mfma_f32_16x16x32_bf16 v[140:143], a[36:39], v[40:43], v[140:143]
    buffer_load_dwordx4 v211, s[20:23], s38 offen offset:3072 lds
    v_cvt_pk_bf16_f32 v89, v90, v91
    v_mfma_f32_16x16x32_bf16 v[144:147], a[40:43], v[32:35], v[144:147]
    v_mul_f32 v92, v92, v199
    v_mul_f32 v93, v93, v199
    v_mfma_f32_16x16x32_bf16 v[152:155], a[40:43], v[40:43], v[152:155]
    v_cvt_pk_bf16_f32 v90, v92, v93
    v_mul_f32 v94, v94, v199
    v_mfma_f32_16x16x32_bf16 v[148:151], a[44:47], v[32:35], v[148:151]
    v_mul_f32 v95, v95, v199
    v_cvt_pk_bf16_f32 v91, v94, v95
    v_mfma_f32_16x16x32_bf16 v[156:159], a[44:47], v[40:43], v[156:159]
    v_mul_f32 v96, v96, v197
    v_mul_f32 v97, v97, v197
    v_mfma_f32_16x16x32_bf16 v[128:131], a[48:51], v[48:51], v[128:131]
    v_cvt_pk_bf16_f32 v96, v96, v97
    v_mul_f32 v98, v98, v197
    v_mfma_f32_16x16x32_bf16 v[136:139], a[48:51], v[56:59], v[136:139]
    v_mul_f32 v99, v99, v197
    v_cvt_pk_bf16_f32 v97, v98, v99
    v_mfma_f32_16x16x32_bf16 v[132:135], a[52:55], v[48:51], v[132:135]
    v_mul_f32 v100, v100, v197
    v_mul_f32 v101, v101, v197
    v_mfma_f32_16x16x32_bf16 v[140:143], a[52:55], v[56:59], v[140:143]
    v_cvt_pk_bf16_f32 v98, v100, v101
    v_mul_f32 v102, v102, v197
    v_mfma_f32_16x16x32_bf16 v[144:147], a[56:59], v[48:51], v[144:147]
    v_mul_f32 v103, v103, v197
    v_cvt_pk_bf16_f32 v99, v102, v103
    v_mfma_f32_16x16x32_bf16 v[152:155], a[56:59], v[56:59], v[152:155]
    v_mul_f32 v104, v104, v199
    v_mul_f32 v105, v105, v199
    v_mfma_f32_16x16x32_bf16 v[148:151], a[60:63], v[48:51], v[148:151]
    v_cvt_pk_bf16_f32 v104, v104, v105
    v_mul_f32 v106, v106, v199
    v_mfma_f32_16x16x32_bf16 v[156:159], a[60:63], v[56:59], v[156:159]
    v_mul_f32 v107, v107, v199
    v_cvt_pk_bf16_f32 v105, v106, v107
    v_mfma_f32_16x16x32_bf16 v[128:131], a[64:67], v[64:67], v[128:131]
    v_mul_f32 v108, v108, v199
    v_mul_f32 v109, v109, v199
    v_mfma_f32_16x16x32_bf16 v[136:139], a[64:67], v[72:75], v[136:139]
    v_cvt_pk_bf16_f32 v106, v108, v109
    v_mul_f32 v110, v110, v199
    v_mfma_f32_16x16x32_bf16 v[132:135], a[68:71], v[64:67], v[132:135]
    v_mul_f32 v111, v111, v199
    v_cvt_pk_bf16_f32 v107, v110, v111
    v_mfma_f32_16x16x32_bf16 v[140:143], a[68:71], v[72:75], v[140:143]
    v_mul_f32 v112, v112, v197
    v_mul_f32 v113, v113, v197
    v_mfma_f32_16x16x32_bf16 v[144:147], a[72:75], v[64:67], v[144:147]
    v_cvt_pk_bf16_f32 v112, v112, v113
    v_mul_f32 v114, v114, v197
    v_mfma_f32_16x16x32_bf16 v[152:155], a[72:75], v[72:75], v[152:155]
    v_mul_f32 v115, v115, v197
    v_cvt_pk_bf16_f32 v113, v114, v115
    v_mfma_f32_16x16x32_bf16 v[148:151], a[76:79], v[64:67], v[148:151]
    v_mul_f32 v116, v116, v197
    v_mul_f32 v117, v117, v197
    v_mfma_f32_16x16x32_bf16 v[156:159], a[76:79], v[72:75], v[156:159]
    v_cvt_pk_bf16_f32 v114, v116, v117
    v_mul_f32 v118, v118, v197
    v_mfma_f32_16x16x32_bf16 v[128:131], a[80:83], v[80:83], v[128:131]
    v_mul_f32 v119, v119, v197
    v_cvt_pk_bf16_f32 v115, v118, v119
    v_mfma_f32_16x16x32_bf16 v[136:139], a[80:83], v[88:91], v[136:139]
    v_mul_f32 v120, v120, v199
    v_mul_f32 v121, v121, v199
    v_mfma_f32_16x16x32_bf16 v[132:135], a[84:87], v[80:83], v[132:135]
    v_cvt_pk_bf16_f32 v120, v120, v121
    v_mul_f32 v122, v122, v199
    v_mfma_f32_16x16x32_bf16 v[140:143], a[84:87], v[88:91], v[140:143]
    v_mul_f32 v123, v123, v199
    v_cvt_pk_bf16_f32 v121, v122, v123
    v_mfma_f32_16x16x32_bf16 v[144:147], a[88:91], v[80:83], v[144:147]
    v_mul_f32 v124, v124, v199
    v_mul_f32 v125, v125, v199
    v_mfma_f32_16x16x32_bf16 v[152:155], a[88:91], v[88:91], v[152:155]
    v_cvt_pk_bf16_f32 v122, v124, v125
    v_mul_f32 v126, v126, v199
    v_mfma_f32_16x16x32_bf16 v[148:151], a[92:95], v[80:83], v[148:151]
    v_mul_f32 v127, v127, v199
    v_cvt_pk_bf16_f32 v123, v126, v127
    v_mfma_f32_16x16x32_bf16 v[156:159], a[92:95], v[88:91], v[156:159]
    v_mfma_f32_16x16x32_bf16 v[128:131], a[96:99], v[96:99], v[128:131]
    v_mfma_f32_16x16x32_bf16 v[136:139], a[96:99], v[104:107], v[136:139]
    v_mfma_f32_16x16x32_bf16 v[132:135], a[100:103], v[96:99], v[132:135]
    v_mfma_f32_16x16x32_bf16 v[140:143], a[100:103], v[104:107], v[140:143]
    v_mfma_f32_16x16x32_bf16 v[144:147], a[104:107], v[96:99], v[144:147]
    v_mfma_f32_16x16x32_bf16 v[152:155], a[104:107], v[104:107], v[152:155]
    v_mfma_f32_16x16x32_bf16 v[148:151], a[108:111], v[96:99], v[148:151]
    v_mfma_f32_16x16x32_bf16 v[156:159], a[108:111], v[104:107], v[156:159]
    v_mfma_f32_16x16x32_bf16 v[128:131], a[112:115], v[112:115], v[128:131]
    v_mfma_f32_16x16x32_bf16 v[136:139], a[112:115], v[120:123], v[136:139]
    v_mfma_f32_16x16x32_bf16 v[132:135], a[116:119], v[112:115], v[132:135]
    v_mfma_f32_16x16x32_bf16 v[140:143], a[116:119], v[120:123], v[140:143]
    v_mfma_f32_16x16x32_bf16 v[144:147], a[120:123], v[112:115], v[144:147]
    v_mfma_f32_16x16x32_bf16 v[152:155], a[120:123], v[120:123], v[152:155]
    v_mfma_f32_16x16x32_bf16 v[148:151], a[124:127], v[112:115], v[148:151]
    v_mfma_f32_16x16x32_bf16 v[156:159], a[124:127], v[120:123], v[156:159]
    v_mfma_f32_16x16x32_bf16 v[224:227], a[144:147], v[16:19], v[224:227]
    v_cvt_pk_bf16_f32 v4, v128, v129
    v_cvt_pk_bf16_f32 v5, v130, v131
    v_mfma_f32_16x16x32_bf16 v[232:235], a[144:147], v[24:27], v[232:235]
    v_cvt_pk_bf16_f32 v6, v132, v133
    v_cvt_pk_bf16_f32 v7, v134, v135
    v_mfma_f32_16x16x32_bf16 v[228:231], a[148:151], v[16:19], v[228:231]
    v_cvt_pk_bf16_f32 v12, v136, v137
    v_cvt_pk_bf16_f32 v13, v138, v139
    v_mfma_f32_16x16x32_bf16 v[236:239], a[148:151], v[24:27], v[236:239]
    v_cvt_pk_bf16_f32 v14, v140, v141
    v_cvt_pk_bf16_f32 v15, v142, v143
    v_mfma_f32_16x16x32_bf16 v[224:227], a[160:163], v[32:35], v[224:227]
    v_cvt_pk_bf16_f32 v20, v144, v145
    v_cvt_pk_bf16_f32 v21, v146, v147
    v_mfma_f32_16x16x32_bf16 v[232:235], a[160:163], v[40:43], v[232:235]
    v_cvt_pk_bf16_f32 v22, v148, v149
    v_cvt_pk_bf16_f32 v23, v150, v151
    v_mfma_f32_16x16x32_bf16 v[228:231], a[164:167], v[32:35], v[228:231]
    v_cvt_pk_bf16_f32 v28, v152, v153
    v_cvt_pk_bf16_f32 v29, v154, v155
    v_mfma_f32_16x16x32_bf16 v[236:239], a[164:167], v[40:43], v[236:239]
    v_cvt_pk_bf16_f32 v30, v156, v157
    v_cvt_pk_bf16_f32 v31, v158, v159
    v_mfma_f32_16x16x32_bf16 v[224:227], a[176:179], v[48:51], v[224:227]
    v_mfma_f32_16x16x32_bf16 v[232:235], a[176:179], v[56:59], v[232:235]
    s_lshl_b32 s40, s64, 8
    buffer_store_dwordx4 v[4:7], v192, s[28:31], s40 offen offset:0 sc0 sc1
    v_mfma_f32_16x16x32_bf16 v[228:231], a[180:183], v[48:51], v[228:231]
    v_mfma_f32_16x16x32_bf16 v[236:239], a[180:183], v[56:59], v[236:239]
    v_mfma_f32_16x16x32_bf16 v[224:227], a[192:195], v[64:67], v[224:227]
    v_mfma_f32_16x16x32_bf16 v[232:235], a[192:195], v[72:75], v[232:235]
    v_mfma_f32_16x16x32_bf16 v[228:231], a[196:199], v[64:67], v[228:231]
    v_mfma_f32_16x16x32_bf16 v[236:239], a[196:199], v[72:75], v[236:239]
    v_mfma_f32_16x16x32_bf16 v[224:227], a[208:211], v[80:83], v[224:227]
    v_mfma_f32_16x16x32_bf16 v[232:235], a[208:211], v[88:91], v[232:235]
    v_mfma_f32_16x16x32_bf16 v[228:231], a[212:215], v[80:83], v[228:231]
    v_mfma_f32_16x16x32_bf16 v[236:239], a[212:215], v[88:91], v[236:239]
    v_mfma_f32_16x16x32_bf16 v[224:227], a[224:227], v[96:99], v[224:227]
    v_mfma_f32_16x16x32_bf16 v[232:235], a[224:227], v[104:107], v[232:235]
    buffer_store_dwordx4 v[12:15], v192, s[28:31], s40 offen offset:2048 sc0 sc1
    v_mfma_f32_16x16x32_bf16 v[228:231], a[228:231], v[96:99], v[228:231]
    v_mfma_f32_16x16x32_bf16 v[236:239], a[228:231], v[104:107], v[236:239]
    v_mfma_f32_16x16x32_bf16 v[224:227], a[240:243], v[112:115], v[224:227]
    v_mfma_f32_16x16x32_bf16 v[232:235], a[240:243], v[120:123], v[232:235]
    v_mfma_f32_16x16x32_bf16 v[228:231], a[244:247], v[112:115], v[228:231]
    v_mfma_f32_16x16x32_bf16 v[236:239], a[244:247], v[120:123], v[236:239]
    v_mfma_f32_16x16x32_bf16 v[240:243], a[152:155], v[16:19], v[240:243]
    v_mfma_f32_16x16x32_bf16 v[248:251], a[152:155], v[24:27], v[248:251]
    v_mfma_f32_16x16x32_bf16 v[244:247], a[156:159], v[16:19], v[244:247]
    v_mfma_f32_16x16x32_bf16 v[252:255], a[156:159], v[24:27], v[252:255]
    v_mfma_f32_16x16x32_bf16 v[240:243], a[168:171], v[32:35], v[240:243]
    v_cvt_pk_bf16_f32 v36, v224, v225
    v_cvt_pk_bf16_f32 v37, v226, v227
    v_mfma_f32_16x16x32_bf16 v[248:251], a[168:171], v[40:43], v[248:251]
    buffer_store_dwordx4 v[20:23], v192, s[28:31], s40 offen offset:512 sc0 sc1
    v_cvt_pk_bf16_f32 v38, v228, v229
    v_cvt_pk_bf16_f32 v39, v230, v231
    v_mfma_f32_16x16x32_bf16 v[244:247], a[172:175], v[32:35], v[244:247]
    v_cvt_pk_bf16_f32 v44, v232, v233
    v_cvt_pk_bf16_f32 v45, v234, v235
    v_mfma_f32_16x16x32_bf16 v[252:255], a[172:175], v[40:43], v[252:255]
    v_cvt_pk_bf16_f32 v46, v236, v237
    v_cvt_pk_bf16_f32 v47, v238, v239
    v_mfma_f32_16x16x32_bf16 v[240:243], a[184:187], v[48:51], v[240:243]
    v_mfma_f32_16x16x32_bf16 v[248:251], a[184:187], v[56:59], v[248:251]
    v_mfma_f32_16x16x32_bf16 v[244:247], a[188:191], v[48:51], v[244:247]
    v_mfma_f32_16x16x32_bf16 v[252:255], a[188:191], v[56:59], v[252:255]
    v_mfma_f32_16x16x32_bf16 v[240:243], a[200:203], v[64:67], v[240:243]
    v_mfma_f32_16x16x32_bf16 v[248:251], a[200:203], v[72:75], v[248:251]
    s_waitcnt vmcnt(35)
    s_barrier
    v_mfma_f32_16x16x32_bf16 v[244:247], a[204:207], v[64:67], v[244:247]
    v_add_u32 v216, 131072, v216
    ds_read_b64_tr_b16 v[160:161], v216 offset:16384
    ds_read_b64_tr_b16 v[162:163], v216 offset:18432
    v_mfma_f32_16x16x32_bf16 v[252:255], a[204:207], v[72:75], v[252:255]
    v_mfma_f32_16x16x32_bf16 v[240:243], a[216:219], v[80:83], v[240:243]
    v_add_u32 v217, 131072, v217
    ds_read_b64_tr_b16 v[164:165], v217 offset:16384
    ds_read_b64_tr_b16 v[166:167], v217 offset:18432
    v_mfma_f32_16x16x32_bf16 v[248:251], a[216:219], v[88:91], v[248:251]
    buffer_store_dwordx4 v[28:31], v192, s[28:31], s40 offen offset:2560 sc0 sc1
    v_mfma_f32_16x16x32_bf16 v[244:247], a[220:223], v[80:83], v[244:247]
    ds_read_b64_tr_b16 v[168:169], v216 offset:20480
    ds_read_b64_tr_b16 v[170:171], v216 offset:22528
    v_mfma_f32_16x16x32_bf16 v[252:255], a[220:223], v[88:91], v[252:255]
    v_mfma_f32_16x16x32_bf16 v[240:243], a[232:235], v[96:99], v[240:243]
    ds_read_b64_tr_b16 v[172:173], v217 offset:20480
    ds_read_b64_tr_b16 v[174:175], v217 offset:22528
    v_mfma_f32_16x16x32_bf16 v[248:251], a[232:235], v[104:107], v[248:251]
    v_mfma_f32_16x16x32_bf16 v[244:247], a[236:239], v[96:99], v[244:247]
    ds_read_b64_tr_b16 v[176:177], v216 offset:24576
    ds_read_b64_tr_b16 v[178:179], v216 offset:26624
    v_mfma_f32_16x16x32_bf16 v[252:255], a[236:239], v[104:107], v[252:255]
    v_mfma_f32_16x16x32_bf16 v[240:243], a[248:251], v[112:115], v[240:243]
    ds_read_b64_tr_b16 v[180:181], v217 offset:24576
    ds_read_b64_tr_b16 v[182:183], v217 offset:26624
    v_mfma_f32_16x16x32_bf16 v[248:251], a[248:251], v[120:123], v[248:251]
    v_mfma_f32_16x16x32_bf16 v[244:247], a[252:255], v[112:115], v[244:247]
    s_waitcnt lgkmcnt(10)
    v_mfma_f32_16x16x32_bf16 v[252:255], a[252:255], v[120:123], v[252:255]
    v_mfma_f32_16x16x32_bf16 v[128:131], v[160:163], v[0:3], 0
    s_waitcnt lgkmcnt(8)
    ds_read_b64_tr_b16 v[184:185], v216 offset:28672
    ds_read_b64_tr_b16 v[186:187], v216 offset:30720
    v_mfma_f32_16x16x32_bf16 v[136:139], v[160:163], v[8:11], 0
    s_lshl_b32 s40, s65, 8
    buffer_store_dwordx4 v[36:39], v192, s[28:31], s40 offen offset:0 sc0 sc1
    v_add_u32 v216, 4294836224, v216
    v_mfma_f32_16x16x32_bf16 v[132:135], v[164:167], v[0:3], 0
    s_waitcnt lgkmcnt(8)
    ds_read_b64_tr_b16 v[188:189], v217 offset:28672
    ds_read_b64_tr_b16 v[190:191], v217 offset:30720
    v_mfma_f32_16x16x32_bf16 v[140:143], v[164:167], v[8:11], 0
    v_add_u32 v217, 4294836224, v217
    v_mfma_f32_16x16x32_bf16 v[128:131], v[168:171], v[16:19], v[128:131]
    s_waitcnt lgkmcnt(8)
    ds_read_b64_tr_b16 v[160:161], v216 offset:0
    ds_read_b64_tr_b16 v[162:163], v216 offset:2048
    v_mfma_f32_16x16x32_bf16 v[136:139], v[168:171], v[24:27], v[136:139]
    v_cvt_pk_bf16_f32 v52, v240, v241
    v_cvt_pk_bf16_f32 v53, v242, v243
    v_mfma_f32_16x16x32_bf16 v[132:135], v[172:175], v[16:19], v[132:135]
    s_waitcnt lgkmcnt(8)
    ds_read_b64_tr_b16 v[164:165], v217 offset:0
    ds_read_b64_tr_b16 v[166:167], v217 offset:2048
    v_mfma_f32_16x16x32_bf16 v[140:143], v[172:175], v[24:27], v[140:143]
    v_cvt_pk_bf16_f32 v54, v244, v245
    v_cvt_pk_bf16_f32 v55, v246, v247
    v_mfma_f32_16x16x32_bf16 v[128:131], v[176:179], v[32:35], v[128:131]
    s_waitcnt lgkmcnt(8)
    ds_read_b64_tr_b16 v[168:169], v216 offset:4096
    ds_read_b64_tr_b16 v[170:171], v216 offset:6144
    v_mfma_f32_16x16x32_bf16 v[136:139], v[176:179], v[40:43], v[136:139]
    v_cvt_pk_bf16_f32 v60, v248, v249
    v_cvt_pk_bf16_f32 v61, v250, v251
    v_mfma_f32_16x16x32_bf16 v[132:135], v[180:183], v[32:35], v[132:135]
    s_waitcnt lgkmcnt(8)
    ds_read_b64_tr_b16 v[172:173], v217 offset:4096
    ds_read_b64_tr_b16 v[174:175], v217 offset:6144
    v_mfma_f32_16x16x32_bf16 v[140:143], v[180:183], v[40:43], v[140:143]
    v_cvt_pk_bf16_f32 v62, v252, v253
    v_cvt_pk_bf16_f32 v63, v254, v255
    v_mfma_f32_16x16x32_bf16 v[128:131], v[184:187], v[48:51], v[128:131]
    s_waitcnt lgkmcnt(8)
    ds_read_b64_tr_b16 v[176:177], v216 offset:8192
    ds_read_b64_tr_b16 v[178:179], v216 offset:10240
    v_mfma_f32_16x16x32_bf16 v[136:139], v[184:187], v[56:59], v[136:139]
    buffer_store_dwordx4 v[44:47], v192, s[28:31], s40 offen offset:2048 sc0 sc1
    v_mfma_f32_16x16x32_bf16 v[132:135], v[188:191], v[48:51], v[132:135]
    s_waitcnt lgkmcnt(8)
    ds_read_b64_tr_b16 v[180:181], v217 offset:8192
    ds_read_b64_tr_b16 v[182:183], v217 offset:10240
    v_mfma_f32_16x16x32_bf16 v[140:143], v[188:191], v[56:59], v[140:143]
    v_mfma_f32_16x16x32_bf16 v[128:131], v[160:163], v[64:67], v[128:131]
    s_waitcnt lgkmcnt(8)
    ds_read_b64_tr_b16 v[184:185], v216 offset:12288
    ds_read_b64_tr_b16 v[186:187], v216 offset:14336
    v_mfma_f32_16x16x32_bf16 v[136:139], v[160:163], v[72:75], v[136:139]
    v_mfma_f32_16x16x32_bf16 v[132:135], v[164:167], v[64:67], v[132:135]
    s_waitcnt lgkmcnt(8)
    ds_read_b64_tr_b16 v[188:189], v217 offset:12288
    ds_read_b64_tr_b16 v[190:191], v217 offset:14336
    v_mfma_f32_16x16x32_bf16 v[140:143], v[164:167], v[72:75], v[140:143]
    v_mfma_f32_16x16x32_bf16 v[128:131], v[168:171], v[80:83], v[128:131]
    s_waitcnt lgkmcnt(8)
    v_add_u32 v218, 131072, v218
    ds_read_b64_tr_b16 v[160:161], v218 offset:16384
    ds_read_b64_tr_b16 v[162:163], v218 offset:18432
    v_mfma_f32_16x16x32_bf16 v[136:139], v[168:171], v[88:91], v[136:139]
    v_mfma_f32_16x16x32_bf16 v[132:135], v[172:175], v[80:83], v[132:135]
    s_waitcnt lgkmcnt(8)
    v_add_u32 v219, 131072, v219
    ds_read_b64_tr_b16 v[164:165], v219 offset:16384
    ds_read_b64_tr_b16 v[166:167], v219 offset:18432
    v_mfma_f32_16x16x32_bf16 v[140:143], v[172:175], v[88:91], v[140:143]
    v_mfma_f32_16x16x32_bf16 v[128:131], v[176:179], v[96:99], v[128:131]
    s_waitcnt lgkmcnt(8)
    ds_read_b64_tr_b16 v[168:169], v218 offset:20480
    ds_read_b64_tr_b16 v[170:171], v218 offset:22528
    v_mfma_f32_16x16x32_bf16 v[136:139], v[176:179], v[104:107], v[136:139]
    buffer_store_dwordx4 v[52:55], v192, s[28:31], s40 offen offset:512 sc0 sc1
    v_mfma_f32_16x16x32_bf16 v[132:135], v[180:183], v[96:99], v[132:135]
    s_waitcnt lgkmcnt(8)
    ds_read_b64_tr_b16 v[172:173], v219 offset:20480
    ds_read_b64_tr_b16 v[174:175], v219 offset:22528
    v_mfma_f32_16x16x32_bf16 v[140:143], v[180:183], v[104:107], v[140:143]
    v_mfma_f32_16x16x32_bf16 v[128:131], v[184:187], v[112:115], v[128:131]
    s_waitcnt lgkmcnt(8)
    ds_read_b64_tr_b16 v[176:177], v218 offset:24576
    ds_read_b64_tr_b16 v[178:179], v218 offset:26624
    v_mfma_f32_16x16x32_bf16 v[136:139], v[184:187], v[120:123], v[136:139]
    v_mfma_f32_16x16x32_bf16 v[132:135], v[188:191], v[112:115], v[132:135]
    s_waitcnt lgkmcnt(8)
    ds_read_b64_tr_b16 v[180:181], v219 offset:24576
    ds_read_b64_tr_b16 v[182:183], v219 offset:26624
    v_mfma_f32_16x16x32_bf16 v[140:143], v[188:191], v[120:123], v[140:143]
    v_mfma_f32_16x16x32_bf16 v[144:147], v[160:163], v[0:3], 0
    s_waitcnt lgkmcnt(8)
    ds_read_b64_tr_b16 v[184:185], v218 offset:28672
    ds_read_b64_tr_b16 v[186:187], v218 offset:30720
    v_mfma_f32_16x16x32_bf16 v[152:155], v[160:163], v[8:11], 0
    v_add_u32 v218, 4294836224, v218
    v_mfma_f32_16x16x32_bf16 v[148:151], v[164:167], v[0:3], 0
    s_waitcnt lgkmcnt(8)
    ds_read_b64_tr_b16 v[188:189], v219 offset:28672
    ds_read_b64_tr_b16 v[190:191], v219 offset:30720
    v_mfma_f32_16x16x32_bf16 v[156:159], v[164:167], v[8:11], 0
    v_add_u32 v219, 4294836224, v219
    v_mfma_f32_16x16x32_bf16 v[144:147], v[168:171], v[16:19], v[144:147]
    s_waitcnt lgkmcnt(8)
    ds_read_b64_tr_b16 v[160:161], v218 offset:0
    ds_read_b64_tr_b16 v[162:163], v218 offset:2048
    v_mfma_f32_16x16x32_bf16 v[152:155], v[168:171], v[24:27], v[152:155]
    buffer_store_dwordx4 v[60:63], v192, s[28:31], s40 offen offset:2560 sc0 sc1
    v_cvt_pk_bf16_f32 v68, v128, v129
    v_cvt_pk_bf16_f32 v69, v130, v131
    v_mfma_f32_16x16x32_bf16 v[148:151], v[172:175], v[16:19], v[148:151]
    s_waitcnt lgkmcnt(8)
    ds_read_b64_tr_b16 v[164:165], v219 offset:0
    ds_read_b64_tr_b16 v[166:167], v219 offset:2048
    v_mfma_f32_16x16x32_bf16 v[156:159], v[172:175], v[24:27], v[156:159]
    v_cvt_pk_bf16_f32 v70, v132, v133
    v_cvt_pk_bf16_f32 v71, v134, v135
    v_mfma_f32_16x16x32_bf16 v[144:147], v[176:179], v[32:35], v[144:147]
    s_waitcnt lgkmcnt(8)
    ds_read_b64_tr_b16 v[168:169], v218 offset:4096
    ds_read_b64_tr_b16 v[170:171], v218 offset:6144
    v_mfma_f32_16x16x32_bf16 v[152:155], v[176:179], v[40:43], v[152:155]
    v_cvt_pk_bf16_f32 v76, v136, v137
    v_cvt_pk_bf16_f32 v77, v138, v139
    v_mfma_f32_16x16x32_bf16 v[148:151], v[180:183], v[32:35], v[148:151]
    s_waitcnt lgkmcnt(8)
    ds_read_b64_tr_b16 v[172:173], v219 offset:4096
    ds_read_b64_tr_b16 v[174:175], v219 offset:6144
    v_mfma_f32_16x16x32_bf16 v[156:159], v[180:183], v[40:43], v[156:159]
    v_cvt_pk_bf16_f32 v78, v140, v141
    v_cvt_pk_bf16_f32 v79, v142, v143
    v_mfma_f32_16x16x32_bf16 v[144:147], v[184:187], v[48:51], v[144:147]
    s_waitcnt lgkmcnt(8)
    ds_read_b64_tr_b16 v[176:177], v218 offset:8192
    ds_read_b64_tr_b16 v[178:179], v218 offset:10240
    v_mfma_f32_16x16x32_bf16 v[152:155], v[184:187], v[56:59], v[152:155]
    v_mfma_f32_16x16x32_bf16 v[148:151], v[188:191], v[48:51], v[148:151]
    s_waitcnt lgkmcnt(8)
    ds_read_b64_tr_b16 v[180:181], v219 offset:8192
    ds_read_b64_tr_b16 v[182:183], v219 offset:10240
    v_mfma_f32_16x16x32_bf16 v[156:159], v[188:191], v[56:59], v[156:159]
    v_mfma_f32_16x16x32_bf16 v[144:147], v[160:163], v[64:67], v[144:147]
    s_waitcnt lgkmcnt(8)
    ds_read_b64_tr_b16 v[184:185], v218 offset:12288
    ds_read_b64_tr_b16 v[186:187], v218 offset:14336
    v_mfma_f32_16x16x32_bf16 v[152:155], v[160:163], v[72:75], v[152:155]
    s_lshl_b32 s40, s66, 8
    buffer_store_dwordx4 v[68:71], v192, s[28:31], s40 offen offset:0 sc0 sc1
    v_mfma_f32_16x16x32_bf16 v[148:151], v[164:167], v[64:67], v[148:151]
    s_waitcnt lgkmcnt(8)
    ds_read_b64_tr_b16 v[188:189], v219 offset:12288
    ds_read_b64_tr_b16 v[190:191], v219 offset:14336
    v_mfma_f32_16x16x32_bf16 v[156:159], v[164:167], v[72:75], v[156:159]
    s_waitcnt vmcnt(33)
    s_barrier
    v_mfma_f32_16x16x32_bf16 v[144:147], v[168:171], v[80:83], v[144:147]
    s_waitcnt lgkmcnt(8)
    ds_read_b64_tr_b16 v[160:161], v216 offset:16384
    ds_read_b64_tr_b16 v[162:163], v216 offset:18432
    v_mfma_f32_16x16x32_bf16 v[152:155], v[168:171], v[88:91], v[152:155]
    v_mfma_f32_16x16x32_bf16 v[148:151], v[172:175], v[80:83], v[148:151]
    s_waitcnt lgkmcnt(8)
    ds_read_b64_tr_b16 v[164:165], v217 offset:16384
    ds_read_b64_tr_b16 v[166:167], v217 offset:18432
    v_mfma_f32_16x16x32_bf16 v[156:159], v[172:175], v[88:91], v[156:159]
    v_mfma_f32_16x16x32_bf16 v[144:147], v[176:179], v[96:99], v[144:147]
    s_waitcnt lgkmcnt(8)
    ds_read_b64_tr_b16 v[168:169], v216 offset:20480
    ds_read_b64_tr_b16 v[170:171], v216 offset:22528
    v_mfma_f32_16x16x32_bf16 v[152:155], v[176:179], v[104:107], v[152:155]
    v_mfma_f32_16x16x32_bf16 v[148:151], v[180:183], v[96:99], v[148:151]
    s_waitcnt lgkmcnt(8)
    ds_read_b64_tr_b16 v[172:173], v217 offset:20480
    ds_read_b64_tr_b16 v[174:175], v217 offset:22528
    v_mfma_f32_16x16x32_bf16 v[156:159], v[180:183], v[104:107], v[156:159]
    v_mfma_f32_16x16x32_bf16 v[144:147], v[184:187], v[112:115], v[144:147]
    s_waitcnt lgkmcnt(8)
    ds_read_b64_tr_b16 v[176:177], v216 offset:24576
    ds_read_b64_tr_b16 v[178:179], v216 offset:26624
    v_mfma_f32_16x16x32_bf16 v[152:155], v[184:187], v[120:123], v[152:155]
    buffer_store_dwordx4 v[76:79], v192, s[28:31], s40 offen offset:2048 sc0 sc1
    v_mfma_f32_16x16x32_bf16 v[148:151], v[188:191], v[112:115], v[148:151]
    s_waitcnt lgkmcnt(8)
    ds_read_b64_tr_b16 v[180:181], v217 offset:24576
    ds_read_b64_tr_b16 v[182:183], v217 offset:26624
    v_mfma_f32_16x16x32_bf16 v[156:159], v[188:191], v[120:123], v[156:159]
    v_mfma_f32_16x16x32_bf16 v[224:227], v[160:163], v[0:3], 0
    s_waitcnt lgkmcnt(8)
    ds_read_b64_tr_b16 v[184:185], v216 offset:28672
    ds_read_b64_tr_b16 v[186:187], v216 offset:30720
    v_mfma_f32_16x16x32_bf16 v[232:235], v[160:163], v[8:11], 0
HK1:
    s_cbranch_vccnz HR1
    v_mfma_f32_16x16x32_bf16 v[228:231], v[164:167], v[0:3], 0
    s_waitcnt lgkmcnt(8)
    ds_read_b64_tr_b16 v[188:189], v217 offset:28672
    ds_read_b64_tr_b16 v[190:191], v217 offset:30720
    v_mfma_f32_16x16x32_bf16 v[236:239], v[164:167], v[8:11], 0
    v_mfma_f32_16x16x32_bf16 v[224:227], v[168:171], v[16:19], v[224:227]
    s_waitcnt lgkmcnt(8)
    ds_read_b64_tr_b16 v[160:161], v216 offset:49152
    ds_read_b64_tr_b16 v[162:163], v216 offset:51200
    v_mfma_f32_16x16x32_bf16 v[232:235], v[168:171], v[24:27], v[232:235]
    v_cvt_pk_bf16_f32 v84, v144, v145
    v_cvt_pk_bf16_f32 v85, v146, v147
    v_mfma_f32_16x16x32_bf16 v[228:231], v[172:175], v[16:19], v[228:231]
    s_waitcnt lgkmcnt(8)
    ds_read_b64_tr_b16 v[164:165], v217 offset:49152
    ds_read_b64_tr_b16 v[166:167], v217 offset:51200
    v_mfma_f32_16x16x32_bf16 v[236:239], v[172:175], v[24:27], v[236:239]
    v_cvt_pk_bf16_f32 v86, v148, v149
    v_cvt_pk_bf16_f32 v87, v150, v151
    v_mfma_f32_16x16x32_bf16 v[224:227], v[176:179], v[32:35], v[224:227]
    s_waitcnt lgkmcnt(8)
    ds_read_b64_tr_b16 v[168:169], v216 offset:53248
    ds_read_b64_tr_b16 v[170:171], v216 offset:55296
    v_mfma_f32_16x16x32_bf16 v[232:235], v[176:179], v[40:43], v[232:235]
    buffer_store_dwordx4 v[84:87], v192, s[28:31], s40 offen offset:512 sc0 sc1
    v_cvt_pk_bf16_f32 v92, v152, v153
    v_cvt_pk_bf16_f32 v93, v154, v155
    v_mfma_f32_16x16x32_bf16 v[228:231], v[180:183], v[32:35], v[228:231]
    s_waitcnt lgkmcnt(8)
    ds_read_b64_tr_b16 v[172:173], v217 offset:53248
    ds_read_b64_tr_b16 v[174:175], v217 offset:55296
    v_mfma_f32_16x16x32_bf16 v[236:239], v[180:183], v[40:43], v[236:239]
    v_cvt_pk_bf16_f32 v94, v156, v157
    v_cvt_pk_bf16_f32 v95, v158, v159
    v_mfma_f32_16x16x32_bf16 v[224:227], v[184:187], v[48:51], v[224:227]
    s_waitcnt lgkmcnt(8)
    ds_read_b64_tr_b16 v[176:177], v216 offset:57344
    ds_read_b64_tr_b16 v[178:179], v216 offset:59392
    v_mfma_f32_16x16x32_bf16 v[232:235], v[184:187], v[56:59], v[232:235]
    v_mfma_f32_16x16x32_bf16 v[228:231], v[188:191], v[48:51], v[228:231]
    s_waitcnt lgkmcnt(8)
    ds_read_b64_tr_b16 v[180:181], v217 offset:57344
    ds_read_b64_tr_b16 v[182:183], v217 offset:59392
    v_mfma_f32_16x16x32_bf16 v[236:239], v[188:191], v[56:59], v[236:239]
    v_mfma_f32_16x16x32_bf16 v[224:227], v[160:163], v[64:67], v[224:227]
    s_waitcnt lgkmcnt(8)
    ds_read_b64_tr_b16 v[184:185], v216 offset:61440
    ds_read_b64_tr_b16 v[186:187], v216 offset:63488
    v_mfma_f32_16x16x32_bf16 v[232:235], v[160:163], v[72:75], v[232:235]
    v_add_u32 v216, 131072, v216
    v_mfma_f32_16x16x32_bf16 v[228:231], v[164:167], v[64:67], v[228:231]
    s_waitcnt lgkmcnt(8)
    ds_read_b64_tr_b16 v[188:189], v217 offset:61440
    ds_read_b64_tr_b16 v[190:191], v217 offset:63488
    v_mfma_f32_16x16x32_bf16 v[236:239], v[164:167], v[72:75], v[236:239]
    v_add_u32 v217, 131072, v217
    v_mfma_f32_16x16x32_bf16 v[224:227], v[168:171], v[80:83], v[224:227]
    s_waitcnt lgkmcnt(8)
    ds_read_b64_tr_b16 v[160:161], v218 offset:16384
    ds_read_b64_tr_b16 v[162:163], v218 offset:18432
    v_mfma_f32_16x16x32_bf16 v[232:235], v[168:171], v[88:91], v[232:235]
    buffer_store_dwordx4 v[92:95], v192, s[28:31], s40 offen offset:2560 sc0 sc1
    v_mfma_f32_16x16x32_bf16 v[228:231], v[172:175], v[80:83], v[228:231]
    s_waitcnt lgkmcnt(8)
    ds_read_b64_tr_b16 v[164:165], v219 offset:16384
    ds_read_b64_tr_b16 v[166:167], v219 offset:18432
    v_mfma_f32_16x16x32_bf16 v[236:239], v[172:175], v[88:91], v[236:239]
    v_mfma_f32_16x16x32_bf16 v[224:227], v[176:179], v[96:99], v[224:227]
    s_waitcnt lgkmcnt(8)
    ds_read_b64_tr_b16 v[168:169], v218 offset:20480
    ds_read_b64_tr_b16 v[170:171], v218 offset:22528
    v_mfma_f32_16x16x32_bf16 v[232:235], v[176:179], v[104:107], v[232:235]
    v_mfma_f32_16x16x32_bf16 v[228:231], v[180:183], v[96:99], v[228:231]
    s_waitcnt lgkmcnt(8)
    ds_read_b64_tr_b16 v[172:173], v219 offset:20480
    ds_read_b64_tr_b16 v[174:175], v219 offset:22528
    v_mfma_f32_16x16x32_bf16 v[236:239], v[180:183], v[104:107], v[236:239]
    v_mfma_f32_16x16x32_bf16 v[224:227], v[184:187], v[112:115], v[224:227]
    s_waitcnt lgkmcnt(8)
    ds_read_b64_tr_b16 v[176:177], v218 offset:24576
    ds_read_b64_tr_b16 v[178:179], v218 offset:26624
    v_mfma_f32_16x16x32_bf16 v[232:235], v[184:187], v[120:123], v[232:235]
    v_mfma_f32_16x16x32_bf16 v[228:231], v[188:191], v[112:115], v[228:231]
    s_waitcnt lgkmcnt(8)
    ds_read_b64_tr_b16 v[180:181], v219 offset:24576
    ds_read_b64_tr_b16 v[182:183], v219 offset:26624
    v_mfma_f32_16x16x32_bf16 v[236:239], v[188:191], v[120:123], v[236:239]
    v_mfma_f32_16x16x32_bf16 v[240:243], v[160:163], v[0:3], 0
    s_waitcnt lgkmcnt(8)
    ds_read_b64_tr_b16 v[184:185], v218 offset:28672
    ds_read_b64_tr_b16 v[186:187], v218 offset:30720
    v_mfma_f32_16x16x32_bf16 v[248:251], v[160:163], v[8:11], 0
    v_mfma_f32_16x16x32_bf16 v[244:247], v[164:167], v[0:3], 0
    s_waitcnt lgkmcnt(8)
    ds_read_b64_tr_b16 v[188:189], v219 offset:28672
    ds_read_b64_tr_b16 v[190:191], v219 offset:30720
    v_mfma_f32_16x16x32_bf16 v[252:255], v[164:167], v[8:11], 0
    v_mfma_f32_16x16x32_bf16 v[240:243], v[168:171], v[16:19], v[240:243]
    s_waitcnt lgkmcnt(8)
    ds_read_b64_tr_b16 v[160:161], v218 offset:49152
    ds_read_b64_tr_b16 v[162:163], v218 offset:51200
    v_mfma_f32_16x16x32_bf16 v[248:251], v[168:171], v[24:27], v[248:251]
    v_cvt_pk_bf16_f32 v100, v224, v225
    v_cvt_pk_bf16_f32 v101, v226, v227
    v_mfma_f32_16x16x32_bf16 v[244:247], v[172:175], v[16:19], v[244:247]
    s_waitcnt lgkmcnt(8)
    ds_read_b64_tr_b16 v[164:165], v219 offset:49152
    ds_read_b64_tr_b16 v[166:167], v219 offset:51200
    v_mfma_f32_16x16x32_bf16 v[252:255], v[172:175], v[24:27], v[252:255]
    v_cvt_pk_bf16_f32 v102, v228, v229
    v_cvt_pk_bf16_f32 v103, v230, v231
    v_mfma_f32_16x16x32_bf16 v[240:243], v[176:179], v[32:35], v[240:243]
    s_waitcnt lgkmcnt(8)
    ds_read_b64_tr_b16 v[168:169], v218 offset:53248
    ds_read_b64_tr_b16 v[170:171], v218 offset:55296
    v_mfma_f32_16x16x32_bf16 v[248:251], v[176:179], v[40:43], v[248:251]
    s_lshl_b32 s40, s67, 8
    buffer_store_dwordx4 v[100:103], v192, s[28:31], s40 offen offset:0 sc0 sc1
    v_cvt_pk_bf16_f32 v108, v232, v233
    v_cvt_pk_bf16_f32 v109, v234, v235
    v_mfma_f32_16x16x32_bf16 v[244:247], v[180:183], v[32:35], v[244:247]
    s_waitcnt lgkmcnt(8)
    ds_read_b64_tr_b16 v[172:173], v219 offset:53248
    ds_read_b64_tr_b16 v[174:175], v219 offset:55296
    v_mfma_f32_16x16x32_bf16 v[252:255], v[180:183], v[40:43], v[252:255]
    v_cvt_pk_bf16_f32 v110, v236, v237
    v_cvt_pk_bf16_f32 v111, v238, v239
    v_mfma_f32_16x16x32_bf16 v[240:243], v[184:187], v[48:51], v[240:243]
    s_waitcnt lgkmcnt(8)
    ds_read_b64_tr_b16 v[176:177], v218 offset:57344
    ds_read_b64_tr_b16 v[178:179], v218 offset:59392
    v_mfma_f32_16x16x32_bf16 v[248:251], v[184:187], v[56:59], v[248:251]
    v_mfma_f32_16x16x32_bf16 v[244:247], v[188:191], v[48:51], v[244:247]
    s_waitcnt lgkmcnt(8)
    ds_read_b64_tr_b16 v[180:181], v219 offset:57344
    ds_read_b64_tr_b16 v[182:183], v219 offset:59392
    v_mfma_f32_16x16x32_bf16 v[252:255], v[188:191], v[56:59], v[252:255]
    v_mfma_f32_16x16x32_bf16 v[240:243], v[160:163], v[64:67], v[240:243]
    s_waitcnt lgkmcnt(8)
    ds_read_b64_tr_b16 v[184:185], v218 offset:61440
    ds_read_b64_tr_b16 v[186:187], v218 offset:63488
    v_mfma_f32_16x16x32_bf16 v[248:251], v[160:163], v[72:75], v[248:251]
    v_add_u32 v218, 131072, v218
    v_mfma_f32_16x16x32_bf16 v[244:247], v[164:167], v[64:67], v[244:247]
    s_waitcnt lgkmcnt(8)
    ds_read_b64_tr_b16 v[188:189], v219 offset:61440
    ds_read_b64_tr_b16 v[190:191], v219 offset:63488
    v_mfma_f32_16x16x32_bf16 v[252:255], v[164:167], v[72:75], v[252:255]
    s_waitcnt vmcnt(29)
    s_barrier
    v_add_u32 v219, 131072, v219
    v_mfma_f32_16x16x32_bf16 v[240:243], v[168:171], v[80:83], v[240:243]
    s_waitcnt lgkmcnt(8)
    ds_read_b64_tr_b16 v[160:161], v216 offset:0
    ds_read_b64_tr_b16 v[162:163], v216 offset:2048
    v_mfma_f32_16x16x32_bf16 v[248:251], v[168:171], v[88:91], v[248:251]
    buffer_store_dwordx4 v[108:111], v192, s[28:31], s40 offen offset:2048 sc0 sc1
    v_mfma_f32_16x16x32_bf16 v[244:247], v[172:175], v[80:83], v[244:247]
    s_waitcnt lgkmcnt(8)
    ds_read_b64_tr_b16 v[164:165], v217 offset:0
    ds_read_b64_tr_b16 v[166:167], v217 offset:2048
    v_mfma_f32_16x16x32_bf16 v[252:255], v[172:175], v[88:91], v[252:255]
    v_mfma_f32_16x16x32_bf16 v[240:243], v[176:179], v[96:99], v[240:243]
    s_waitcnt lgkmcnt(8)
    ds_read_b64_tr_b16 v[168:169], v216 offset:4096
    ds_read_b64_tr_b16 v[170:171], v216 offset:6144
    v_mfma_f32_16x16x32_bf16 v[248:251], v[176:179], v[104:107], v[248:251]
    v_mfma_f32_16x16x32_bf16 v[244:247], v[180:183], v[96:99], v[244:247]
    s_waitcnt lgkmcnt(8)
    ds_read_b64_tr_b16 v[172:173], v217 offset:4096
    ds_read_b64_tr_b16 v[174:175], v217 offset:6144
    v_mfma_f32_16x16x32_bf16 v[252:255], v[180:183], v[104:107], v[252:255]
    v_mfma_f32_16x16x32_bf16 v[240:243], v[184:187], v[112:115], v[240:243]
    s_waitcnt lgkmcnt(8)
    ds_read_b64_tr_b16 v[176:177], v216 offset:8192
    ds_read_b64_tr_b16 v[178:179], v216 offset:10240
    v_mfma_f32_16x16x32_bf16 v[248:251], v[184:187], v[120:123], v[248:251]
    v_mfma_f32_16x16x32_bf16 v[244:247], v[188:191], v[112:115], v[244:247]
    s_waitcnt lgkmcnt(8)
    ds_read_b64_tr_b16 v[180:181], v217 offset:8192
    ds_read_b64_tr_b16 v[182:183], v217 offset:10240
    v_mfma_f32_16x16x32_bf16 v[252:255], v[188:191], v[120:123], v[252:255]
    v_mfma_f32_16x16x32_bf16 v[128:131], v[160:163], v[0:3], 0
    s_waitcnt lgkmcnt(8)
    ds_read_b64_tr_b16 v[184:185], v216 offset:12288
    ds_read_b64_tr_b16 v[186:187], v216 offset:14336
    v_mfma_f32_16x16x32_bf16 v[136:139], v[160:163], v[8:11], 0
    v_add_u32 v216, 4294901760, v216
    v_mfma_f32_16x16x32_bf16 v[132:135], v[164:167], v[0:3], 0
    s_waitcnt lgkmcnt(8)
    ds_read_b64_tr_b16 v[188:189], v217 offset:12288
    ds_read_b64_tr_b16 v[190:191], v217 offset:14336
    v_mfma_f32_16x16x32_bf16 v[140:143], v[164:167], v[8:11], 0
    v_add_u32 v217, 4294901760, v217
    v_mfma_f32_16x16x32_bf16 v[128:131], v[168:171], v[16:19], v[128:131]
    s_waitcnt lgkmcnt(8)
    ds_read_b64_tr_b16 v[160:161], v216 offset:16384
    ds_read_b64_tr_b16 v[162:163], v216 offset:18432
    v_mfma_f32_16x16x32_bf16 v[136:139], v[168:171], v[24:27], v[136:139]
    v_cvt_pk_bf16_f32 v116, v240, v241
    v_cvt_pk_bf16_f32 v117, v242, v243
    v_mfma_f32_16x16x32_bf16 v[132:135], v[172:175], v[16:19], v[132:135]
    s_waitcnt lgkmcnt(8)
    ds_read_b64_tr_b16 v[164:165], v217 offset:16384
    ds_read_b64_tr_b16 v[166:167], v217 offset:18432
    v_mfma_f32_16x16x32_bf16 v[140:143], v[172:175], v[24:27], v[140:143]
    v_cvt_pk_bf16_f32 v118, v244, v245
    v_cvt_pk_bf16_f32 v119, v246, v247
    v_mfma_f32_16x16x32_bf16 v[128:131], v[176:179], v[32:35], v[128:131]
    s_waitcnt lgkmcnt(8)
    ds_read_b64_tr_b16 v[168:169], v216 offset:20480
    ds_read_b64_tr_b16 v[170:171], v216 offset:22528
    v_mfma_f32_16x16x32_bf16 v[136:139], v[176:179], v[40:43], v[136:139]
    buffer_store_dwordx4 v[116:119], v192, s[28:31], s40 offen offset:512 sc0 sc1
    v_cvt_pk_bf16_f32 v124, v248, v249
    v_cvt_pk_bf16_f32 v125, v250, v251
    v_mfma_f32_16x16x32_bf16 v[132:135], v[180:183], v[32:35], v[132:135]
    s_waitcnt lgkmcnt(8)
    ds_read_b64_tr_b16 v[172:173], v217 offset:20480
    ds_read_b64_tr_b16 v[174:175], v217 offset:22528
    v_mfma_f32_16x16x32_bf16 v[140:143], v[180:183], v[40:43], v[140:143]
    v_cvt_pk_bf16_f32 v126, v252, v253
    v_cvt_pk_bf16_f32 v127, v254, v255
    v_mfma_f32_16x16x32_bf16 v[128:131], v[184:187], v[48:51], v[128:131]
    s_waitcnt lgkmcnt(8)
    ds_read_b64_tr_b16 v[176:177], v216 offset:24576
    ds_read_b64_tr_b16 v[178:179], v216 offset:26624
    v_mfma_f32_16x16x32_bf16 v[136:139], v[184:187], v[56:59], v[136:139]
    v_mfma_f32_16x16x32_bf16 v[132:135], v[188:191], v[48:51], v[132:135]
    s_waitcnt lgkmcnt(8)
    ds_read_b64_tr_b16 v[180:181], v217 offset:24576
    ds_read_b64_tr_b16 v[182:183], v217 offset:26624
    v_mfma_f32_16x16x32_bf16 v[140:143], v[188:191], v[56:59], v[140:143]
    v_mfma_f32_16x16x32_bf16 v[128:131], v[160:163], v[64:67], v[128:131]
    s_waitcnt lgkmcnt(8)
    ds_read_b64_tr_b16 v[184:185], v216 offset:28672
    ds_read_b64_tr_b16 v[186:187], v216 offset:30720
    v_mfma_f32_16x16x32_bf16 v[136:139], v[160:163], v[72:75], v[136:139]
    v_mfma_f32_16x16x32_bf16 v[132:135], v[164:167], v[64:67], v[132:135]
    s_waitcnt lgkmcnt(8)
    ds_read_b64_tr_b16 v[188:189], v217 offset:28672
    ds_read_b64_tr_b16 v[190:191], v217 offset:30720
    v_mfma_f32_16x16x32_bf16 v[140:143], v[164:167], v[72:75], v[140:143]
    v_mfma_f32_16x16x32_bf16 v[128:131], v[168:171], v[80:83], v[128:131]
    s_waitcnt lgkmcnt(8)
    ds_read_b64_tr_b16 v[160:161], v218 offset:0
    ds_read_b64_tr_b16 v[162:163], v218 offset:2048
    v_mfma_f32_16x16x32_bf16 v[136:139], v[168:171], v[88:91], v[136:139]
    buffer_store_dwordx4 v[124:127], v192, s[28:31], s40 offen offset:2560 sc0 sc1
    v_mfma_f32_16x16x32_bf16 v[132:135], v[172:175], v[80:83], v[132:135]
    s_waitcnt lgkmcnt(8)
    ds_read_b64_tr_b16 v[164:165], v219 offset:0
    ds_read_b64_tr_b16 v[166:167], v219 offset:2048
    v_mfma_f32_16x16x32_bf16 v[140:143], v[172:175], v[88:91], v[140:143]
    v_mfma_f32_16x16x32_bf16 v[128:131], v[176:179], v[96:99], v[128:131]
    s_waitcnt lgkmcnt(8)
    ds_read_b64_tr_b16 v[168:169], v218 offset:4096
    ds_read_b64_tr_b16 v[170:171], v218 offset:6144
    v_mfma_f32_16x16x32_bf16 v[136:139], v[176:179], v[104:107], v[136:139]
    v_mfma_f32_16x16x32_bf16 v[132:135], v[180:183], v[96:99], v[132:135]
    s_waitcnt lgkmcnt(8)
    ds_read_b64_tr_b16 v[172:173], v219 offset:4096
    ds_read_b64_tr_b16 v[174:175], v219 offset:6144
    v_mfma_f32_16x16x32_bf16 v[140:143], v[180:183], v[104:107], v[140:143]
    v_mfma_f32_16x16x32_bf16 v[128:131], v[184:187], v[112:115], v[128:131]
    s_waitcnt lgkmcnt(8)
    ds_read_b64_tr_b16 v[176:177], v218 offset:8192
    ds_read_b64_tr_b16 v[178:179], v218 offset:10240
    v_mfma_f32_16x16x32_bf16 v[136:139], v[184:187], v[120:123], v[136:139]
    v_mfma_f32_16x16x32_bf16 v[132:135], v[188:191], v[112:115], v[132:135]
    s_waitcnt lgkmcnt(8)
    ds_read_b64_tr_b16 v[180:181], v219 offset:8192
    ds_read_b64_tr_b16 v[182:183], v219 offset:10240
    v_mfma_f32_16x16x32_bf16 v[140:143], v[188:191], v[120:123], v[140:143]
    v_mfma_f32_16x16x32_bf16 v[144:147], v[160:163], v[0:3], 0
    s_waitcnt lgkmcnt(8)
    ds_read_b64_tr_b16 v[184:185], v218 offset:12288
    ds_read_b64_tr_b16 v[186:187], v218 offset:14336
    v_mfma_f32_16x16x32_bf16 v[152:155], v[160:163], v[8:11], 0
    v_add_u32 v218, 4294901760, v218
    v_mfma_f32_16x16x32_bf16 v[148:151], v[164:167], v[0:3], 0
    s_waitcnt lgkmcnt(8)
    ds_read_b64_tr_b16 v[188:189], v219 offset:12288
    ds_read_b64_tr_b16 v[190:191], v219 offset:14336
    v_mfma_f32_16x16x32_bf16 v[156:159], v[164:167], v[8:11], 0
    v_add_u32 v219, 4294901760, v219
    v_mfma_f32_16x16x32_bf16 v[144:147], v[168:171], v[16:19], v[144:147]
    s_waitcnt lgkmcnt(8)
    ds_read_b64_tr_b16 v[160:161], v218 offset:16384
    ds_read_b64_tr_b16 v[162:163], v218 offset:18432
    v_mfma_f32_16x16x32_bf16 v[152:155], v[168:171], v[24:27], v[152:155]
    v_cvt_pk_bf16_f32 v4, v128, v129
    v_cvt_pk_bf16_f32 v5, v130, v131
    v_mfma_f32_16x16x32_bf16 v[148:151], v[172:175], v[16:19], v[148:151]
    s_waitcnt lgkmcnt(8)
    ds_read_b64_tr_b16 v[164:165], v219 offset:16384
    ds_read_b64_tr_b16 v[166:167], v219 offset:18432
    v_mfma_f32_16x16x32_bf16 v[156:159], v[172:175], v[24:27], v[156:159]
    v_cvt_pk_bf16_f32 v6, v132, v133
    v_cvt_pk_bf16_f32 v7, v134, v135
    v_mfma_f32_16x16x32_bf16 v[144:147], v[176:179], v[32:35], v[144:147]
    s_waitcnt lgkmcnt(8)
    ds_read_b64_tr_b16 v[168:169], v218 offset:20480
    ds_read_b64_tr_b16 v[170:171], v218 offset:22528
    v_mfma_f32_16x16x32_bf16 v[152:155], v[176:179], v[40:43], v[152:155]
    s_lshl_b32 s40, s68, 8
    buffer_store_dwordx4 v[4:7], v192, s[28:31], s40 offen offset:0 sc0 sc1
    v_cvt_pk_bf16_f32 v12, v136, v137
    v_cvt_pk_bf16_f32 v13, v138, v139
    v_mfma_f32_16x16x32_bf16 v[148:151], v[180:183], v[32:35], v[148:151]
    s_waitcnt lgkmcnt(8)
    ds_read_b64_tr_b16 v[172:173], v219 offset:20480
    ds_read_b64_tr_b16 v[174:175], v219 offset:22528
    v_mfma_f32_16x16x32_bf16 v[156:159], v[180:183], v[40:43], v[156:159]
    v_cvt_pk_bf16_f32 v14, v140, v141
    v_cvt_pk_bf16_f32 v15, v142, v143
    v_mfma_f32_16x16x32_bf16 v[144:147], v[184:187], v[48:51], v[144:147]
    s_waitcnt lgkmcnt(8)
    ds_read_b64_tr_b16 v[176:177], v218 offset:24576
    ds_read_b64_tr_b16 v[178:179], v218 offset:26624
    v_mfma_f32_16x16x32_bf16 v[152:155], v[184:187], v[56:59], v[152:155]
    v_mfma_f32_16x16x32_bf16 v[148:151], v[188:191], v[48:51], v[148:151]
    s_waitcnt lgkmcnt(8)
    ds_read_b64_tr_b16 v[180:181], v219 offset:24576
    ds_read_b64_tr_b16 v[182:183], v219 offset:26624
    v_mfma_f32_16x16x32_bf16 v[156:159], v[188:191], v[56:59], v[156:159]
    v_mfma_f32_16x16x32_bf16 v[144:147], v[160:163], v[64:67], v[144:147]
    s_waitcnt lgkmcnt(8)
    ds_read_b64_tr_b16 v[184:185], v218 offset:28672
    ds_read_b64_tr_b16 v[186:187], v218 offset:30720
    v_mfma_f32_16x16x32_bf16 v[152:155], v[160:163], v[72:75], v[152:155]
    v_mfma_f32_16x16x32_bf16 v[148:151], v[164:167], v[64:67], v[148:151]
    s_waitcnt lgkmcnt(8)
    ds_read_b64_tr_b16 v[188:189], v219 offset:28672
    ds_read_b64_tr_b16 v[190:191], v219 offset:30720
    v_mfma_f32_16x16x32_bf16 v[156:159], v[164:167], v[72:75], v[156:159]
    s_waitcnt vmcnt(25)
    s_barrier
    v_mfma_f32_16x16x32_bf16 v[144:147], v[168:171], v[80:83], v[144:147]
    s_waitcnt lgkmcnt(8)
    ds_read_b64_tr_b16 v[160:161], v216 offset:32768
    ds_read_b64_tr_b16 v[162:163], v216 offset:34816
    v_mfma_f32_16x16x32_bf16 v[152:155], v[168:171], v[88:91], v[152:155]
    buffer_store_dwordx4 v[12:15], v192, s[28:31], s40 offen offset:2048 sc0 sc1
    v_mfma_f32_16x16x32_bf16 v[148:151], v[172:175], v[80:83], v[148:151]
    s_waitcnt lgkmcnt(8)
    ds_read_b64_tr_b16 v[164:165], v217 offset:32768
    ds_read_b64_tr_b16 v[166:167], v217 offset:34816
    v_mfma_f32_16x16x32_bf16 v[156:159], v[172:175], v[88:91], v[156:159]
    v_mfma_f32_16x16x32_bf16 v[144:147], v[176:179], v[96:99], v[144:147]
    s_waitcnt lgkmcnt(8)
    ds_read_b64_tr_b16 v[168:169], v216 offset:36864
    ds_read_b64_tr_b16 v[170:171], v216 offset:38912
    v_mfma_f32_16x16x32_bf16 v[152:155], v[176:179], v[104:107], v[152:155]
    v_mfma_f32_16x16x32_bf16 v[148:151], v[180:183], v[96:99], v[148:151]
    s_waitcnt lgkmcnt(8)
    ds_read_b64_tr_b16 v[172:173], v217 offset:36864
    ds_read_b64_tr_b16 v[174:175], v217 offset:38912
    v_mfma_f32_16x16x32_bf16 v[156:159], v[180:183], v[104:107], v[156:159]
    v_mfma_f32_16x16x32_bf16 v[144:147], v[184:187], v[112:115], v[144:147]
    s_waitcnt lgkmcnt(8)
    ds_read_b64_tr_b16 v[176:177], v216 offset:40960
    ds_read_b64_tr_b16 v[178:179], v216 offset:43008
    v_mfma_f32_16x16x32_bf16 v[152:155], v[184:187], v[120:123], v[152:155]
    v_mfma_f32_16x16x32_bf16 v[148:151], v[188:191], v[112:115], v[148:151]
    s_waitcnt lgkmcnt(8)
    ds_read_b64_tr_b16 v[180:181], v217 offset:40960
    ds_read_b64_tr_b16 v[182:183], v217 offset:43008
    v_mfma_f32_16x16x32_bf16 v[156:159], v[188:191], v[120:123], v[156:159]
    v_mfma_f32_16x16x32_bf16 v[224:227], v[160:163], v[0:3], 0
    s_waitcnt lgkmcnt(8)
    ds_read_b64_tr_b16 v[184:185], v216 offset:45056
    ds_read_b64_tr_b16 v[186:187], v216 offset:47104
    v_mfma_f32_16x16x32_bf16 v[232:235], v[160:163], v[8:11], 0
    v_mfma_f32_16x16x32_bf16 v[228:231], v[164:167], v[0:3], 0
    s_waitcnt lgkmcnt(8)
    ds_read_b64_tr_b16 v[188:189], v217 offset:45056
    ds_read_b64_tr_b16 v[190:191], v217 offset:47104
    v_mfma_f32_16x16x32_bf16 v[236:239], v[164:167], v[8:11], 0
    v_mfma_f32_16x16x32_bf16 v[224:227], v[168:171], v[16:19], v[224:227]
    s_waitcnt lgkmcnt(8)
    ds_read_b64_tr_b16 v[160:161], v216 offset:49152
    ds_read_b64_tr_b16 v[162:163], v216 offset:51200
    v_mfma_f32_16x16x32_bf16 v[232:235], v[168:171], v[24:27], v[232:235]
    v_cvt_pk_bf16_f32 v20, v144, v145
    v_cvt_pk_bf16_f32 v21, v146, v147
    v_mfma_f32_16x16x32_bf16 v[228:231], v[172:175], v[16:19], v[228:231]
    s_waitcnt lgkmcnt(8)
    ds_read_b64_tr_b16 v[164:165], v217 offset:49152
    ds_read_b64_tr_b16 v[166:167], v217 offset:51200
    v_mfma_f32_16x16x32_bf16 v[236:239], v[172:175], v[24:27], v[236:239]
    v_cvt_pk_bf16_f32 v22, v148, v149
    v_cvt_pk_bf16_f32 v23, v150, v151
    v_mfma_f32_16x16x32_bf16 v[224:227], v[176:179], v[32:35], v[224:227]
    s_waitcnt lgkmcnt(8)
    ds_read_b64_tr_b16 v[168:169], v216 offset:53248
    ds_read_b64_tr_b16 v[170:171], v216 offset:55296
    v_mfma_f32_16x16x32_bf16 v[232:235], v[176:179], v[40:43], v[232:235]
    buffer_store_dwordx4 v[20:23], v192, s[28:31], s40 offen offset:512 sc0 sc1
    v_cvt_pk_bf16_f32 v28, v152, v153
    v_cvt_pk_bf16_f32 v29, v154, v155
    v_mfma_f32_16x16x32_bf16 v[228:231], v[180:183], v[32:35], v[228:231]
    s_waitcnt lgkmcnt(8)
    ds_read_b64_tr_b16 v[172:173], v217 offset:53248
    ds_read_b64_tr_b16 v[174:175], v217 offset:55296
    v_mfma_f32_16x16x32_bf16 v[236:239], v[180:183], v[40:43], v[236:239]
    v_cvt_pk_bf16_f32 v30, v156, v157
    v_cvt_pk_bf16_f32 v31, v158, v159
    v_mfma_f32_16x16x32_bf16 v[224:227], v[184:187], v[48:51], v[224:227]
    s_waitcnt lgkmcnt(8)
    ds_read_b64_tr_b16 v[176:177], v216 offset:57344
    ds_read_b64_tr_b16 v[178:179], v216 offset:59392
    v_mfma_f32_16x16x32_bf16 v[232:235], v[184:187], v[56:59], v[232:235]
    v_mfma_f32_16x16x32_bf16 v[228:231], v[188:191], v[48:51], v[228:231]
    s_waitcnt lgkmcnt(8)
    ds_read_b64_tr_b16 v[180:181], v217 offset:57344
    ds_read_b64_tr_b16 v[182:183], v217 offset:59392
    v_mfma_f32_16x16x32_bf16 v[236:239], v[188:191], v[56:59], v[236:239]
    v_mfma_f32_16x16x32_bf16 v[224:227], v[160:163], v[64:67], v[224:227]
    s_waitcnt lgkmcnt(8)
    ds_read_b64_tr_b16 v[184:185], v216 offset:61440
    ds_read_b64_tr_b16 v[186:187], v216 offset:63488
    v_mfma_f32_16x16x32_bf16 v[232:235], v[160:163], v[72:75], v[232:235]
    v_add_u32 v216, 4294901760, v216
    v_mfma_f32_16x16x32_bf16 v[228:231], v[164:167], v[64:67], v[228:231]
    s_waitcnt lgkmcnt(8)
    ds_read_b64_tr_b16 v[188:189], v217 offset:61440
    ds_read_b64_tr_b16 v[190:191], v217 offset:63488
    v_mfma_f32_16x16x32_bf16 v[236:239], v[164:167], v[72:75], v[236:239]
    v_add_u32 v217, 4294901760, v217
    v_mfma_f32_16x16x32_bf16 v[224:227], v[168:171], v[80:83], v[224:227]
    s_waitcnt lgkmcnt(8)
    ds_read_b64_tr_b16 v[160:161], v218 offset:32768
    ds_read_b64_tr_b16 v[162:163], v218 offset:34816
    v_mfma_f32_16x16x32_bf16 v[232:235], v[168:171], v[88:91], v[232:235]
    buffer_store_dwordx4 v[28:31], v192, s[28:31], s40 offen offset:2560 sc0 sc1
    v_mfma_f32_16x16x32_bf16 v[228:231], v[172:175], v[80:83], v[228:231]
    s_waitcnt lgkmcnt(8)
    ds_read_b64_tr_b16 v[164:165], v219 offset:32768
    ds_read_b64_tr_b16 v[166:167], v219 offset:34816
    v_mfma_f32_16x16x32_bf16 v[236:239], v[172:175], v[88:91], v[236:239]
    v_mfma_f32_16x16x32_bf16 v[224:227], v[176:179], v[96:99], v[224:227]
    s_waitcnt lgkmcnt(8)
    ds_read_b64_tr_b16 v[168:169], v218 offset:36864
    ds_read_b64_tr_b16 v[170:171], v218 offset:38912
    v_mfma_f32_16x16x32_bf16 v[232:235], v[176:179], v[104:107], v[232:235]
    v_mfma_f32_16x16x32_bf16 v[228:231], v[180:183], v[96:99], v[228:231]
    s_waitcnt lgkmcnt(8)
    ds_read_b64_tr_b16 v[172:173], v219 offset:36864
    ds_read_b64_tr_b16 v[174:175], v219 offset:38912
    v_mfma_f32_16x16x32_bf16 v[236:239], v[180:183], v[104:107], v[236:239]
    v_mfma_f32_16x16x32_bf16 v[224:227], v[184:187], v[112:115], v[224:227]
    s_waitcnt lgkmcnt(8)
    ds_read_b64_tr_b16 v[176:177], v218 offset:40960
    ds_read_b64_tr_b16 v[178:179], v218 offset:43008
    v_mfma_f32_16x16x32_bf16 v[232:235], v[184:187], v[120:123], v[232:235]
    v_mfma_f32_16x16x32_bf16 v[228:231], v[188:191], v[112:115], v[228:231]
    s_waitcnt lgkmcnt(8)
    ds_read_b64_tr_b16 v[180:181], v219 offset:40960
    ds_read_b64_tr_b16 v[182:183], v219 offset:43008
    v_mfma_f32_16x16x32_bf16 v[236:239], v[188:191], v[120:123], v[236:239]
    v_mfma_f32_16x16x32_bf16 v[240:243], v[160:163], v[0:3], 0
    s_waitcnt lgkmcnt(8)
    ds_read_b64_tr_b16 v[184:185], v218 offset:45056
    ds_read_b64_tr_b16 v[186:187], v218 offset:47104
    v_mfma_f32_16x16x32_bf16 v[248:251], v[160:163], v[8:11], 0
    v_mfma_f32_16x16x32_bf16 v[244:247], v[164:167], v[0:3], 0
    s_waitcnt lgkmcnt(8)
    ds_read_b64_tr_b16 v[188:189], v219 offset:45056
    ds_read_b64_tr_b16 v[190:191], v219 offset:47104
    v_mfma_f32_16x16x32_bf16 v[252:255], v[164:167], v[8:11], 0
    v_mfma_f32_16x16x32_bf16 v[240:243], v[168:171], v[16:19], v[240:243]
    s_waitcnt lgkmcnt(8)
    ds_read_b64_tr_b16 v[160:161], v218 offset:49152
    ds_read_b64_tr_b16 v[162:163], v218 offset:51200
    v_mfma_f32_16x16x32_bf16 v[248:251], v[168:171], v[24:27], v[248:251]
L_rdy:
    v_cmp_ne_u32 vcc, 0, v194
    s_cbranch_vccnz L_rdy_ok
    v_mov_b32 v194, 0
    buffer_load_dword v194, v194, s[76:79], 0 offen sc0 sc1
    s_waitcnt vmcnt(0)
    s_sub_u32 s3, s3, 1
    s_cmp_gt_i32 s3, 0
    s_cbranch_scc1 L_rdy
L_rdy_ok:
    s_mov_b64 vcc, 0
    v_and_b32 v194, 0x2000, v194
    v_add_u32 v193, v193, v194
    v_add_u32 v195, v195, v194
    s_add_u32 s6, s74, 4
    v_mov_b32 v203, s6
    s_waitcnt vmcnt(4)
    s_mov_b64 exec, 1
    buffer_store_dword v203, v193, s[44:47], 0 offen sc0 sc1
    s_mov_b64 exec, -1
    v_cvt_pk_bf16_f32 v36, v224, v225
    v_cvt_pk_bf16_f32 v37, v226, v227
    v_mfma_f32_16x16x32_bf16 v[244:247], v[172:175], v[16:19], v[244:247]
    s_waitcnt lgkmcnt(8)
    ds_read_b64_tr_b16 v[164:165], v219 offset:49152
    ds_read_b64_tr_b16 v[166:167], v219 offset:51200
    v_mfma_f32_16x16x32_bf16 v[252:255], v[172:175], v[24:27], v[252:255]
    v_cvt_pk_bf16_f32 v38, v228, v229
    v_cvt_pk_bf16_f32 v39, v230, v231
    v_mfma_f32_16x16x32_bf16 v[240:243], v[176:179], v[32:35], v[240:243]
    s_waitcnt lgkmcnt(8)
    ds_read_b64_tr_b16 v[168:169], v218 offset:53248
    ds_read_b64_tr_b16 v[170:171], v218 offset:55296
    v_mfma_f32_16x16x32_bf16 v[248:251], v[176:179], v[40:43], v[248:251]
    s_lshl_b32 s40, s69, 8
    buffer_store_dwordx4 v[36:39], v192, s[28:31], s40 offen offset:0 sc0 sc1
    v_cvt_pk_bf16_f32 v44, v232, v233
    v_cvt_pk_bf16_f32 v45, v234, v235
    v_mfma_f32_16x16x32_bf16 v[244:247], v[180:183], v[32:35], v[244:247]
    s_waitcnt lgkmcnt(8)
    ds_read_b64_tr_b16 v[172:173], v219 offset:53248
    ds_read_b64_tr_b16 v[174:175], v219 offset:55296
    v_mfma_f32_16x16x32_bf16 v[252:255], v[180:183], v[40:43], v[252:255]
    v_cvt_pk_bf16_f32 v46, v236, v237
    v_cvt_pk_bf16_f32 v47, v238, v239
    v_mfma_f32_16x16x32_bf16 v[240:243], v[184:187], v[48:51], v[240:243]
    s_waitcnt lgkmcnt(8)
    ds_read_b64_tr_b16 v[176:177], v218 offset:57344
    ds_read_b64_tr_b16 v[178:179], v218 offset:59392
    v_mfma_f32_16x16x32_bf16 v[248:251], v[184:187], v[56:59], v[248:251]
    v_mfma_f32_16x16x32_bf16 v[244:247], v[188:191], v[48:51], v[244:247]
    s_waitcnt lgkmcnt(8)
    ds_read_b64_tr_b16 v[180:181], v219 offset:57344
    ds_read_b64_tr_b16 v[182:183], v219 offset:59392
    v_mfma_f32_16x16x32_bf16 v[252:255], v[188:191], v[56:59], v[252:255]
    v_mfma_f32_16x16x32_bf16 v[240:243], v[160:163], v[64:67], v[240:243]
    s_waitcnt lgkmcnt(8)
    ds_read_b64_tr_b16 v[184:185], v218 offset:61440
    ds_read_b64_tr_b16 v[186:187], v218 offset:63488
    v_mfma_f32_16x16x32_bf16 v[248:251], v[160:163], v[72:75], v[248:251]
    v_add_u32 v218, 4294901760, v218
    v_mfma_f32_16x16x32_bf16 v[244:247], v[164:167], v[64:67], v[244:247]
    s_waitcnt lgkmcnt(8)
    ds_read_b64_tr_b16 v[188:189], v219 offset:61440
    ds_read_b64_tr_b16 v[190:191], v219 offset:63488
    v_mfma_f32_16x16x32_bf16 v[252:255], v[164:167], v[72:75], v[252:255]
    s_waitcnt vmcnt(22)
    s_barrier
    v_add_u32 v219, 4294901760, v219
    v_mfma_f32_16x16x32_bf16 v[240:243], v[168:171], v[80:83], v[240:243]
    s_waitcnt lgkmcnt(8)
    ds_read_b64_tr_b16 v[160:161], v216 offset:32768
    ds_read_b64_tr_b16 v[162:163], v216 offset:34816
    v_mfma_f32_16x16x32_bf16 v[248:251], v[168:171], v[88:91], v[248:251]
    buffer_store_dwordx4 v[44:47], v192, s[28:31], s40 offen offset:2048 sc0 sc1
    v_mfma_f32_16x16x32_bf16 v[244:247], v[172:175], v[80:83], v[244:247]
    s_waitcnt lgkmcnt(8)
    ds_read_b64_tr_b16 v[164:165], v217 offset:32768
    ds_read_b64_tr_b16 v[166:167], v217 offset:34816
    v_mfma_f32_16x16x32_bf16 v[252:255], v[172:175], v[88:91], v[252:255]
    v_mfma_f32_16x16x32_bf16 v[240:243], v[176:179], v[96:99], v[240:243]
    s_waitcnt lgkmcnt(8)
    ds_read_b64_tr_b16 v[168:169], v216 offset:36864
    ds_read_b64_tr_b16 v[170:171], v216 offset:38912
    v_mfma_f32_16x16x32_bf16 v[248:251], v[176:179], v[104:107], v[248:251]
    v_mfma_f32_16x16x32_bf16 v[244:247], v[180:183], v[96:99], v[244:247]
    s_waitcnt lgkmcnt(8)
    ds_read_b64_tr_b16 v[172:173], v217 offset:36864
    ds_read_b64_tr_b16 v[174:175], v217 offset:38912
    v_mfma_f32_16x16x32_bf16 v[252:255], v[180:183], v[104:107], v[252:255]
    v_mfma_f32_16x16x32_bf16 v[240:243], v[184:187], v[112:115], v[240:243]
    s_waitcnt lgkmcnt(8)
    ds_read_b64_tr_b16 v[176:177], v216 offset:40960
    ds_read_b64_tr_b16 v[178:179], v216 offset:43008
    v_mfma_f32_16x16x32_bf16 v[248:251], v[184:187], v[120:123], v[248:251]
HK2:
    s_cbranch_vccnz HR2
    v_mfma_f32_16x16x32_bf16 v[244:247], v[188:191], v[112:115], v[244:247]
    s_waitcnt lgkmcnt(8)
    ds_read_b64_tr_b16 v[180:181], v217 offset:40960
    ds_read_b64_tr_b16 v[182:183], v217 offset:43008
    v_mfma_f32_16x16x32_bf16 v[252:255], v[188:191], v[120:123], v[252:255]
    v_mfma_f32_16x16x32_bf16 v[128:131], v[160:163], v[0:3], 0
    s_waitcnt lgkmcnt(8)
    ds_read_b64_tr_b16 v[184:185], v216 offset:45056
    ds_read_b64_tr_b16 v[186:187], v216 offset:47104
    v_mfma_f32_16x16x32_bf16 v[136:139], v[160:163], v[8:11], 0
    v_add_u32 v216, 65536, v216
    v_mfma_f32_16x16x32_bf16 v[132:135], v[164:167], v[0:3], 0
    s_waitcnt lgkmcnt(8)
    ds_read_b64_tr_b16 v[188:189], v217 offset:45056
    ds_read_b64_tr_b16 v[190:191], v217 offset:47104
    v_mfma_f32_16x16x32_bf16 v[140:143], v[164:167], v[8:11], 0
    v_add_u32 v217, 65536, v217
    v_mfma_f32_16x16x32_bf16 v[128:131], v[168:171], v[16:19], v[128:131]
    s_waitcnt lgkmcnt(8)
    ds_read_b64_tr_b16 v[160:161], v216 offset:0
    ds_read_b64_tr_b16 v[162:163], v216 offset:2048
    v_mfma_f32_16x16x32_bf16 v[136:139], v[168:171], v[24:27], v[136:139]
    v_cvt_pk_bf16_f32 v52, v240, v241
    v_cvt_pk_bf16_f32 v53, v242, v243
    v_mfma_f32_16x16x32_bf16 v[132:135], v[172:175], v[16:19], v[132:135]
    s_waitcnt lgkmcnt(8)
    ds_read_b64_tr_b16 v[164:165], v217 offset:0
    ds_read_b64_tr_b16 v[166:167], v217 offset:2048
    v_mfma_f32_16x16x32_bf16 v[140:143], v[172:175], v[24:27], v[140:143]
    v_cvt_pk_bf16_f32 v54, v244, v245
    v_cvt_pk_bf16_f32 v55, v246, v247
    v_mfma_f32_16x16x32_bf16 v[128:131], v[176:179], v[32:35], v[128:131]
    s_waitcnt lgkmcnt(8)
    ds_read_b64_tr_b16 v[168:169], v216 offset:4096
    ds_read_b64_tr_b16 v[170:171], v216 offset:6144
    v_mfma_f32_16x16x32_bf16 v[136:139], v[176:179], v[40:43], v[136:139]
    buffer_store_dwordx4 v[52:55], v192, s[28:31], s40 offen offset:512 sc0 sc1
    v_cvt_pk_bf16_f32 v60, v248, v249
    v_cvt_pk_bf16_f32 v61, v250, v251
    v_mfma_f32_16x16x32_bf16 v[132:135], v[180:183], v[32:35], v[132:135]
    s_waitcnt lgkmcnt(8)
    ds_read_b64_tr_b16 v[172:173], v217 offset:4096
    ds_read_b64_tr_b16 v[174:175], v217 offset:6144
    v_mfma_f32_16x16x32_bf16 v[140:143], v[180:183], v[40:43], v[140:143]
    v_cvt_pk_bf16_f32 v62, v252, v253
    v_cvt_pk_bf16_f32 v63, v254, v255
    v_mfma_f32_16x16x32_bf16 v[128:131], v[184:187], v[48:51], v[128:131]
    s_waitcnt lgkmcnt(8)
    ds_read_b64_tr_b16 v[176:177], v216 offset:8192
    ds_read_b64_tr_b16 v[178:179], v216 offset:10240
    v_mfma_f32_16x16x32_bf16 v[136:139], v[184:187], v[56:59], v[136:139]
    v_mfma_f32_16x16x32_bf16 v[132:135], v[188:191], v[48:51], v[132:135]
    s_waitcnt lgkmcnt(8)
    ds_read_b64_tr_b16 v[180:181], v217 offset:8192
    ds_read_b64_tr_b16 v[182:183], v217 offset:10240
    v_mfma_f32_16x16x32_bf16 v[140:143], v[188:191], v[56:59], v[140:143]
    v_mfma_f32_16x16x32_bf16 v[128:131], v[160:163], v[64:67], v[128:131]
    s_waitcnt lgkmcnt(8)
    ds_read_b64_tr_b16 v[184:185], v216 offset:12288
    ds_read_b64_tr_b16 v[186:187], v216 offset:14336
    v_mfma_f32_16x16x32_bf16 v[136:139], v[160:163], v[72:75], v[136:139]
    v_mfma_f32_16x16x32_bf16 v[132:135], v[164:167], v[64:67], v[132:135]
    s_waitcnt lgkmcnt(8)
    ds_read_b64_tr_b16 v[188:189], v217 offset:12288
    ds_read_b64_tr_b16 v[190:191], v217 offset:14336
    v_mfma_f32_16x16x32_bf16 v[140:143], v[164:167], v[72:75], v[140:143]
    v_mfma_f32_16x16x32_bf16 v[128:131], v[168:171], v[80:83], v[128:131]
    s_waitcnt lgkmcnt(8)
    ds_read_b64_tr_b16 v[160:161], v218 offset:32768
    ds_read_b64_tr_b16 v[162:163], v218 offset:34816
    v_mfma_f32_16x16x32_bf16 v[136:139], v[168:171], v[88:91], v[136:139]
    buffer_store_dwordx4 v[60:63], v192, s[28:31], s40 offen offset:2560 sc0 sc1
    v_mfma_f32_16x16x32_bf16 v[132:135], v[172:175], v[80:83], v[132:135]
    s_waitcnt lgkmcnt(8)
    ds_read_b64_tr_b16 v[164:165], v219 offset:32768
    ds_read_b64_tr_b16 v[166:167], v219 offset:34816
    v_mfma_f32_16x16x32_bf16 v[140:143], v[172:175], v[88:91], v[140:143]
    v_mfma_f32_16x16x32_bf16 v[128:131], v[176:179], v[96:99], v[128:131]
    s_waitcnt lgkmcnt(8)
    ds_read_b64_tr_b16 v[168:169], v218 offset:36864
    ds_read_b64_tr_b16 v[170:171], v218 offset:38912
    v_mfma_f32_16x16x32_bf16 v[136:139], v[176:179], v[104:107], v[136:139]
    v_mfma_f32_16x16x32_bf16 v[132:135], v[180:183], v[96:99], v[132:135]
    s_waitcnt lgkmcnt(8)
    ds_read_b64_tr_b16 v[172:173], v219 offset:36864
    ds_read_b64_tr_b16 v[174:175], v219 offset:38912
    v_mfma_f32_16x16x32_bf16 v[140:143], v[180:183], v[104:107], v[140:143]
    v_mfma_f32_16x16x32_bf16 v[128:131], v[184:187], v[112:115], v[128:131]
    s_waitcnt lgkmcnt(8)
    ds_read_b64_tr_b16 v[176:177], v218 offset:40960
    ds_read_b64_tr_b16 v[178:179], v218 offset:43008
    v_mfma_f32_16x16x32_bf16 v[136:139], v[184:187], v[120:123], v[136:139]
    v_mfma_f32_16x16x32_bf16 v[132:135], v[188:191], v[112:115], v[132:135]
    s_waitcnt lgkmcnt(8)
    ds_read_b64_tr_b16 v[180:181], v219 offset:40960
    ds_read_b64_tr_b16 v[182:183], v219 offset:43008
    v_mfma_f32_16x16x32_bf16 v[140:143], v[188:191], v[120:123], v[140:143]
    v_mfma_f32_16x16x32_bf16 v[144:147], v[160:163], v[0:3], 0
    s_waitcnt lgkmcnt(8)
    ds_read_b64_tr_b16 v[184:185], v218 offset:45056
    ds_read_b64_tr_b16 v[186:187], v218 offset:47104
    v_mfma_f32_16x16x32_bf16 v[152:155], v[160:163], v[8:11], 0
    v_add_u32 v218, 65536, v218
    v_mfma_f32_16x16x32_bf16 v[148:151], v[164:167], v[0:3], 0
    s_waitcnt lgkmcnt(8)
    ds_read_b64_tr_b16 v[188:189], v219 offset:45056
    ds_read_b64_tr_b16 v[190:191], v219 offset:47104
    v_mfma_f32_16x16x32_bf16 v[156:159], v[164:167], v[8:11], 0
    v_add_u32 v219, 65536, v219
    v_mfma_f32_16x16x32_bf16 v[144:147], v[168:171], v[16:19], v[144:147]
    s_waitcnt lgkmcnt(8)
    ds_read_b64_tr_b16 v[160:161], v218 offset:0
    ds_read_b64_tr_b16 v[162:163], v218 offset:2048
    v_mfma_f32_16x16x32_bf16 v[152:155], v[168:171], v[24:27], v[152:155]
    v_cvt_pk_bf16_f32 v68, v128, v129
    v_cvt_pk_bf16_f32 v69, v130, v131
    v_mfma_f32_16x16x32_bf16 v[148:151], v[172:175], v[16:19], v[148:151]
    s_waitcnt lgkmcnt(8)
    ds_read_b64_tr_b16 v[164:165], v219 offset:0
    ds_read_b64_tr_b16 v[166:167], v219 offset:2048
    v_mfma_f32_16x16x32_bf16 v[156:159], v[172:175], v[24:27], v[156:159]
    v_cvt_pk_bf16_f32 v70, v132, v133
    v_cvt_pk_bf16_f32 v71, v134, v135
    v_mfma_f32_16x16x32_bf16 v[144:147], v[176:179], v[32:35], v[144:147]
    s_waitcnt lgkmcnt(8)
    ds_read_b64_tr_b16 v[168:169], v218 offset:4096
    ds_read_b64_tr_b16 v[170:171], v218 offset:6144
    v_mfma_f32_16x16x32_bf16 v[152:155], v[176:179], v[40:43], v[152:155]
    s_lshl_b32 s40, s70, 8
    buffer_store_dwordx4 v[68:71], v192, s[28:31], s40 offen offset:0 sc0 sc1
    v_cvt_pk_bf16_f32 v76, v136, v137
    v_cvt_pk_bf16_f32 v77, v138, v139
    v_mfma_f32_16x16x32_bf16 v[148:151], v[180:183], v[32:35], v[148:151]
    s_waitcnt lgkmcnt(8)
    ds_read_b64_tr_b16 v[172:173], v219 offset:4096
    ds_read_b64_tr_b16 v[174:175], v219 offset:6144
    v_mfma_f32_16x16x32_bf16 v[156:159], v[180:183], v[40:43], v[156:159]
    v_cvt_pk_bf16_f32 v78, v140, v141
    v_cvt_pk_bf16_f32 v79, v142, v143
    v_mfma_f32_16x16x32_bf16 v[144:147], v[184:187], v[48:51], v[144:147]
    s_waitcnt lgkmcnt(8)
    ds_read_b64_tr_b16 v[176:177], v218 offset:8192
    ds_read_b64_tr_b16 v[178:179], v218 offset:10240
    v_mfma_f32_16x16x32_bf16 v[152:155], v[184:187], v[56:59], v[152:155]
    v_mfma_f32_16x16x32_bf16 v[148:151], v[188:191], v[48:51], v[148:151]
    s_waitcnt lgkmcnt(8)
    ds_read_b64_tr_b16 v[180:181], v219 offset:8192
    ds_read_b64_tr_b16 v[182:183], v219 offset:10240
    v_mfma_f32_16x16x32_bf16 v[156:159], v[188:191], v[56:59], v[156:159]
    v_mfma_f32_16x16x32_bf16 v[144:147], v[160:163], v[64:67], v[144:147]
    s_waitcnt lgkmcnt(8)
    ds_read_b64_tr_b16 v[184:185], v218 offset:12288
    ds_read_b64_tr_b16 v[186:187], v218 offset:14336
    v_mfma_f32_16x16x32_bf16 v[152:155], v[160:163], v[72:75], v[152:155]
    v_mfma_f32_16x16x32_bf16 v[148:151], v[164:167], v[64:67], v[148:151]
    s_waitcnt lgkmcnt(8)
    ds_read_b64_tr_b16 v[188:189], v219 offset:12288
    ds_read_b64_tr_b16 v[190:191], v219 offset:14336
    v_mfma_f32_16x16x32_bf16 v[156:159], v[164:167], v[72:75], v[156:159]
    v_mfma_f32_16x16x32_bf16 v[144:147], v[168:171], v[80:83], v[144:147]
    s_waitcnt lgkmcnt(8)
    v_mfma_f32_16x16x32_bf16 v[152:155], v[168:171], v[88:91], v[152:155]
    buffer_store_dwordx4 v[76:79], v192, s[28:31], s40 offen offset:2048 sc0 sc1
    v_mfma_f32_16x16x32_bf16 v[148:151], v[172:175], v[80:83], v[148:151]
    s_waitcnt lgkmcnt(6)
    v_mfma_f32_16x16x32_bf16 v[156:159], v[172:175], v[88:91], v[156:159]
    v_mfma_f32_16x16x32_bf16 v[144:147], v[176:179], v[96:99], v[144:147]
    s_waitcnt lgkmcnt(4)
    v_mfma_f32_16x16x32_bf16 v[152:155], v[176:179], v[104:107], v[152:155]
    v_mfma_f32_16x16x32_bf16 v[148:151], v[180:183], v[96:99], v[148:151]
    s_waitcnt lgkmcnt(2)
    v_mfma_f32_16x16x32_bf16 v[156:159], v[180:183], v[104:107], v[156:159]
    v_mfma_f32_16x16x32_bf16 v[144:147], v[184:187], v[112:115], v[144:147]
    s_waitcnt lgkmcnt(0)
    v_mfma_f32_16x16x32_bf16 v[152:155], v[184:187], v[120:123], v[152:155]
    v_mfma_f32_16x16x32_bf16 v[148:151], v[188:191], v[112:115], v[148:151]
    v_mfma_f32_16x16x32_bf16 v[156:159], v[188:191], v[120:123], v[156:159]
    s_nop 3
    v_cvt_pk_bf16_f32 v84, v144, v145
    v_cvt_pk_bf16_f32 v85, v146, v147
    s_nop 0
    v_cvt_pk_bf16_f32 v86, v148, v149
    v_cvt_pk_bf16_f32 v87, v150, v151
    buffer_store_dwordx4 v[84:87], v192, s[28:31], s40 offen offset:512 sc0 sc1
    v_cvt_pk_bf16_f32 v92, v152, v153
    v_cvt_pk_bf16_f32 v93, v154, v155
    v_cvt_pk_bf16_f32 v94, v156, v157
    v_cvt_pk_bf16_f32 v95, v158, v159
    buffer_store_dwordx4 v[92:95], v192, s[28:31], s40 offen offset:2560 sc0 sc1
    v_mbcnt_lo_u32_b32 v64, -1, 0
    v_mbcnt_hi_u32_b32 v64, -1, v64
    v_and_b32 v65, 1, v64
    v_lshlrev_b32 v65, 4, v65
    v_mov_b32 v66, 0x3f80
    v_lshlrev_b32 v66, v65, v66
    v_bfe_u32 v65, v64, 1, 3
    v_cmp_eq_u32 vcc, 0, v65
    s_nop 1
    v_cndmask_b32 v0, 0, v66, vcc
    v_cmp_eq_u32 vcc, 1, v65
    s_nop 1
    v_cndmask_b32 v1, 0, v66, vcc
    v_cmp_eq_u32 vcc, 2, v65
    s_nop 1
    v_cndmask_b32 v2, 0, v66, vcc
    v_cmp_eq_u32 vcc, 3, v65
    s_nop 1
    v_cndmask_b32 v3, 0, v66, vcc
    buffer_load_dword v202, v195, s[44:47], 0 offen sc0 sc1
    s_add_u32 s6, s74, 7
    v_mov_b32 v203, s6
    s_waitcnt vmcnt(1)
    s_mov_b64 exec, 1
    buffer_store_dword v203, v193, s[44:47], 0 offen sc0 sc1
    s_mov_b64 exec, -1
    s_waitcnt vmcnt(1)
L_chk3:
    v_and_b32 v220, 15, v202
    v_cmp_gt_u32 vcc, 4, v220
    s_cbranch_vccz L_ok3
    buffer_load_dword v202, v195, s[44:47], 0 offen sc0 sc1
    s_waitcnt vmcnt(0)
    s_sub_u32 s3, s3, 1
    s_cmp_gt_i32 s3, 0
    s_cbranch_scc1 L_chk3
L_ok3:
    v_cmp_lt_u32 vcc, 15, v202
    v_mbcnt_lo_u32_b32 v221, -1, 0
    v_mbcnt_hi_u32_b32 v221, -1, v221
    v_lshrrev_b32 v221, 4, v221
    v_lshrrev_b32 v221, v221, vcc_lo
    v_bfe_u32 v212, v221, 0, 1
    v_lshl_add_u32 v212, v212, 13, v200
    v_bfe_u32 v213, v221, 4, 1
    v_lshl_add_u32 v213, v213, 13, v200
    v_bfe_u32 v214, v221, 8, 1
    v_lshl_add_u32 v214, v214, 13, v200
    v_bfe_u32 v215, v221, 12, 1
    v_lshl_add_u32 v215, v215, 13, v200
    s_lshl_b32 s41, s64, 8
    buffer_load_dwordx4 a[0:3], v212, s[24:27], s41 offen sc0 sc1
    s_add_u32 s41, s41, 1048576
    buffer_load_dwordx4 a[4:7], v213, s[24:27], s41 offen sc0 sc1
    s_add_u32 s41, s41, 1048576
    buffer_load_dwordx4 a[8:11], v214, s[24:27], s41 offen sc0 sc1
    s_add_u32 s41, s41, 1048576
    buffer_load_dwordx4 a[12:15], v215, s[24:27], s41 offen sc0 sc1
    s_lshl_b32 s41, s65, 8
    buffer_load_dwordx4 a[16:19], v212, s[24:27], s41 offen sc0 sc1
    s_add_u32 s41, s41, 1048576
    buffer_load_dwordx4 a[20:23], v213, s[24:27], s41 offen sc0 sc1
    s_add_u32 s41, s41, 1048576
    buffer_load_dwordx4 a[24:27], v214, s[24:27], s41 offen sc0 sc1
    s_add_u32 s41, s41, 1048576
    buffer_load_dwordx4 a[28:31], v215, s[24:27], s41 offen sc0 sc1
    s_lshl_b32 s41, s66, 8
    buffer_load_dwordx4 a[32:35], v212, s[24:27], s41 offen sc0 sc1
    s_add_u32 s41, s41, 1048576
    buffer_load_dwordx4 a[36:39], v213, s[24:27], s41 offen sc0 sc1
    buffer_load_dword v202, v195, s[44:47], 0 offen sc0 sc1
    s_add_u32 s41, s41, 1048576
    buffer_load_dwordx4 a[40:43], v214, s[24:27], s41 offen sc0 sc1
    s_add_u32 s41, s41, 1048576
    buffer_load_dwordx4 a[44:47], v215, s[24:27], s41 offen sc0 sc1
    s_lshl_b32 s41, s67, 8
    buffer_load_dwordx4 a[48:51], v212, s[24:27], s41 offen sc0 sc1
    s_add_u32 s41, s41, 1048576
    buffer_load_dwordx4 a[52:55], v213, s[24:27], s41 offen sc0 sc1
    s_add_u32 s41, s41, 1048576
    buffer_load_dwordx4 a[56:59], v214, s[24:27], s41 offen sc0 sc1
    s_add_u32 s41, s41, 1048576
    buffer_load_dwordx4 a[60:63], v215, s[24:27], s41 offen sc0 sc1
    s_waitcnt vmcnt(6)
L_chk6:
    v_and_b32 v220, 15, v202
    v_cmp_gt_u32 vcc, 7, v220
    s_cbranch_vccz L_ok6
    buffer_load_dword v202, v195, s[44:47], 0 offen sc0 sc1
    s_waitcnt vmcnt(0)
    s_sub_u32 s3, s3, 1
    s_cmp_gt_i32 s3, 0
    s_cbranch_scc1 L_chk6
L_ok6:
    s_lshl_b32 s41, s68, 8
    buffer_load_dwordx4 a[64:67], v212, s[24:27], s41 offen sc0 sc1
    s_add_u32 s41, s41, 1048576
    buffer_load_dwordx4 a[68:71], v213, s[24:27], s41 offen sc0 sc1
    s_add_u32 s41, s41, 1048576
    buffer_load_dwordx4 a[72:75], v214, s[24:27], s41 offen sc0 sc1
    s_add_u32 s41, s41, 1048576
    buffer_load_dwordx4 a[76:79], v215, s[24:27], s41 offen sc0 sc1
    s_lshl_b32 s41, s69, 8
    buffer_load_dwordx4 a[80:83], v212, s[24:27], s41 offen sc0 sc1
    s_add_u32 s41, s41, 1048576
    buffer_load_dwordx4 a[84:87], v213, s[24:27], s41 offen sc0 sc1
    s_add_u32 s41, s41, 1048576
    buffer_load_dwordx4 a[88:91], v214, s[24:27], s41 offen sc0 sc1
    s_add_u32 s41, s41, 1048576
    buffer_load_dwordx4 a[92:95], v215, s[24:27], s41 offen sc0 sc1
    s_lshl_b32 s41, s70, 8
    buffer_load_dwordx4 a[96:99], v212, s[24:27], s41 offen sc0 sc1
    s_add_u32 s41, s41, 1048576
    buffer_load_dwordx4 a[100:103], v213, s[24:27], s41 offen sc0 sc1
    s_add_u32 s41, s41, 1048576
    buffer_load_dwordx4 a[104:107], v214, s[24:27], s41 offen sc0 sc1
    s_add_u32 s41, s41, 1048576
    buffer_load_dwordx4 a[108:111], v215, s[24:27], s41 offen sc0 sc1
    s_waitcnt vmcnt(28)
    v_mfma_f32_16x16x32_bf16 v[8:11], v[0:3], a[0:3], 0
    s_waitcnt vmcnt(27)
    v_mfma_f32_16x16x32_bf16 v[8:11], v[0:3], a[4:7], v[8:11]
    s_waitcnt vmcnt(26)
    v_mfma_f32_16x16x32_bf16 v[8:11], v[0:3], a[8:11], v[8:11]
    s_waitcnt vmcnt(25)
    v_mfma_f32_16x16x32_bf16 v[8:11], v[0:3], a[12:15], v[8:11]
    s_waitcnt vmcnt(24)
    v_mfma_f32_16x16x32_bf16 v[16:19], v[0:3], a[16:19], 0
    s_waitcnt vmcnt(23)
    v_mfma_f32_16x16x32_bf16 v[16:19], v[0:3], a[20:23], v[16:19]
    s_waitcnt vmcnt(22)
    v_mfma_f32_16x16x32_bf16 v[16:19], v[0:3], a[24:27], v[16:19]
    s_waitcnt vmcnt(21)
    v_mfma_f32_16x16x32_bf16 v[16:19], v[0:3], a[28:31], v[16:19]
    v_cvt_pk_bf16_f32 v8, v8, v9
    v_cvt_pk_bf16_f32 v9, v10, v11
    s_mov_b32 exec_hi, 0
    buffer_store_dwordx2 v[8:9], v201, s[16:19], s64 offen
    s_mov_b32 exec_hi, -1
    s_waitcnt vmcnt(21)
    v_mfma_f32_16x16x32_bf16 v[24:27], v[0:3], a[32:35], 0
    s_waitcnt vmcnt(20)
    v_mfma_f32_16x16x32_bf16 v[24:27], v[0:3], a[36:39], v[24:27]
    s_waitcnt vmcnt(18)
    v_mfma_f32_16x16x32_bf16 v[24:27], v[0:3], a[40:43], v[24:27]
    s_waitcnt vmcnt(17)
    v_mfma_f32_16x16x32_bf16 v[24:27], v[0:3], a[44:47], v[24:27]
    v_cvt_pk_bf16_f32 v16, v16, v17
    v_cvt_pk_bf16_f32 v17, v18, v19
    s_mov_b32 exec_hi, 0
    buffer_store_dwordx2 v[16:17], v201, s[16:19], s65 offen
    s_mov_b32 exec_hi, -1
    s_waitcnt vmcnt(17)
    v_mfma_f32_16x16x32_bf16 v[32:35], v[0:3], a[48:51], 0
    s_waitcnt vmcnt(16)
    v_mfma_f32_16x16x32_bf16 v[32:35], v[0:3], a[52:55], v[32:35]
    s_waitcnt vmcnt(15)
    v_mfma_f32_16x16x32_bf16 v[32:35], v[0:3], a[56:59], v[32:35]
    s_waitcnt vmcnt(14)
    v_mfma_f32_16x16x32_bf16 v[32:35], v[0:3], a[60:63], v[32:35]
    v_cvt_pk_bf16_f32 v24, v24, v25
    v_cvt_pk_bf16_f32 v25, v26, v27
    s_mov_b32 exec_hi, 0
    buffer_store_dwordx2 v[24:25], v201, s[16:19], s66 offen
    s_mov_b32 exec_hi, -1
    s_waitcnt vmcnt(14)
    v_mfma_f32_16x16x32_bf16 v[40:43], v[0:3], a[64:67], 0
    s_waitcnt vmcnt(13)
    v_mfma_f32_16x16x32_bf16 v[40:43], v[0:3], a[68:71], v[40:43]
    s_waitcnt vmcnt(12)
    v_mfma_f32_16x16x32_bf16 v[40:43], v[0:3], a[72:75], v[40:43]
    s_waitcnt vmcnt(11)
    v_mfma_f32_16x16x32_bf16 v[40:43], v[0:3], a[76:79], v[40:43]
    v_cvt_pk_bf16_f32 v32, v32, v33
    v_cvt_pk_bf16_f32 v33, v34, v35
    s_mov_b32 exec_hi, 0
    buffer_store_dwordx2 v[32:33], v201, s[16:19], s67 offen
    s_mov_b32 exec_hi, -1
    s_waitcnt vmcnt(11)
    v_mfma_f32_16x16x32_bf16 v[48:51], v[0:3], a[80:83], 0
    s_waitcnt vmcnt(10)
    v_mfma_f32_16x16x32_bf16 v[48:51], v[0:3], a[84:87], v[48:51]
    s_waitcnt vmcnt(9)
    v_mfma_f32_16x16x32_bf16 v[48:51], v[0:3], a[88:91], v[48:51]
    s_waitcnt vmcnt(8)
    v_mfma_f32_16x16x32_bf16 v[48:51], v[0:3], a[92:95], v[48:51]
    v_cvt_pk_bf16_f32 v40, v40, v41
    v_cvt_pk_bf16_f32 v41, v42, v43
    s_mov_b32 exec_hi, 0
    buffer_store_dwordx2 v[40:41], v201, s[16:19], s68 offen
    s_mov_b32 exec_hi, -1
    s_waitcnt vmcnt(8)
    v_mfma_f32_16x16x32_bf16 v[56:59], v[0:3], a[96:99], 0
    s_waitcnt vmcnt(7)
    v_mfma_f32_16x16x32_bf16 v[56:59], v[0:3], a[100:103], v[56:59]
    s_waitcnt vmcnt(6)
    v_mfma_f32_16x16x32_bf16 v[56:59], v[0:3], a[104:107], v[56:59]
    s_waitcnt vmcnt(5)
    v_mfma_f32_16x16x32_bf16 v[56:59], v[0:3], a[108:111], v[56:59]
    v_cvt_pk_bf16_f32 v48, v48, v49
    v_cvt_pk_bf16_f32 v49, v50, v51
    s_mov_b32 exec_hi, 0
    buffer_store_dwordx2 v[48:49], v201, s[16:19], s69 offen
    s_mov_b32 exec_hi, -1
    s_nop 2
    v_cvt_pk_bf16_f32 v56, v56, v57
    v_cvt_pk_bf16_f32 v57, v58, v59
    s_mov_b32 exec_hi, 0
    buffer_store_dwordx2 v[56:57], v201, s[16:19], s70 offen
    s_mov_b32 exec_hi, -1
L_end:
    s_endpgm
.section .rodata,"a"
.p2align 6
.amdhsa_kernel concat_heads__mha_block_cached__mha_block_cached__near_ridge_kernel
  .amdhsa_next_free_vgpr 512
  .amdhsa_next_free_sgpr 102
  .amdhsa_accum_offset 256
  .amdhsa_group_segment_fixed_size 0
  .amdhsa_kernarg_size 104
  .amdhsa_user_sgpr_count 2
  .amdhsa_user_sgpr_kernarg_segment_ptr 1
  .amdhsa_system_sgpr_workgroup_id_x 1
.end_amdhsa_kernel
```
